```python
import torch

def _softmax(x, axis=-1):
    return torch.softmax(x, dim=axis)

def _gelu(x):
    return torch.nn.functional.gelu(x, approximate='tanh')

def _silu(x):
    return torch.nn.functional.silu(x)

def _sigmoid(x):
    return torch.sigmoid(x)

def _layernorm(x, axis=-1, eps=1e-05):
    m = x.mean(dim=axis, keepdim=True)
    v = x.var(dim=axis, keepdim=True, unbiased=False)
    return (x - m) / torch.sqrt(v + eps)

def _scatter_add(tgt, idx, src, axis=0):
    return tgt.clone().index_add_(axis, idx, src)

def _segment_sum(src, seg, n):
    out = torch.zeros((n,) + src.shape[1:], dtype=src.dtype)
    return out.index_add_(0, seg, src)

def _pad(x, pw):
    flat = tuple((v for pair in reversed(pw) for v in pair))
    return torch.nn.functional.pad(x, flat)
kernel_name = 'interleave_layers__spectral_fnet__mixer_gmlp__prompt'

def setup_inputs():

    _w = lambda a: (lambda t: t.to(torch.bfloat16) if t.is_floating_point() else t)(torch.as_tensor(a))

    def _A_setup():
        B, S, D = (1, 2048, 1024)
        ns = torch.arange(S)[:, None] * torch.arange(S)[None, :]
        nd = torch.arange(D)[:, None] * torch.arange(D)[None, :]
        Ws_re = torch.cos(-2.0 * torch.pi * ns / S).to(float)
        Ws_im = torch.sin(-2.0 * torch.pi * ns / S).to(float)
        Wd_re = torch.cos(-2.0 * torch.pi * nd / D).to(float)
        Wd_im = torch.sin(-2.0 * torch.pi * nd / D).to(float)
        return {'x': _w((lambda *s: torch.randn(*s, dtype=torch.bfloat16) * 0.05)(B, S, D)), 'dft_seq_re': _w(Ws_re), 'dft_seq_im': _w(Ws_im), 'dft_hid_re': _w(Wd_re), 'dft_hid_im': _w(Wd_im)}
    _A_in = _A_setup()

    def _B_setup():
        B, S, D, F = (1, 2048, 1024, 3584)
        Fh = F // 2
        return {'x': _w((lambda *s: torch.randn(*s, dtype=torch.bfloat16) * 0.05)(B, S, D)), 'w_in': _w((lambda *s: torch.randn(*s, dtype=torch.bfloat16) * 1.6)(D, 2 * Fh)), 'w_sp': _w(0.01 * (lambda *s: torch.randn(*s, dtype=torch.bfloat16) * 1.6)(S, S)), 'b_sp': _w(1.0 + 0.01 * (lambda *s: torch.randn(*s, dtype=torch.bfloat16) * 1.6)(S)), 'w_out': _w((lambda *s: torch.randn(*s, dtype=torch.bfloat16) * 1.6)(Fh, D))}
    _B_in = _B_setup()
    return {'A_x': _A_in['x'], 'A_dft_seq_re': _A_in['dft_seq_re'], 'A_dft_seq_im': _A_in['dft_seq_im'], 'A_dft_hid_re': _A_in['dft_hid_re'], 'A_dft_hid_im': _A_in['dft_hid_im'], 'B_x': _B_in['x'], 'B_w_in': _B_in['w_in'], 'B_w_sp': _B_in['w_sp'], 'B_b_sp': _B_in['b_sp'], 'B_w_out': _B_in['w_out']}

def reference(A_x, A_dft_seq_re, A_dft_seq_im, A_dft_hid_re, A_dft_hid_im, B_x, B_w_in, B_w_sp, B_b_sp, B_w_out):

    def _A_ref(x, dft_seq_re, dft_seq_im, dft_hid_re, dft_hid_im):
        a = torch.einsum('bsd,ed->bse', x, dft_hid_re)
        b = torch.einsum('bsd,ed->bse', x, dft_hid_im)
        y = torch.einsum('ts,bse->bte', dft_seq_re, a) - torch.einsum('ts,bse->bte', dft_seq_im, b)
        return y

    def _B_ref(x, w_in, w_sp, b_sp, w_out):
        B, S, D = x.shape
        F = w_in.shape[-1]
        Fh = F // 2
        z = _gelu(torch.einsum('bsd,df->bsf', x, w_in))
        z1 = z[..., :Fh].clone()
        z2 = _layernorm(z[..., Fh:], axis=-1)
        g = torch.einsum('ts,bsf->btf', w_sp, z2) + b_sp[None, :, None]
        return torch.einsum('bsf,fd->bsd', z1 * g, w_out)
    x = A_x
    x = x + _A_ref(_layernorm(x, axis=-1), A_dft_seq_re, A_dft_seq_im, A_dft_hid_re, A_dft_hid_im)
    x = x + _B_ref(_layernorm(x, axis=-1), B_w_in, B_w_sp, B_b_sp, B_w_out)
    x = x + _A_ref(_layernorm(x, axis=-1), A_dft_seq_re, A_dft_seq_im, A_dft_hid_re, A_dft_hid_im)
    x = x + _B_ref(_layernorm(x, axis=-1), B_w_in, B_w_sp, B_b_sp, B_w_out)
    return x
```

```asm
; @launch kernel=g1_kernel grid=(256,1,1) block=(768,1,1) lds=161280
; @launch kernel=g2_kernel grid=(256,1,1) block=(512,1,1) lds=163840
.amdgcn_target "amdgcn-amd-amdhsa--gfx950"
.text
.globl g1_kernel
.p2align 8
.type g1_kernel,@function
g1_kernel:
  s_mov_b32 s90, 1
g1_kernel_body:
  s_cmp_ge_u32 s2, 256
  s_cbranch_scc1 g1_kernel_end
  v_lshrrev_b32 v1, 6, v0
  v_and_b32 v0, 63, v0
  v_readfirstlane_b32 s14, v1
g1_kernel_fe:
  s_load_dwordx2 s[4:5], s[0:1], 0
  s_load_dwordx2 s[8:9], s[0:1], 24
  s_load_dwordx2 s[22:23], s[0:1], 32
  s_and_b32 s3, s2, 7
  s_lshr_b32 s16, s2, 3
  s_and_b32 s12, s3, 1
  s_mul_i32 s12, s12, 8
  s_lshr_b32 s13, s3, 1
  s_mul_i32 s13, s13, 4
  s_and_b32 s3, s16, 7
  s_add_u32 s12, s12, s3
  s_lshr_b32 s16, s16, 3
  s_add_u32 s13, s13, s16
  s_mov_b32 s15, 0
  s_cmp_lt_u32 s14, 4
  s_cbranch_scc1 g1_kernel_comp
  s_cmp_ge_u32 s14, 8
  s_cbranch_scc1 g1_kernel_aux
  s_sub_u32 s24, s14, 4
  s_setprio 2
  s_mul_i32 s82, s12, 262144
  s_mul_i32 s3, s24, 16384
  s_add_u32 s82, s82, s3
  s_mul_i32 s84, s24, 1024
  v_lshrrev_b32 v6, 3, v0
  v_lshlrev_b32 v6, 11, v6
  v_lshrrev_b32 v3, 4, v0
  v_and_b32 v3, 1, v3
  v_xor_b32 v2, v0, v3
  v_and_b32 v2, 7, v2
  v_lshlrev_b32 v2, 4, v2
  v_add_u32 v6, v6, v2
  s_lshl_b32 s3, s24, 5
  v_xor_b32 v6, s3, v6
  v_add_u32 v6, s82, v6
  s_and_b32 s3, s13, 7
  s_mul_i32 s83, s3, 262144
  s_mul_i32 s3, s24, 16384
  s_add_u32 s83, s83, s3
  s_mul_i32 s85, s24, 1024
  s_add_u32 s85, s85, 16384
  v_lshrrev_b32 v7, 3, v0
  v_lshlrev_b32 v7, 11, v7
  v_lshrrev_b32 v3, 4, v0
  v_and_b32 v3, 1, v3
  v_xor_b32 v2, v0, v3
  v_and_b32 v2, 7, v2
  v_lshlrev_b32 v2, 4, v2
  v_add_u32 v7, v7, v2
  s_lshl_b32 s3, s24, 5
  v_xor_b32 v7, s3, v7
  v_add_u32 v7, s83, v7
  s_mov_b32 s17, 0
  s_mov_b32 s18, 0
  s_mov_b32 s80, 0
  s_mul_i32 s81, s12, 1
  s_mul_i32 s3, s13, 1
  s_add_u32 s81, s81, s3
  s_mov_b32 s16, 0
  s_waitcnt lgkmcnt(0)
  s_mov_b32 s6, 4194304
  s_mov_b32 s7, 0x20000
  s_mov_b32 s10, 2097152
  s_mov_b32 s11, 0x20000
  s_cmp_ge_u32 s13, 8
  s_cselect_b32 s8, s22, s8
  s_cselect_b32 s9, s23, s9
  s_add_u32 s3, s80, s81
  s_and_b32 s3, s3, 3
  s_andn2_b32 s19, s80, 3
  s_or_b32 s3, s3, s19
  s_mul_i32 s17, s3, 128
  s_mul_i32 s18, s3, 128
  s_lshl_b32 s3, s24, 12
  v_lshlrev_b32 v8, 6, v0
  v_lshrrev_b32 v2, 2, v0
  v_and_b32 v2, 3, v2
  v_lshlrev_b32 v2, 4, v2
  v_add_u32 v8, v8, v2
  v_add_u32 v8, s3, v8
  v_lshlrev_b32 v9, 6, v0
  v_lshrrev_b32 v2, 2, v0
  v_and_b32 v2, 3, v2
  v_xor_b32 v2, 1, v2
  v_lshlrev_b32 v2, 4, v2
  v_add_u32 v9, v9, v2
  v_add_u32 v9, s3, v9
  v_lshlrev_b32 v10, 6, v0
  v_lshrrev_b32 v2, 2, v0
  v_and_b32 v2, 3, v2
  v_xor_b32 v2, 2, v2
  v_lshlrev_b32 v2, 4, v2
  v_add_u32 v10, v10, v2
  v_add_u32 v10, s3, v10
  v_lshlrev_b32 v11, 6, v0
  v_lshrrev_b32 v2, 2, v0
  v_and_b32 v2, 3, v2
  v_xor_b32 v2, 3, v2
  v_lshlrev_b32 v2, 4, v2
  v_add_u32 v11, v11, v2
  v_add_u32 v11, s3, v11
  v_mov_b32 v48, 0
  v_mov_b32 v49, 0
  v_mov_b32 v50, 0
  v_mov_b32 v51, 0
  v_mov_b32 v52, 0
  v_mov_b32 v53, 0
  s_mov_b32 s98, 0
  s_mov_b32 s99, 0x3f803f80
  s_branch g1_kernel_ldissue2
g1_kernel_ldloop1:
  s_cmp_lt_u32 s16, 3
  s_cbranch_scc1 g1_kernel_ldissue2
  s_waitcnt vmcnt(16)
  s_barrier
g1_kernel_ldissue2:
  s_add_u32 s26, s15, s84
  s_mov_b32 m0, s26
  s_nop 0
  buffer_load_dwordx4 v6, s[4:7], s17 offen lds
  s_add_u32 m0, s26, 4096
  s_add_u32 s27, s17, 65536
  buffer_load_dwordx4 v6, s[4:7], s27 offen lds
  s_add_u32 m0, s26, 8192
  s_add_u32 s27, s17, 131072
  buffer_load_dwordx4 v6, s[4:7], s27 offen lds
  s_add_u32 m0, s26, 12288
  s_add_u32 s27, s17, 196608
  buffer_load_dwordx4 v6, s[4:7], s27 offen lds
  s_add_u32 s26, s15, s85
  s_mov_b32 m0, s26
  s_nop 0
  buffer_load_dwordx4 v7, s[8:11], s18 offen lds
  s_add_u32 m0, s26, 4096
  s_add_u32 s27, s18, 65536
  buffer_load_dwordx4 v7, s[8:11], s27 offen lds
  s_add_u32 m0, s26, 8192
  s_add_u32 s27, s18, 131072
  buffer_load_dwordx4 v7, s[8:11], s27 offen lds
  s_add_u32 m0, s26, 12288
  s_add_u32 s27, s18, 196608
  buffer_load_dwordx4 v7, s[8:11], s27 offen lds
  s_cmp_lt_u32 s16, 3
  s_cbranch_scc1 g1_kernel_hks3
  v_add_u32 v12, s98, v8
  v_add_u32 v13, s98, v9
  v_add_u32 v14, s98, v10
  v_add_u32 v15, s98, v11
  ds_read_b128 v[16:19], v12 offset:0
  ds_read_b128 v[20:23], v13 offset:0
  ds_read_b128 v[24:27], v14 offset:0
  ds_read_b128 v[28:31], v15 offset:0
  ds_read_b128 v[32:35], v12 offset:16384
  ds_read_b128 v[36:39], v13 offset:16384
  ds_read_b128 v[40:43], v14 offset:16384
  ds_read_b128 v[44:47], v15 offset:16384
  s_add_u32 s98, s98, 32768
  s_cmp_eq_u32 s98, 131072
  s_cselect_b32 s98, 0, s98
  s_waitcnt lgkmcnt(7)
  v_dot2c_f32_bf16 v48, s99, v16
  v_dot2c_f32_bf16 v50, v16, v16
  v_dot2c_f32_bf16 v49, s99, v17
  v_dot2c_f32_bf16 v51, v17, v17
  v_dot2c_f32_bf16 v48, s99, v18
  v_dot2c_f32_bf16 v50, v18, v18
  v_dot2c_f32_bf16 v49, s99, v19
  v_dot2c_f32_bf16 v51, v19, v19
  s_waitcnt lgkmcnt(6)
  v_dot2c_f32_bf16 v48, s99, v20
  v_dot2c_f32_bf16 v50, v20, v20
  v_dot2c_f32_bf16 v49, s99, v21
  v_dot2c_f32_bf16 v51, v21, v21
  v_dot2c_f32_bf16 v48, s99, v22
  v_dot2c_f32_bf16 v50, v22, v22
  v_dot2c_f32_bf16 v49, s99, v23
  v_dot2c_f32_bf16 v51, v23, v23
  s_waitcnt lgkmcnt(5)
  v_dot2c_f32_bf16 v48, s99, v24
  v_dot2c_f32_bf16 v50, v24, v24
  v_dot2c_f32_bf16 v49, s99, v25
  v_dot2c_f32_bf16 v51, v25, v25
  v_dot2c_f32_bf16 v48, s99, v26
  v_dot2c_f32_bf16 v50, v26, v26
  v_dot2c_f32_bf16 v49, s99, v27
  v_dot2c_f32_bf16 v51, v27, v27
  s_waitcnt lgkmcnt(4)
  v_dot2c_f32_bf16 v48, s99, v28
  v_dot2c_f32_bf16 v50, v28, v28
  v_dot2c_f32_bf16 v49, s99, v29
  v_dot2c_f32_bf16 v51, v29, v29
  v_dot2c_f32_bf16 v48, s99, v30
  v_dot2c_f32_bf16 v50, v30, v30
  v_dot2c_f32_bf16 v49, s99, v31
  v_dot2c_f32_bf16 v51, v31, v31
  s_waitcnt lgkmcnt(3)
  v_dot2c_f32_bf16 v52, s99, v32
  v_dot2c_f32_bf16 v53, s99, v33
  v_dot2c_f32_bf16 v52, s99, v34
  v_dot2c_f32_bf16 v53, s99, v35
  s_waitcnt lgkmcnt(2)
  v_dot2c_f32_bf16 v52, s99, v36
  v_dot2c_f32_bf16 v53, s99, v37
  v_dot2c_f32_bf16 v52, s99, v38
  v_dot2c_f32_bf16 v53, s99, v39
  s_waitcnt lgkmcnt(1)
  v_dot2c_f32_bf16 v52, s99, v40
  v_dot2c_f32_bf16 v53, s99, v41
  v_dot2c_f32_bf16 v52, s99, v42
  v_dot2c_f32_bf16 v53, s99, v43
  s_waitcnt lgkmcnt(0)
  v_dot2c_f32_bf16 v52, s99, v44
  v_dot2c_f32_bf16 v53, s99, v45
  v_dot2c_f32_bf16 v52, s99, v46
  v_dot2c_f32_bf16 v53, s99, v47
g1_kernel_hks3:
  s_add_u32 s15, s15, 32768
  s_cmp_eq_u32 s15, 131072
  s_cselect_b32 s15, 0, s15
  s_add_u32 s80, s80, 1
  s_add_u32 s3, s80, s81
  s_and_b32 s3, s3, 3
  s_andn2_b32 s19, s80, 3
  s_or_b32 s3, s3, s19
  s_mul_i32 s17, s3, 128
  s_mul_i32 s18, s3, 128
  s_add_u32 s16, s16, 1
  s_cmp_lt_u32 s16, 16
  s_cbranch_scc1 g1_kernel_ldloop1
  s_load_dwordx2 s[32:33], s[0:1], 96
  s_waitcnt lgkmcnt(0)
  s_add_u32 s32, s32, 44040192
  s_addc_u32 s33, s33, 0
  s_mov_b32 s34, 8192
  s_mov_b32 s35, 0x20000
  s_waitcnt vmcnt(16)
  s_barrier
  v_add_u32 v12, s98, v8
  v_add_u32 v13, s98, v9
  v_add_u32 v14, s98, v10
  v_add_u32 v15, s98, v11
  ds_read_b128 v[16:19], v12 offset:0
  ds_read_b128 v[20:23], v13 offset:0
  ds_read_b128 v[24:27], v14 offset:0
  ds_read_b128 v[28:31], v15 offset:0
  ds_read_b128 v[32:35], v12 offset:16384
  ds_read_b128 v[36:39], v13 offset:16384
  ds_read_b128 v[40:43], v14 offset:16384
  ds_read_b128 v[44:47], v15 offset:16384
  s_add_u32 s98, s98, 32768
  s_cmp_eq_u32 s98, 131072
  s_cselect_b32 s98, 0, s98
  s_waitcnt lgkmcnt(7)
  v_dot2c_f32_bf16 v48, s99, v16
  v_dot2c_f32_bf16 v50, v16, v16
  v_dot2c_f32_bf16 v49, s99, v17
  v_dot2c_f32_bf16 v51, v17, v17
  v_dot2c_f32_bf16 v48, s99, v18
  v_dot2c_f32_bf16 v50, v18, v18
  v_dot2c_f32_bf16 v49, s99, v19
  v_dot2c_f32_bf16 v51, v19, v19
  s_waitcnt lgkmcnt(6)
  v_dot2c_f32_bf16 v48, s99, v20
  v_dot2c_f32_bf16 v50, v20, v20
  v_dot2c_f32_bf16 v49, s99, v21
  v_dot2c_f32_bf16 v51, v21, v21
  v_dot2c_f32_bf16 v48, s99, v22
  v_dot2c_f32_bf16 v50, v22, v22
  v_dot2c_f32_bf16 v49, s99, v23
  v_dot2c_f32_bf16 v51, v23, v23
  s_waitcnt lgkmcnt(5)
  v_dot2c_f32_bf16 v48, s99, v24
  v_dot2c_f32_bf16 v50, v24, v24
  v_dot2c_f32_bf16 v49, s99, v25
  v_dot2c_f32_bf16 v51, v25, v25
  v_dot2c_f32_bf16 v48, s99, v26
  v_dot2c_f32_bf16 v50, v26, v26
  v_dot2c_f32_bf16 v49, s99, v27
  v_dot2c_f32_bf16 v51, v27, v27
  s_waitcnt lgkmcnt(4)
  v_dot2c_f32_bf16 v48, s99, v28
  v_dot2c_f32_bf16 v50, v28, v28
  v_dot2c_f32_bf16 v49, s99, v29
  v_dot2c_f32_bf16 v51, v29, v29
  v_dot2c_f32_bf16 v48, s99, v30
  v_dot2c_f32_bf16 v50, v30, v30
  v_dot2c_f32_bf16 v49, s99, v31
  v_dot2c_f32_bf16 v51, v31, v31
  s_waitcnt lgkmcnt(3)
  v_dot2c_f32_bf16 v52, s99, v32
  v_dot2c_f32_bf16 v53, s99, v33
  v_dot2c_f32_bf16 v52, s99, v34
  v_dot2c_f32_bf16 v53, s99, v35
  s_waitcnt lgkmcnt(2)
  v_dot2c_f32_bf16 v52, s99, v36
  v_dot2c_f32_bf16 v53, s99, v37
  v_dot2c_f32_bf16 v52, s99, v38
  v_dot2c_f32_bf16 v53, s99, v39
  s_waitcnt lgkmcnt(1)
  v_dot2c_f32_bf16 v52, s99, v40
  v_dot2c_f32_bf16 v53, s99, v41
  v_dot2c_f32_bf16 v52, s99, v42
  v_dot2c_f32_bf16 v53, s99, v43
  s_waitcnt lgkmcnt(0)
  v_dot2c_f32_bf16 v52, s99, v44
  v_dot2c_f32_bf16 v53, s99, v45
  v_dot2c_f32_bf16 v52, s99, v46
  v_dot2c_f32_bf16 v53, s99, v47
  s_waitcnt vmcnt(8)
  s_barrier
  v_add_u32 v12, s98, v8
  v_add_u32 v13, s98, v9
  v_add_u32 v14, s98, v10
  v_add_u32 v15, s98, v11
  ds_read_b128 v[16:19], v12 offset:0
  ds_read_b128 v[20:23], v13 offset:0
  ds_read_b128 v[24:27], v14 offset:0
  ds_read_b128 v[28:31], v15 offset:0
  ds_read_b128 v[32:35], v12 offset:16384
  ds_read_b128 v[36:39], v13 offset:16384
  ds_read_b128 v[40:43], v14 offset:16384
  ds_read_b128 v[44:47], v15 offset:16384
  s_add_u32 s98, s98, 32768
  s_cmp_eq_u32 s98, 131072
  s_cselect_b32 s98, 0, s98
  s_waitcnt lgkmcnt(7)
  v_dot2c_f32_bf16 v48, s99, v16
  v_dot2c_f32_bf16 v50, v16, v16
  v_dot2c_f32_bf16 v49, s99, v17
  v_dot2c_f32_bf16 v51, v17, v17
  v_dot2c_f32_bf16 v48, s99, v18
  v_dot2c_f32_bf16 v50, v18, v18
  v_dot2c_f32_bf16 v49, s99, v19
  v_dot2c_f32_bf16 v51, v19, v19
  s_waitcnt lgkmcnt(6)
  v_dot2c_f32_bf16 v48, s99, v20
  v_dot2c_f32_bf16 v50, v20, v20
  v_dot2c_f32_bf16 v49, s99, v21
  v_dot2c_f32_bf16 v51, v21, v21
  v_dot2c_f32_bf16 v48, s99, v22
  v_dot2c_f32_bf16 v50, v22, v22
  v_dot2c_f32_bf16 v49, s99, v23
  v_dot2c_f32_bf16 v51, v23, v23
  s_waitcnt lgkmcnt(5)
  v_dot2c_f32_bf16 v48, s99, v24
  v_dot2c_f32_bf16 v50, v24, v24
  v_dot2c_f32_bf16 v49, s99, v25
  v_dot2c_f32_bf16 v51, v25, v25
  v_dot2c_f32_bf16 v48, s99, v26
  v_dot2c_f32_bf16 v50, v26, v26
  v_dot2c_f32_bf16 v49, s99, v27
  v_dot2c_f32_bf16 v51, v27, v27
  s_waitcnt lgkmcnt(4)
  v_dot2c_f32_bf16 v48, s99, v28
  v_dot2c_f32_bf16 v50, v28, v28
  v_dot2c_f32_bf16 v49, s99, v29
  v_dot2c_f32_bf16 v51, v29, v29
  v_dot2c_f32_bf16 v48, s99, v30
  v_dot2c_f32_bf16 v50, v30, v30
  v_dot2c_f32_bf16 v49, s99, v31
  v_dot2c_f32_bf16 v51, v31, v31
  s_waitcnt lgkmcnt(3)
  v_dot2c_f32_bf16 v52, s99, v32
  v_dot2c_f32_bf16 v53, s99, v33
  v_dot2c_f32_bf16 v52, s99, v34
  v_dot2c_f32_bf16 v53, s99, v35
  s_waitcnt lgkmcnt(2)
  v_dot2c_f32_bf16 v52, s99, v36
  v_dot2c_f32_bf16 v53, s99, v37
  v_dot2c_f32_bf16 v52, s99, v38
  v_dot2c_f32_bf16 v53, s99, v39
  s_waitcnt lgkmcnt(1)
  v_dot2c_f32_bf16 v52, s99, v40
  v_dot2c_f32_bf16 v53, s99, v41
  v_dot2c_f32_bf16 v52, s99, v42
  v_dot2c_f32_bf16 v53, s99, v43
  s_waitcnt lgkmcnt(0)
  v_dot2c_f32_bf16 v52, s99, v44
  v_dot2c_f32_bf16 v53, s99, v45
  v_dot2c_f32_bf16 v52, s99, v46
  v_dot2c_f32_bf16 v53, s99, v47
  s_waitcnt vmcnt(0)
  s_barrier
  v_add_u32 v12, s98, v8
  v_add_u32 v13, s98, v9
  v_add_u32 v14, s98, v10
  v_add_u32 v15, s98, v11
  ds_read_b128 v[16:19], v12 offset:0
  ds_read_b128 v[20:23], v13 offset:0
  ds_read_b128 v[24:27], v14 offset:0
  ds_read_b128 v[28:31], v15 offset:0
  ds_read_b128 v[32:35], v12 offset:16384
  ds_read_b128 v[36:39], v13 offset:16384
  ds_read_b128 v[40:43], v14 offset:16384
  ds_read_b128 v[44:47], v15 offset:16384
  s_add_u32 s98, s98, 32768
  s_cmp_eq_u32 s98, 131072
  s_cselect_b32 s98, 0, s98
  s_waitcnt lgkmcnt(7)
  v_dot2c_f32_bf16 v48, s99, v16
  v_dot2c_f32_bf16 v50, v16, v16
  v_dot2c_f32_bf16 v49, s99, v17
  v_dot2c_f32_bf16 v51, v17, v17
  v_dot2c_f32_bf16 v48, s99, v18
  v_dot2c_f32_bf16 v50, v18, v18
  v_dot2c_f32_bf16 v49, s99, v19
  v_dot2c_f32_bf16 v51, v19, v19
  s_waitcnt lgkmcnt(6)
  v_dot2c_f32_bf16 v48, s99, v20
  v_dot2c_f32_bf16 v50, v20, v20
  v_dot2c_f32_bf16 v49, s99, v21
  v_dot2c_f32_bf16 v51, v21, v21
  v_dot2c_f32_bf16 v48, s99, v22
  v_dot2c_f32_bf16 v50, v22, v22
  v_dot2c_f32_bf16 v49, s99, v23
  v_dot2c_f32_bf16 v51, v23, v23
  s_waitcnt lgkmcnt(5)
  v_dot2c_f32_bf16 v48, s99, v24
  v_dot2c_f32_bf16 v50, v24, v24
  v_dot2c_f32_bf16 v49, s99, v25
  v_dot2c_f32_bf16 v51, v25, v25
  v_dot2c_f32_bf16 v48, s99, v26
  v_dot2c_f32_bf16 v50, v26, v26
  v_dot2c_f32_bf16 v49, s99, v27
  v_dot2c_f32_bf16 v51, v27, v27
  s_waitcnt lgkmcnt(4)
  v_dot2c_f32_bf16 v48, s99, v28
  v_dot2c_f32_bf16 v50, v28, v28
  v_dot2c_f32_bf16 v49, s99, v29
  v_dot2c_f32_bf16 v51, v29, v29
  v_dot2c_f32_bf16 v48, s99, v30
  v_dot2c_f32_bf16 v50, v30, v30
  v_dot2c_f32_bf16 v49, s99, v31
  v_dot2c_f32_bf16 v51, v31, v31
  s_waitcnt lgkmcnt(3)
  v_dot2c_f32_bf16 v52, s99, v32
  v_dot2c_f32_bf16 v53, s99, v33
  v_dot2c_f32_bf16 v52, s99, v34
  v_dot2c_f32_bf16 v53, s99, v35
  s_waitcnt lgkmcnt(2)
  v_dot2c_f32_bf16 v52, s99, v36
  v_dot2c_f32_bf16 v53, s99, v37
  v_dot2c_f32_bf16 v52, s99, v38
  v_dot2c_f32_bf16 v53, s99, v39
  s_waitcnt lgkmcnt(1)
  v_dot2c_f32_bf16 v52, s99, v40
  v_dot2c_f32_bf16 v53, s99, v41
  v_dot2c_f32_bf16 v52, s99, v42
  v_dot2c_f32_bf16 v53, s99, v43
  s_waitcnt lgkmcnt(0)
  v_dot2c_f32_bf16 v52, s99, v44
  v_dot2c_f32_bf16 v53, s99, v45
  v_dot2c_f32_bf16 v52, s99, v46
  v_dot2c_f32_bf16 v53, s99, v47
  s_cmp_ge_u32 s13, 8
  s_cselect_b32 s56, 3212836864, 1065353216
  s_nop 3
  v_add_f32 v48, v48, v49
  v_add_f32 v50, v50, v51
  v_add_f32 v52, v52, v53
  v_add_f32_dpp v48, v48, v48 quad_perm:[1,0,3,2] row_mask:0xf bank_mask:0xf
  v_add_f32_dpp v50, v50, v50 quad_perm:[1,0,3,2] row_mask:0xf bank_mask:0xf
  v_add_f32_dpp v52, v52, v52 quad_perm:[1,0,3,2] row_mask:0xf bank_mask:0xf
  v_mul_f32 v48, 981467136, v48
  v_mul_f32 v50, 981467136, v50
  v_fma_f32 v50, -v48, v48, v50
  v_max_f32 v50, 0, v50
  v_add_f32 v50, 925353388, v50
  v_rsq_f32 v50, v50
  v_lshrrev_b32 v12, 1, v0
  v_lshlrev_b32 v12, 2, v12
  s_lshl_b32 s3, s24, 7
  v_add_u32 v12, s3, v12
  v_add_u32 v13, 131072, v12
  v_mul_f32 v50, s56, v50
  v_mul_f32 v48, v48, v50
  v_sub_f32 v48, 0, v48
  ds_write_b32 v13, v50
  ds_write_b32 v13, v48 offset:512
  ds_write_b32 v13, v52 offset:1024
  s_waitcnt lgkmcnt(0)
  s_barrier
  s_cmp_lg_u32 s12, 0
  s_cbranch_scc1 g1_kernel_nohs4
  s_lshl_b32 s3, s13, 9
  buffer_store_dword v52, v12, s[32:35], s3 offen sc0 sc1
g1_kernel_nohs4:
  s_endpgm
g1_kernel_aux:
  s_sub_u32 s24, s14, 8
  s_lshl_b32 s91, s24, 8
  s_add_u32 s91, s91, s2
  s_add_u32 s91, s91, 0
  s_add_u32 s91, s2, 0
  s_cmp_ge_u32 s91, 256
  s_cbranch_scc1 g1_kernel_end
  s_load_dwordx2 s[60:61], s[0:1], 48
  s_lshr_b32 s72, s2, 4
  s_and_b32 s73, s2, 15
  v_mov_b32 v4, v0
  v_mul_u32_u24 v4, 2341, v4
  v_lshrrev_b32 v4, 16, v4
  v_mul_u32_u24 v4, 7168, v4
  v_mov_b32 v44, v0
  v_mov_b32 v45, v0
  v_mul_u32_u24 v45, 2341, v45
  v_lshrrev_b32 v45, 16, v45
  v_mul_u32_u24 v45, 65508, v45
  v_add_u32 v44, v44, v45
  v_and_b32 v44, 65535, v44
  v_mov_b32 v45, v0
  v_mul_u32_u24 v45, 2341, v45
  v_lshrrev_b32 v45, 16, v45
  v_lshrrev_b32 v45, 3, v45
  v_and_b32 v45, 1, v45
  v_lshlrev_b32 v45, 1, v45
  v_xor_b32 v44, v44, v45
  v_lshlrev_b32 v44, 4, v44
  v_add_u32 v4, v4, v44
  v_mov_b32 v44, v0
  v_mov_b32 v45, v0
  v_mul_u32_u24 v45, 2341, v45
  v_lshrrev_b32 v45, 16, v45
  v_mul_u32_u24 v45, 65508, v45
  v_add_u32 v44, v44, v45
  v_and_b32 v44, 65535, v44
  v_mov_b32 v45, v0
  v_mul_u32_u24 v45, 2341, v45
  v_lshrrev_b32 v45, 16, v45
  v_lshrrev_b32 v45, 3, v45
  v_and_b32 v45, 1, v45
  v_lshlrev_b32 v45, 1, v45
  v_xor_b32 v44, v44, v45
  v_add_u32 v44, 2, v44
  v_lshrrev_b32 v44, 4, v44
  v_xor_b32 v44, 1, v44
  v_mul_u32_u24 v44, 3808, v44
  v_add_u32 v4, v4, v44
  v_add_u32 v4, 4294967072, v4
  v_add_u32 v5, 64, v0
  v_mul_u32_u24 v5, 2341, v5
  v_lshrrev_b32 v5, 16, v5
  v_mul_u32_u24 v5, 7168, v5
  v_add_u32 v44, 64, v0
  v_add_u32 v45, 64, v0
  v_mul_u32_u24 v45, 2341, v45
  v_lshrrev_b32 v45, 16, v45
  v_mul_u32_u24 v45, 65508, v45
  v_add_u32 v44, v44, v45
  v_and_b32 v44, 65535, v44
  v_add_u32 v45, 64, v0
  v_mul_u32_u24 v45, 2341, v45
  v_lshrrev_b32 v45, 16, v45
  v_lshrrev_b32 v45, 3, v45
  v_and_b32 v45, 1, v45
  v_lshlrev_b32 v45, 1, v45
  v_xor_b32 v44, v44, v45
  v_lshlrev_b32 v44, 4, v44
  v_add_u32 v5, v5, v44
  v_add_u32 v44, 64, v0
  v_add_u32 v45, 64, v0
  v_mul_u32_u24 v45, 2341, v45
  v_lshrrev_b32 v45, 16, v45
  v_mul_u32_u24 v45, 65508, v45
  v_add_u32 v44, v44, v45
  v_and_b32 v44, 65535, v44
  v_add_u32 v45, 64, v0
  v_mul_u32_u24 v45, 2341, v45
  v_lshrrev_b32 v45, 16, v45
  v_lshrrev_b32 v45, 3, v45
  v_and_b32 v45, 1, v45
  v_lshlrev_b32 v45, 1, v45
  v_xor_b32 v44, v44, v45
  v_add_u32 v44, 2, v44
  v_lshrrev_b32 v44, 4, v44
  v_xor_b32 v44, 1, v44
  v_mul_u32_u24 v44, 3808, v44
  v_add_u32 v5, v5, v44
  v_add_u32 v5, 4294967072, v5
  v_add_u32 v6, 128, v0
  v_mul_u32_u24 v6, 2341, v6
  v_lshrrev_b32 v6, 16, v6
  v_mul_u32_u24 v6, 7168, v6
  v_add_u32 v44, 128, v0
  v_add_u32 v45, 128, v0
  v_mul_u32_u24 v45, 2341, v45
  v_lshrrev_b32 v45, 16, v45
  v_mul_u32_u24 v45, 65508, v45
  v_add_u32 v44, v44, v45
  v_and_b32 v44, 65535, v44
  v_add_u32 v45, 128, v0
  v_mul_u32_u24 v45, 2341, v45
  v_lshrrev_b32 v45, 16, v45
  v_lshrrev_b32 v45, 3, v45
  v_and_b32 v45, 1, v45
  v_lshlrev_b32 v45, 1, v45
  v_xor_b32 v44, v44, v45
  v_lshlrev_b32 v44, 4, v44
  v_add_u32 v6, v6, v44
  v_add_u32 v44, 128, v0
  v_add_u32 v45, 128, v0
  v_mul_u32_u24 v45, 2341, v45
  v_lshrrev_b32 v45, 16, v45
  v_mul_u32_u24 v45, 65508, v45
  v_add_u32 v44, v44, v45
  v_and_b32 v44, 65535, v44
  v_add_u32 v45, 128, v0
  v_mul_u32_u24 v45, 2341, v45
  v_lshrrev_b32 v45, 16, v45
  v_lshrrev_b32 v45, 3, v45
  v_and_b32 v45, 1, v45
  v_lshlrev_b32 v45, 1, v45
  v_xor_b32 v44, v44, v45
  v_add_u32 v44, 2, v44
  v_lshrrev_b32 v44, 4, v44
  v_xor_b32 v44, 1, v44
  v_mul_u32_u24 v44, 3808, v44
  v_add_u32 v6, v6, v44
  v_add_u32 v6, 4294967072, v6
  v_add_u32 v7, 192, v0
  v_mul_u32_u24 v7, 2341, v7
  v_lshrrev_b32 v7, 16, v7
  v_mul_u32_u24 v7, 7168, v7
  v_add_u32 v44, 192, v0
  v_add_u32 v45, 192, v0
  v_mul_u32_u24 v45, 2341, v45
  v_lshrrev_b32 v45, 16, v45
  v_mul_u32_u24 v45, 65508, v45
  v_add_u32 v44, v44, v45
  v_and_b32 v44, 65535, v44
  v_add_u32 v45, 192, v0
  v_mul_u32_u24 v45, 2341, v45
  v_lshrrev_b32 v45, 16, v45
  v_lshrrev_b32 v45, 3, v45
  v_and_b32 v45, 1, v45
  v_lshlrev_b32 v45, 1, v45
  v_xor_b32 v44, v44, v45
  v_lshlrev_b32 v44, 4, v44
  v_add_u32 v7, v7, v44
  v_add_u32 v44, 192, v0
  v_add_u32 v45, 192, v0
  v_mul_u32_u24 v45, 2341, v45
  v_lshrrev_b32 v45, 16, v45
  v_mul_u32_u24 v45, 65508, v45
  v_add_u32 v44, v44, v45
  v_and_b32 v44, 65535, v44
  v_add_u32 v45, 192, v0
  v_mul_u32_u24 v45, 2341, v45
  v_lshrrev_b32 v45, 16, v45
  v_lshrrev_b32 v45, 3, v45
  v_and_b32 v45, 1, v45
  v_lshlrev_b32 v45, 1, v45
  v_xor_b32 v44, v44, v45
  v_add_u32 v44, 2, v44
  v_lshrrev_b32 v44, 4, v44
  v_xor_b32 v44, 1, v44
  v_mul_u32_u24 v44, 3808, v44
  v_add_u32 v7, v7, v44
  v_add_u32 v7, 4294967072, v7
  v_add_u32 v8, 256, v0
  v_mul_u32_u24 v8, 2341, v8
  v_lshrrev_b32 v8, 16, v8
  v_mul_u32_u24 v8, 7168, v8
  v_add_u32 v44, 256, v0
  v_add_u32 v45, 256, v0
  v_mul_u32_u24 v45, 2341, v45
  v_lshrrev_b32 v45, 16, v45
  v_mul_u32_u24 v45, 65508, v45
  v_add_u32 v44, v44, v45
  v_and_b32 v44, 65535, v44
  v_add_u32 v45, 256, v0
  v_mul_u32_u24 v45, 2341, v45
  v_lshrrev_b32 v45, 16, v45
  v_lshrrev_b32 v45, 3, v45
  v_and_b32 v45, 1, v45
  v_lshlrev_b32 v45, 1, v45
  v_xor_b32 v44, v44, v45
  v_lshlrev_b32 v44, 4, v44
  v_add_u32 v8, v8, v44
  v_add_u32 v44, 256, v0
  v_add_u32 v45, 256, v0
  v_mul_u32_u24 v45, 2341, v45
  v_lshrrev_b32 v45, 16, v45
  v_mul_u32_u24 v45, 65508, v45
  v_add_u32 v44, v44, v45
  v_and_b32 v44, 65535, v44
  v_add_u32 v45, 256, v0
  v_mul_u32_u24 v45, 2341, v45
  v_lshrrev_b32 v45, 16, v45
  v_lshrrev_b32 v45, 3, v45
  v_and_b32 v45, 1, v45
  v_lshlrev_b32 v45, 1, v45
  v_xor_b32 v44, v44, v45
  v_add_u32 v44, 2, v44
  v_lshrrev_b32 v44, 4, v44
  v_xor_b32 v44, 1, v44
  v_mul_u32_u24 v44, 3808, v44
  v_add_u32 v8, v8, v44
  v_add_u32 v8, 4294967072, v8
  v_add_u32 v9, 320, v0
  v_mul_u32_u24 v9, 2341, v9
  v_lshrrev_b32 v9, 16, v9
  v_mul_u32_u24 v9, 7168, v9
  v_add_u32 v44, 320, v0
  v_add_u32 v45, 320, v0
  v_mul_u32_u24 v45, 2341, v45
  v_lshrrev_b32 v45, 16, v45
  v_mul_u32_u24 v45, 65508, v45
  v_add_u32 v44, v44, v45
  v_and_b32 v44, 65535, v44
  v_add_u32 v45, 320, v0
  v_mul_u32_u24 v45, 2341, v45
  v_lshrrev_b32 v45, 16, v45
  v_lshrrev_b32 v45, 3, v45
  v_and_b32 v45, 1, v45
  v_lshlrev_b32 v45, 1, v45
  v_xor_b32 v44, v44, v45
  v_lshlrev_b32 v44, 4, v44
  v_add_u32 v9, v9, v44
  v_add_u32 v44, 320, v0
  v_add_u32 v45, 320, v0
  v_mul_u32_u24 v45, 2341, v45
  v_lshrrev_b32 v45, 16, v45
  v_mul_u32_u24 v45, 65508, v45
  v_add_u32 v44, v44, v45
  v_and_b32 v44, 65535, v44
  v_add_u32 v45, 320, v0
  v_mul_u32_u24 v45, 2341, v45
  v_lshrrev_b32 v45, 16, v45
  v_lshrrev_b32 v45, 3, v45
  v_and_b32 v45, 1, v45
  v_lshlrev_b32 v45, 1, v45
  v_xor_b32 v44, v44, v45
  v_add_u32 v44, 2, v44
  v_lshrrev_b32 v44, 4, v44
  v_xor_b32 v44, 1, v44
  v_mul_u32_u24 v44, 3808, v44
  v_add_u32 v9, v9, v44
  v_add_u32 v9, 4294967072, v9
  v_add_u32 v10, 384, v0
  v_mul_u32_u24 v10, 2341, v10
  v_lshrrev_b32 v10, 16, v10
  v_mul_u32_u24 v10, 7168, v10
  v_add_u32 v44, 384, v0
  v_add_u32 v45, 384, v0
  v_mul_u32_u24 v45, 2341, v45
  v_lshrrev_b32 v45, 16, v45
  v_mul_u32_u24 v45, 65508, v45
  v_add_u32 v44, v44, v45
  v_and_b32 v44, 65535, v44
  v_add_u32 v45, 384, v0
  v_mul_u32_u24 v45, 2341, v45
  v_lshrrev_b32 v45, 16, v45
  v_lshrrev_b32 v45, 3, v45
  v_and_b32 v45, 1, v45
  v_lshlrev_b32 v45, 1, v45
  v_xor_b32 v44, v44, v45
  v_lshlrev_b32 v44, 4, v44
  v_add_u32 v10, v10, v44
  v_add_u32 v44, 384, v0
  v_add_u32 v45, 384, v0
  v_mul_u32_u24 v45, 2341, v45
  v_lshrrev_b32 v45, 16, v45
  v_mul_u32_u24 v45, 65508, v45
  v_add_u32 v44, v44, v45
  v_and_b32 v44, 65535, v44
  v_add_u32 v45, 384, v0
  v_mul_u32_u24 v45, 2341, v45
  v_lshrrev_b32 v45, 16, v45
  v_lshrrev_b32 v45, 3, v45
  v_and_b32 v45, 1, v45
  v_lshlrev_b32 v45, 1, v45
  v_xor_b32 v44, v44, v45
  v_add_u32 v44, 2, v44
  v_lshrrev_b32 v44, 4, v44
  v_xor_b32 v44, 1, v44
  v_mul_u32_u24 v44, 3808, v44
  v_add_u32 v10, v10, v44
  v_add_u32 v10, 4294967072, v10
  s_mul_i32 s74, s73, 458752
  s_mul_i32 s75, s24, 114688
  s_add_u32 s74, s74, s75
  s_mul_i32 s75, s72, 224
  s_add_u32 s74, s74, s75
  v_add_u32 v4, s74, v4
  v_add_u32 v5, s74, v5
  v_add_u32 v6, s74, v6
  v_add_u32 v7, s74, v7
  v_add_u32 v8, s74, v8
  v_add_u32 v9, s74, v9
  v_add_u32 v10, s74, v10
  s_mul_i32 s75, s24, 7168
  s_waitcnt lgkmcnt(0)
  s_mov_b32 s62, 7340032
  s_mov_b32 s63, 0x20000
  s_load_dwordx2 s[64:65], s[0:1], 96
  s_load_dwordx2 s[68:69], s[0:1], 96
  s_lshr_b32 s72, s2, 4
  s_and_b32 s73, s2, 15
  s_mul_i32 s75, s24, 7168
  s_mov_b32 s77, 0xffff0000
  s_waitcnt lgkmcnt(0)
  s_add_u32 s64, s64, 46137344
  s_addc_u32 s65, s65, 0
  s_mov_b32 s66, 7340032
  s_mov_b32 s67, 0x20000
  s_add_u32 s68, s68, 45088768
  s_addc_u32 s69, s69, 0
  s_mov_b32 s70, 229376
  s_mov_b32 s71, 0x20000
  s_lshr_b32 s3, s2, 3
  s_mul_i32 s3, s3, 1
  s_mul_i32 s19, s24, 0
  s_add_u32 s3, s3, s19
  s_and_b32 s3, s3, 3
  s_add_u32 s16, s3, 2
g1_kernel_axl5:
  s_cmp_eq_u32 s16, 0
  s_cbranch_scc1 g1_kernel_axe6
  s_barrier
  s_sub_u32 s16, s16, 1
  s_branch g1_kernel_axl5
g1_kernel_axe6:
  s_add_u32 m0, s75, 132608
  s_nop 0
  buffer_load_dwordx4 v4, s[60:63], 0 offen lds
  s_add_u32 m0, s75, 133632
  s_nop 0
  buffer_load_dwordx4 v5, s[60:63], 0 offen lds
  s_add_u32 m0, s75, 134656
  s_nop 0
  buffer_load_dwordx4 v6, s[60:63], 0 offen lds
  s_add_u32 m0, s75, 135680
  s_nop 0
  buffer_load_dwordx4 v7, s[60:63], 0 offen lds
  s_add_u32 m0, s75, 136704
  s_nop 0
  buffer_load_dwordx4 v8, s[60:63], 0 offen lds
  s_add_u32 m0, s75, 137728
  s_nop 0
  buffer_load_dwordx4 v9, s[60:63], 0 offen lds
  s_add_u32 m0, s75, 138752
  s_nop 0
  buffer_load_dwordx4 v10, s[60:63], 0 offen lds
  s_barrier
  s_barrier
  s_barrier
  s_barrier
  s_barrier
  s_barrier
  s_barrier
  s_barrier
  s_barrier
  s_waitcnt vmcnt(0)
  v_lshlrev_b32 v44, 4, v0
  s_add_u32 s74, s75, 132608
  v_add_u32 v45, s74, v44
  s_mul_i32 s74, s2, 28672
  s_add_u32 s74, s74, s75
  ds_read_b128 v[4:7], v45 offset:0
  ds_read_b128 v[8:11], v45 offset:1024
  ds_read_b128 v[12:15], v45 offset:2048
  ds_read_b128 v[16:19], v45 offset:3072
  ds_read_b128 v[20:23], v45 offset:4096
  ds_read_b128 v[24:27], v45 offset:5120
  ds_read_b128 v[28:31], v45 offset:6144
  s_waitcnt lgkmcnt(6)
  buffer_store_dwordx4 v[4:7], v44, s[64:67], s74 offen offset:0 sc0 sc1
  s_waitcnt lgkmcnt(5)
  buffer_store_dwordx4 v[8:11], v44, s[64:67], s74 offen offset:1024 sc0 sc1
  s_waitcnt lgkmcnt(4)
  buffer_store_dwordx4 v[12:15], v44, s[64:67], s74 offen offset:2048 sc0 sc1
  s_waitcnt lgkmcnt(3)
  buffer_store_dwordx4 v[16:19], v44, s[64:67], s74 offen offset:3072 sc0 sc1
  s_waitcnt lgkmcnt(2)
  s_add_u32 s74, s74, 4096
  buffer_store_dwordx4 v[20:23], v44, s[64:67], s74 offen offset:0 sc0 sc1
  s_waitcnt lgkmcnt(1)
  buffer_store_dwordx4 v[24:27], v44, s[64:67], s74 offen offset:1024 sc0 sc1
  s_waitcnt lgkmcnt(0)
  buffer_store_dwordx4 v[28:31], v44, s[64:67], s74 offen offset:2048 sc0 sc1
  s_barrier
  v_lshrrev_b32 v44, 3, v0
  v_min_u32 v44, 6, v44
  s_mul_i32 s74, s24, 7
  v_add_u32 v44, s74, v44
  v_and_b32 v45, 7, v0
  v_mul_u32_u24 v45, 448, v45
  v_add_u32 v45, 132608, v45
  v_lshlrev_b32 v48, 4, v44
  v_xor_b32 v49, 32, v48
  v_add_u32 v48, v48, v45
  v_add_u32 v49, v49, v45
  ds_read_b128 v[52:55], v48 offset:0
  ds_read_b128 v[56:59], v49 offset:3584
  ds_read_b128 v[60:63], v48 offset:7168
  ds_read_b128 v[64:67], v49 offset:10752
  ds_read_b128 v[68:71], v48 offset:14336
  ds_read_b128 v[72:75], v49 offset:17920
  ds_read_b128 v[76:79], v48 offset:21504
  ds_read_b128 v[80:83], v49 offset:25088
  v_lshlrev_b32 v48, 5, v44
  v_and_b32 v45, 1, v0
  v_lshlrev_b32 v45, 4, v45
  v_add_u32 v48, v48, v45
  s_cmp_lt_u32 s24, 2
  s_cselect_b32 s74, 7616, 0
  s_mul_i32 s75, s73, 14336
  s_add_u32 s74, s74, s75
  s_mul_i32 s75, s72, 448
  s_add_u32 s74, s74, s75
  v_add_u32 v48, s74, v48
  v_subrev_u32 v48, 448, v48
  v_cmp_eq_u32 vcc, 0, v45
  s_waitcnt lgkmcnt(7)
  v_lshlrev_b32 v44, 16, v52
  v_and_b32 v45, s77, v52
  v_mov_b32 v36, v44
  v_mov_b32 v37, v45
  v_lshlrev_b32 v46, 16, v53
  v_and_b32 v47, s77, v53
  v_mov_b32 v38, v46
  v_mov_b32 v39, v47
  v_lshlrev_b32 v44, 16, v54
  v_and_b32 v45, s77, v54
  v_mov_b32 v40, v44
  v_mov_b32 v41, v45
  v_lshlrev_b32 v46, 16, v55
  v_and_b32 v47, s77, v55
  v_mov_b32 v42, v46
  v_mov_b32 v43, v47
  s_waitcnt lgkmcnt(6)
  v_lshlrev_b32 v44, 16, v56
  v_and_b32 v45, s77, v56
  v_pk_add_f32 v[36:37], v[36:37], v[44:45] op_sel:[0,0] op_sel_hi:[1,1]
  v_lshlrev_b32 v46, 16, v57
  v_and_b32 v47, s77, v57
  v_pk_add_f32 v[38:39], v[38:39], v[46:47] op_sel:[0,0] op_sel_hi:[1,1]
  v_lshlrev_b32 v44, 16, v58
  v_and_b32 v45, s77, v58
  v_pk_add_f32 v[40:41], v[40:41], v[44:45] op_sel:[0,0] op_sel_hi:[1,1]
  v_lshlrev_b32 v46, 16, v59
  v_and_b32 v47, s77, v59
  v_pk_add_f32 v[42:43], v[42:43], v[46:47] op_sel:[0,0] op_sel_hi:[1,1]
  s_waitcnt lgkmcnt(5)
  v_lshlrev_b32 v44, 16, v60
  v_and_b32 v45, s77, v60
  v_pk_add_f32 v[36:37], v[36:37], v[44:45] op_sel:[0,0] op_sel_hi:[1,1]
  v_lshlrev_b32 v46, 16, v61
  v_and_b32 v47, s77, v61
  v_pk_add_f32 v[38:39], v[38:39], v[46:47] op_sel:[0,0] op_sel_hi:[1,1]
  v_lshlrev_b32 v44, 16, v62
  v_and_b32 v45, s77, v62
  v_pk_add_f32 v[40:41], v[40:41], v[44:45] op_sel:[0,0] op_sel_hi:[1,1]
  v_lshlrev_b32 v46, 16, v63
  v_and_b32 v47, s77, v63
  v_pk_add_f32 v[42:43], v[42:43], v[46:47] op_sel:[0,0] op_sel_hi:[1,1]
  s_waitcnt lgkmcnt(4)
  v_lshlrev_b32 v44, 16, v64
  v_and_b32 v45, s77, v64
  v_pk_add_f32 v[36:37], v[36:37], v[44:45] op_sel:[0,0] op_sel_hi:[1,1]
  v_lshlrev_b32 v46, 16, v65
  v_and_b32 v47, s77, v65
  v_pk_add_f32 v[38:39], v[38:39], v[46:47] op_sel:[0,0] op_sel_hi:[1,1]
  v_lshlrev_b32 v44, 16, v66
  v_and_b32 v45, s77, v66
  v_pk_add_f32 v[40:41], v[40:41], v[44:45] op_sel:[0,0] op_sel_hi:[1,1]
  v_lshlrev_b32 v46, 16, v67
  v_and_b32 v47, s77, v67
  v_pk_add_f32 v[42:43], v[42:43], v[46:47] op_sel:[0,0] op_sel_hi:[1,1]
  s_waitcnt lgkmcnt(3)
  v_lshlrev_b32 v44, 16, v68
  v_and_b32 v45, s77, v68
  v_pk_add_f32 v[36:37], v[36:37], v[44:45] op_sel:[0,0] op_sel_hi:[1,1]
  v_lshlrev_b32 v46, 16, v69
  v_and_b32 v47, s77, v69
  v_pk_add_f32 v[38:39], v[38:39], v[46:47] op_sel:[0,0] op_sel_hi:[1,1]
  v_lshlrev_b32 v44, 16, v70
  v_and_b32 v45, s77, v70
  v_pk_add_f32 v[40:41], v[40:41], v[44:45] op_sel:[0,0] op_sel_hi:[1,1]
  v_lshlrev_b32 v46, 16, v71
  v_and_b32 v47, s77, v71
  v_pk_add_f32 v[42:43], v[42:43], v[46:47] op_sel:[0,0] op_sel_hi:[1,1]
  s_waitcnt lgkmcnt(2)
  v_lshlrev_b32 v44, 16, v72
  v_and_b32 v45, s77, v72
  v_pk_add_f32 v[36:37], v[36:37], v[44:45] op_sel:[0,0] op_sel_hi:[1,1]
  v_lshlrev_b32 v46, 16, v73
  v_and_b32 v47, s77, v73
  v_pk_add_f32 v[38:39], v[38:39], v[46:47] op_sel:[0,0] op_sel_hi:[1,1]
  v_lshlrev_b32 v44, 16, v74
  v_and_b32 v45, s77, v74
  v_pk_add_f32 v[40:41], v[40:41], v[44:45] op_sel:[0,0] op_sel_hi:[1,1]
  v_lshlrev_b32 v46, 16, v75
  v_and_b32 v47, s77, v75
  v_pk_add_f32 v[42:43], v[42:43], v[46:47] op_sel:[0,0] op_sel_hi:[1,1]
  s_waitcnt lgkmcnt(1)
  v_lshlrev_b32 v44, 16, v76
  v_and_b32 v45, s77, v76
  v_pk_add_f32 v[36:37], v[36:37], v[44:45] op_sel:[0,0] op_sel_hi:[1,1]
  v_lshlrev_b32 v46, 16, v77
  v_and_b32 v47, s77, v77
  v_pk_add_f32 v[38:39], v[38:39], v[46:47] op_sel:[0,0] op_sel_hi:[1,1]
  v_lshlrev_b32 v44, 16, v78
  v_and_b32 v45, s77, v78
  v_pk_add_f32 v[40:41], v[40:41], v[44:45] op_sel:[0,0] op_sel_hi:[1,1]
  v_lshlrev_b32 v46, 16, v79
  v_and_b32 v47, s77, v79
  v_pk_add_f32 v[42:43], v[42:43], v[46:47] op_sel:[0,0] op_sel_hi:[1,1]
  s_waitcnt lgkmcnt(0)
  v_lshlrev_b32 v44, 16, v80
  v_and_b32 v45, s77, v80
  v_pk_add_f32 v[36:37], v[36:37], v[44:45] op_sel:[0,0] op_sel_hi:[1,1]
  v_lshlrev_b32 v46, 16, v81
  v_and_b32 v47, s77, v81
  v_pk_add_f32 v[38:39], v[38:39], v[46:47] op_sel:[0,0] op_sel_hi:[1,1]
  v_lshlrev_b32 v44, 16, v82
  v_and_b32 v45, s77, v82
  v_pk_add_f32 v[40:41], v[40:41], v[44:45] op_sel:[0,0] op_sel_hi:[1,1]
  v_lshlrev_b32 v46, 16, v83
  v_and_b32 v47, s77, v83
  v_pk_add_f32 v[42:43], v[42:43], v[46:47] op_sel:[0,0] op_sel_hi:[1,1]
  v_add_f32_dpp v36, v36, v36 quad_perm:[1,0,3,2] row_mask:0xf bank_mask:0xf
  v_add_f32_dpp v37, v37, v37 quad_perm:[1,0,3,2] row_mask:0xf bank_mask:0xf
  v_add_f32_dpp v38, v38, v38 quad_perm:[1,0,3,2] row_mask:0xf bank_mask:0xf
  v_add_f32_dpp v39, v39, v39 quad_perm:[1,0,3,2] row_mask:0xf bank_mask:0xf
  v_add_f32_dpp v40, v40, v40 quad_perm:[1,0,3,2] row_mask:0xf bank_mask:0xf
  v_add_f32_dpp v41, v41, v41 quad_perm:[1,0,3,2] row_mask:0xf bank_mask:0xf
  v_add_f32_dpp v42, v42, v42 quad_perm:[1,0,3,2] row_mask:0xf bank_mask:0xf
  v_add_f32_dpp v43, v43, v43 quad_perm:[1,0,3,2] row_mask:0xf bank_mask:0xf
  v_add_f32_dpp v36, v36, v36 quad_perm:[2,3,0,1] row_mask:0xf bank_mask:0xf
  v_add_f32_dpp v37, v37, v37 quad_perm:[2,3,0,1] row_mask:0xf bank_mask:0xf
  v_add_f32_dpp v38, v38, v38 quad_perm:[2,3,0,1] row_mask:0xf bank_mask:0xf
  v_add_f32_dpp v39, v39, v39 quad_perm:[2,3,0,1] row_mask:0xf bank_mask:0xf
  v_add_f32_dpp v40, v40, v40 quad_perm:[2,3,0,1] row_mask:0xf bank_mask:0xf
  v_add_f32_dpp v41, v41, v41 quad_perm:[2,3,0,1] row_mask:0xf bank_mask:0xf
  v_add_f32_dpp v42, v42, v42 quad_perm:[2,3,0,1] row_mask:0xf bank_mask:0xf
  v_add_f32_dpp v43, v43, v43 quad_perm:[2,3,0,1] row_mask:0xf bank_mask:0xf
  v_add_f32_dpp v36, v36, v36 row_half_mirror row_mask:0xf bank_mask:0xf
  v_add_f32_dpp v37, v37, v37 row_half_mirror row_mask:0xf bank_mask:0xf
  v_add_f32_dpp v38, v38, v38 row_half_mirror row_mask:0xf bank_mask:0xf
  v_add_f32_dpp v39, v39, v39 row_half_mirror row_mask:0xf bank_mask:0xf
  v_add_f32_dpp v40, v40, v40 row_half_mirror row_mask:0xf bank_mask:0xf
  v_add_f32_dpp v41, v41, v41 row_half_mirror row_mask:0xf bank_mask:0xf
  v_add_f32_dpp v42, v42, v42 row_half_mirror row_mask:0xf bank_mask:0xf
  v_add_f32_dpp v43, v43, v43 row_half_mirror row_mask:0xf bank_mask:0xf
  v_cndmask_b32 v36, v40, v36, vcc
  v_cndmask_b32 v37, v41, v37, vcc
  v_cndmask_b32 v38, v42, v38, vcc
  v_cndmask_b32 v39, v43, v39, vcc
  buffer_store_dwordx4 v[36:39], v48, s[68:71], 0 offen sc0 sc1
  s_endpgm
g1_kernel_comp:
  s_load_dwordx2 s[28:29], s[0:1], 96
  s_load_dwordx2 s[68:69], s[0:1], 96
  s_load_dwordx2 s[64:65], s[0:1], 96
  s_and_b32 s24, s14, 1
  s_lshr_b32 s25, s14, 1
  v_and_b32 v6, 15, v0
  v_and_b32 v2, 15, v0
  v_and_b32 v2, 12, v2
  v_add_u32 v6, v6, v2
  v_lshlrev_b32 v6, 7, v6
  v_lshrrev_b32 v2, 4, v0
  v_and_b32 v3, 15, v0
  v_and_b32 v4, 15, v0
  v_and_b32 v4, 12, v4
  v_add_u32 v3, v3, v4
  v_lshrrev_b32 v3, 1, v3
  v_and_b32 v3, 1, v3
  v_and_b32 v4, 15, v0
  v_and_b32 v5, 15, v0
  v_and_b32 v5, 12, v5
  v_add_u32 v4, v4, v5
  v_lshrrev_b32 v4, 2, v4
  v_and_b32 v4, 6, v4
  v_add_u32 v3, v3, v4
  v_xor_b32 v2, v2, v3
  v_and_b32 v2, 7, v2
  v_lshlrev_b32 v2, 4, v2
  v_add_u32 v6, v6, v2
  s_mul_i32 s3, s24, 8192
  v_add_u32 v6, s3, v6
  v_mov_b32 v7, v6
  v_and_b32 v8, 15, v0
  v_and_b32 v2, 15, v0
  v_and_b32 v2, 12, v2
  v_add_u32 v8, v8, v2
  v_lshlrev_b32 v8, 7, v8
  v_lshrrev_b32 v2, 4, v0
  v_xor_b32 v2, 4, v2
  v_and_b32 v3, 15, v0
  v_and_b32 v4, 15, v0
  v_and_b32 v4, 12, v4
  v_add_u32 v3, v3, v4
  v_lshrrev_b32 v3, 1, v3
  v_and_b32 v3, 1, v3
  v_and_b32 v4, 15, v0
  v_and_b32 v5, 15, v0
  v_and_b32 v5, 12, v5
  v_add_u32 v4, v4, v5
  v_lshrrev_b32 v4, 2, v4
  v_and_b32 v4, 6, v4
  v_add_u32 v3, v3, v4
  v_xor_b32 v2, v2, v3
  v_and_b32 v2, 7, v2
  v_lshlrev_b32 v2, 4, v2
  v_add_u32 v8, v8, v2
  s_mul_i32 s3, s24, 8192
  v_add_u32 v8, s3, v8
  v_mov_b32 v9, v8
  v_and_b32 v10, 15, v0
  v_and_b32 v2, 15, v0
  v_and_b32 v2, 12, v2
  v_add_u32 v10, v10, v2
  v_lshlrev_b32 v10, 7, v10
  v_lshrrev_b32 v2, 4, v0
  v_and_b32 v3, 15, v0
  v_and_b32 v4, 15, v0
  v_and_b32 v4, 12, v4
  v_add_u32 v3, v3, v4
  v_lshrrev_b32 v3, 1, v3
  v_and_b32 v3, 1, v3
  v_and_b32 v4, 15, v0
  v_and_b32 v5, 15, v0
  v_and_b32 v5, 12, v5
  v_add_u32 v4, v4, v5
  v_lshrrev_b32 v4, 2, v4
  v_and_b32 v4, 6, v4
  v_add_u32 v3, v3, v4
  v_xor_b32 v2, v2, v3
  v_and_b32 v2, 7, v2
  v_lshlrev_b32 v2, 4, v2
  v_add_u32 v10, v10, v2
  s_mul_i32 s3, s25, 8192
  s_add_u32 s3, s3, 16384
  v_add_u32 v10, s3, v10
  v_mov_b32 v11, v10
  v_and_b32 v12, 15, v0
  v_and_b32 v2, 15, v0
  v_and_b32 v2, 12, v2
  v_add_u32 v12, v12, v2
  v_lshlrev_b32 v12, 7, v12
  v_lshrrev_b32 v2, 4, v0
  v_xor_b32 v2, 4, v2
  v_and_b32 v3, 15, v0
  v_and_b32 v4, 15, v0
  v_and_b32 v4, 12, v4
  v_add_u32 v3, v3, v4
  v_lshrrev_b32 v3, 1, v3
  v_and_b32 v3, 1, v3
  v_and_b32 v4, 15, v0
  v_and_b32 v5, 15, v0
  v_and_b32 v5, 12, v5
  v_add_u32 v4, v4, v5
  v_lshrrev_b32 v4, 2, v4
  v_and_b32 v4, 6, v4
  v_add_u32 v3, v3, v4
  v_xor_b32 v2, v2, v3
  v_and_b32 v2, 7, v2
  v_lshlrev_b32 v2, 4, v2
  v_add_u32 v12, v12, v2
  s_mul_i32 s3, s25, 8192
  s_add_u32 s3, s3, 16384
  v_add_u32 v12, s3, v12
  v_mov_b32 v13, v12
  s_waitcnt lgkmcnt(0)
  s_add_u32 s28, s28, 8388608
  s_addc_u32 s29, s29, 0
  s_cmp_eq_u32 s90, 0
  s_cselect_b32 s30, 67108864, 0
  s_add_u32 s28, s28, s30
  s_addc_u32 s29, s29, 0
  s_mov_b32 s30, 8388608
  s_mov_b32 s31, 0x20000
  s_add_u32 s68, s68, 54525952
  s_addc_u32 s69, s69, 0
  s_mov_b32 s70, 4194304
  s_mov_b32 s71, 0x20000
  s_add_u32 s64, s64, 63963136
  s_addc_u32 s65, s65, 0
  s_mov_b32 s66, 262144
  s_mov_b32 s67, 0x20000
  v_lshlrev_b32 v85, 2, v0
  v_mov_b32 v80, -1
  s_lshl_b32 s3, s2, 2
  s_add_u32 s3, s3, s14
  s_lshl_b32 s3, s3, 8
  buffer_store_dword v80, v85, s[64:67], s3 offen sc0 sc1
  s_getpc_b64 s[72:73]
cpf_here:
  s_mov_b32 s74, text_end_mark-cpf_here
  s_mov_b32 s75, 0x20000
  v_lshlrev_b32 v2, 4, v0
  s_lshr_b32 s3, s2, 3
  s_lshl_b32 s3, s3, 2
  s_add_u32 s3, s3, s14
  s_lshl_b32 s3, s3, 10
  buffer_load_dwordx4 v[156:159], v2, s[72:75], s3 offen
  s_waitcnt lgkmcnt(0)
  s_barrier
  ds_read_b128 v[80:83], v7 offset:0
  ds_read_b128 v[96:99], v11 offset:0
  ds_read_b128 v[84:87], v7 offset:512
  ds_read_b128 v[100:103], v11 offset:512
  ds_read_b128 v[88:91], v7 offset:4096
  ds_read_b128 v[104:107], v11 offset:4096
  ds_read_b128 v[92:95], v7 offset:4608
  ds_read_b128 v[108:111], v11 offset:4608
  s_waitcnt lgkmcnt(6)
  v_mfma_f32_16x16x32_bf16 v[16:19], v[80:83], v[96:99], 0
  ds_read_b128 v[112:115], v9 offset:0
  s_waitcnt lgkmcnt(5)
  v_mfma_f32_16x16x32_bf16 v[20:23], v[80:83], v[100:103], 0
  ds_read_b128 v[128:131], v13 offset:0
  v_mfma_f32_16x16x32_bf16 v[32:35], v[84:87], v[96:99], 0
  ds_read_b128 v[116:119], v9 offset:512
  v_mfma_f32_16x16x32_bf16 v[36:39], v[84:87], v[100:103], 0
  ds_read_b128 v[132:135], v13 offset:512
  s_waitcnt lgkmcnt(6)
  v_mfma_f32_16x16x32_bf16 v[24:27], v[80:83], v[104:107], 0
  ds_read_b128 v[120:123], v9 offset:4096
  v_mfma_f32_16x16x32_bf16 v[40:43], v[84:87], v[104:107], 0
  ds_read_b128 v[136:139], v13 offset:4096
  v_mfma_f32_16x16x32_bf16 v[48:51], v[88:91], v[96:99], 0
  ds_read_b128 v[124:127], v9 offset:4608
  v_mfma_f32_16x16x32_bf16 v[52:55], v[88:91], v[100:103], 0
  ds_read_b128 v[140:143], v13 offset:4608
  v_mfma_f32_16x16x32_bf16 v[56:59], v[88:91], v[104:107], 0
  s_add_u32 s15, s15, 32768
  s_cmp_ge_u32 s15, 131072
  s_cselect_b32 s3, 131072, 0
  s_sub_u32 s15, s15, s3
  s_waitcnt lgkmcnt(8)
  v_mfma_f32_16x16x32_bf16 v[28:31], v[80:83], v[108:111], 0
  v_add_u32 v7, s15, v6
  v_mfma_f32_16x16x32_bf16 v[44:47], v[84:87], v[108:111], 0
  v_add_u32 v11, s15, v10
  v_mfma_f32_16x16x32_bf16 v[60:63], v[88:91], v[108:111], 0
  v_mfma_f32_16x16x32_bf16 v[64:67], v[92:95], v[96:99], 0
  v_mfma_f32_16x16x32_bf16 v[68:71], v[92:95], v[100:103], 0
  v_mfma_f32_16x16x32_bf16 v[72:75], v[92:95], v[104:107], 0
  v_mfma_f32_16x16x32_bf16 v[76:79], v[92:95], v[108:111], 0
  s_waitcnt lgkmcnt(6)
  v_mfma_f32_16x16x32_bf16 v[16:19], v[112:115], v[128:131], v[16:19]
  v_add_u32 v9, s15, v8
  s_waitcnt lgkmcnt(4)
  v_mfma_f32_16x16x32_bf16 v[20:23], v[112:115], v[132:135], v[20:23]
  v_add_u32 v13, s15, v12
  s_waitcnt lgkmcnt(0)
  s_barrier
  v_mfma_f32_16x16x32_bf16 v[32:35], v[116:119], v[128:131], v[32:35]
  ds_read_b128 v[80:83], v7 offset:0
  v_mfma_f32_16x16x32_bf16 v[36:39], v[116:119], v[132:135], v[36:39]
  ds_read_b128 v[96:99], v11 offset:0
  v_mfma_f32_16x16x32_bf16 v[24:27], v[112:115], v[136:139], v[24:27]
  ds_read_b128 v[84:87], v7 offset:512
  v_mfma_f32_16x16x32_bf16 v[40:43], v[116:119], v[136:139], v[40:43]
  ds_read_b128 v[100:103], v11 offset:512
  v_mfma_f32_16x16x32_bf16 v[48:51], v[120:123], v[128:131], v[48:51]
  ds_read_b128 v[88:91], v7 offset:4096
  v_mfma_f32_16x16x32_bf16 v[52:55], v[120:123], v[132:135], v[52:55]
  ds_read_b128 v[104:107], v11 offset:4096
  v_mfma_f32_16x16x32_bf16 v[56:59], v[120:123], v[136:139], v[56:59]
  ds_read_b128 v[92:95], v7 offset:4608
  v_mfma_f32_16x16x32_bf16 v[28:31], v[112:115], v[140:143], v[28:31]
  ds_read_b128 v[108:111], v11 offset:4608
  v_mfma_f32_16x16x32_bf16 v[44:47], v[116:119], v[140:143], v[44:47]
  v_mfma_f32_16x16x32_bf16 v[60:63], v[120:123], v[140:143], v[60:63]
  v_mfma_f32_16x16x32_bf16 v[64:67], v[124:127], v[128:131], v[64:67]
  v_mfma_f32_16x16x32_bf16 v[68:71], v[124:127], v[132:135], v[68:71]
  v_mfma_f32_16x16x32_bf16 v[72:75], v[124:127], v[136:139], v[72:75]
  v_mfma_f32_16x16x32_bf16 v[76:79], v[124:127], v[140:143], v[76:79]
  s_mov_b32 s16, 14
  .p2align 3
g1_kernel_cloop7:
  s_waitcnt lgkmcnt(6)
  v_mfma_f32_16x16x32_bf16 v[16:19], v[80:83], v[96:99], v[16:19]
  ds_read_b128 v[112:115], v9 offset:0
  s_waitcnt lgkmcnt(5)
  v_mfma_f32_16x16x32_bf16 v[20:23], v[80:83], v[100:103], v[20:23]
  ds_read_b128 v[128:131], v13 offset:0
  v_mfma_f32_16x16x32_bf16 v[32:35], v[84:87], v[96:99], v[32:35]
  ds_read_b128 v[116:119], v9 offset:512
  v_mfma_f32_16x16x32_bf16 v[36:39], v[84:87], v[100:103], v[36:39]
  ds_read_b128 v[132:135], v13 offset:512
  s_waitcnt lgkmcnt(6)
  v_mfma_f32_16x16x32_bf16 v[24:27], v[80:83], v[104:107], v[24:27]
  ds_read_b128 v[120:123], v9 offset:4096
  v_mfma_f32_16x16x32_bf16 v[40:43], v[84:87], v[104:107], v[40:43]
  ds_read_b128 v[136:139], v13 offset:4096
  v_mfma_f32_16x16x32_bf16 v[48:51], v[88:91], v[96:99], v[48:51]
  ds_read_b128 v[124:127], v9 offset:4608
  v_mfma_f32_16x16x32_bf16 v[52:55], v[88:91], v[100:103], v[52:55]
  ds_read_b128 v[140:143], v13 offset:4608
  v_mfma_f32_16x16x32_bf16 v[56:59], v[88:91], v[104:107], v[56:59]
  s_add_u32 s15, s15, 32768
  s_cmp_ge_u32 s15, 131072
  s_cselect_b32 s3, 131072, 0
  s_sub_u32 s15, s15, s3
  s_waitcnt lgkmcnt(8)
  v_mfma_f32_16x16x32_bf16 v[28:31], v[80:83], v[108:111], v[28:31]
  v_add_u32 v7, s15, v6
  v_mfma_f32_16x16x32_bf16 v[44:47], v[84:87], v[108:111], v[44:47]
  v_add_u32 v11, s15, v10
  v_mfma_f32_16x16x32_bf16 v[60:63], v[88:91], v[108:111], v[60:63]
  v_mfma_f32_16x16x32_bf16 v[64:67], v[92:95], v[96:99], v[64:67]
  v_mfma_f32_16x16x32_bf16 v[68:71], v[92:95], v[100:103], v[68:71]
  v_mfma_f32_16x16x32_bf16 v[72:75], v[92:95], v[104:107], v[72:75]
  v_mfma_f32_16x16x32_bf16 v[76:79], v[92:95], v[108:111], v[76:79]
  s_waitcnt lgkmcnt(6)
  v_mfma_f32_16x16x32_bf16 v[16:19], v[112:115], v[128:131], v[16:19]
  v_add_u32 v9, s15, v8
  s_waitcnt lgkmcnt(4)
  v_mfma_f32_16x16x32_bf16 v[20:23], v[112:115], v[132:135], v[20:23]
  v_add_u32 v13, s15, v12
  s_waitcnt lgkmcnt(0)
  s_barrier
  v_mfma_f32_16x16x32_bf16 v[32:35], v[116:119], v[128:131], v[32:35]
  ds_read_b128 v[80:83], v7 offset:0
  v_mfma_f32_16x16x32_bf16 v[36:39], v[116:119], v[132:135], v[36:39]
  ds_read_b128 v[96:99], v11 offset:0
  v_mfma_f32_16x16x32_bf16 v[24:27], v[112:115], v[136:139], v[24:27]
  ds_read_b128 v[84:87], v7 offset:512
  v_mfma_f32_16x16x32_bf16 v[40:43], v[116:119], v[136:139], v[40:43]
  ds_read_b128 v[100:103], v11 offset:512
  v_mfma_f32_16x16x32_bf16 v[48:51], v[120:123], v[128:131], v[48:51]
  ds_read_b128 v[88:91], v7 offset:4096
  v_mfma_f32_16x16x32_bf16 v[52:55], v[120:123], v[132:135], v[52:55]
  ds_read_b128 v[104:107], v11 offset:4096
  v_mfma_f32_16x16x32_bf16 v[56:59], v[120:123], v[136:139], v[56:59]
  ds_read_b128 v[92:95], v7 offset:4608
  v_mfma_f32_16x16x32_bf16 v[28:31], v[112:115], v[140:143], v[28:31]
  ds_read_b128 v[108:111], v11 offset:4608
  v_mfma_f32_16x16x32_bf16 v[44:47], v[116:119], v[140:143], v[44:47]
  v_mfma_f32_16x16x32_bf16 v[60:63], v[120:123], v[140:143], v[60:63]
  v_mfma_f32_16x16x32_bf16 v[64:67], v[124:127], v[128:131], v[64:67]
  v_mfma_f32_16x16x32_bf16 v[68:71], v[124:127], v[132:135], v[68:71]
  v_mfma_f32_16x16x32_bf16 v[72:75], v[124:127], v[136:139], v[72:75]
  v_mfma_f32_16x16x32_bf16 v[76:79], v[124:127], v[140:143], v[76:79]
  s_sub_u32 s16, s16, 1
  s_cmp_lg_u32 s16, 0
  s_cbranch_scc1 g1_kernel_cloop7
  s_waitcnt lgkmcnt(6)
  v_mfma_f32_16x16x32_bf16 v[16:19], v[80:83], v[96:99], v[16:19]
  ds_read_b128 v[112:115], v9 offset:0
  s_waitcnt lgkmcnt(5)
  v_mfma_f32_16x16x32_bf16 v[20:23], v[80:83], v[100:103], v[20:23]
  ds_read_b128 v[128:131], v13 offset:0
  v_mfma_f32_16x16x32_bf16 v[32:35], v[84:87], v[96:99], v[32:35]
  ds_read_b128 v[116:119], v9 offset:512
  v_mfma_f32_16x16x32_bf16 v[36:39], v[84:87], v[100:103], v[36:39]
  ds_read_b128 v[132:135], v13 offset:512
  s_waitcnt lgkmcnt(6)
  v_mfma_f32_16x16x32_bf16 v[24:27], v[80:83], v[104:107], v[24:27]
  ds_read_b128 v[120:123], v9 offset:4096
  v_mfma_f32_16x16x32_bf16 v[40:43], v[84:87], v[104:107], v[40:43]
  ds_read_b128 v[136:139], v13 offset:4096
  v_mfma_f32_16x16x32_bf16 v[48:51], v[88:91], v[96:99], v[48:51]
  ds_read_b128 v[124:127], v9 offset:4608
  v_mfma_f32_16x16x32_bf16 v[52:55], v[88:91], v[100:103], v[52:55]
  ds_read_b128 v[140:143], v13 offset:4608
  v_mfma_f32_16x16x32_bf16 v[56:59], v[88:91], v[104:107], v[56:59]
  s_waitcnt lgkmcnt(8)
  v_mfma_f32_16x16x32_bf16 v[28:31], v[80:83], v[108:111], v[28:31]
  v_mfma_f32_16x16x32_bf16 v[44:47], v[84:87], v[108:111], v[44:47]
  v_mfma_f32_16x16x32_bf16 v[60:63], v[88:91], v[108:111], v[60:63]
  v_mfma_f32_16x16x32_bf16 v[64:67], v[92:95], v[96:99], v[64:67]
  v_mfma_f32_16x16x32_bf16 v[68:71], v[92:95], v[100:103], v[68:71]
  v_mfma_f32_16x16x32_bf16 v[72:75], v[92:95], v[104:107], v[72:75]
  v_mfma_f32_16x16x32_bf16 v[76:79], v[92:95], v[108:111], v[76:79]
  s_waitcnt lgkmcnt(6)
  v_mfma_f32_16x16x32_bf16 v[16:19], v[112:115], v[128:131], v[16:19]
  s_waitcnt lgkmcnt(4)
  v_mfma_f32_16x16x32_bf16 v[20:23], v[112:115], v[132:135], v[20:23]
  v_mfma_f32_16x16x32_bf16 v[32:35], v[116:119], v[128:131], v[32:35]
  v_mfma_f32_16x16x32_bf16 v[36:39], v[116:119], v[132:135], v[36:39]
  s_waitcnt lgkmcnt(2)
  v_mfma_f32_16x16x32_bf16 v[24:27], v[112:115], v[136:139], v[24:27]
  v_mfma_f32_16x16x32_bf16 v[40:43], v[116:119], v[136:139], v[40:43]
  v_mfma_f32_16x16x32_bf16 v[48:51], v[120:123], v[128:131], v[48:51]
  v_mfma_f32_16x16x32_bf16 v[52:55], v[120:123], v[132:135], v[52:55]
  v_mfma_f32_16x16x32_bf16 v[56:59], v[120:123], v[136:139], v[56:59]
  s_waitcnt lgkmcnt(0)
  v_mfma_f32_16x16x32_bf16 v[28:31], v[112:115], v[140:143], v[28:31]
  v_mfma_f32_16x16x32_bf16 v[44:47], v[116:119], v[140:143], v[44:47]
  v_mfma_f32_16x16x32_bf16 v[60:63], v[120:123], v[140:143], v[60:63]
  v_mfma_f32_16x16x32_bf16 v[64:67], v[124:127], v[128:131], v[64:67]
  v_mfma_f32_16x16x32_bf16 v[68:71], v[124:127], v[132:135], v[68:71]
  v_mfma_f32_16x16x32_bf16 v[72:75], v[124:127], v[136:139], v[72:75]
  v_mfma_f32_16x16x32_bf16 v[76:79], v[124:127], v[140:143], v[76:79]
  v_lshlrev_b32 v152, 4, v0
  v_mov_b32 v148, -1
  v_mov_b32 v149, -1
  v_mov_b32 v150, -1
  v_mov_b32 v151, -1
  s_lshl_b32 s3, s2, 2
  s_add_u32 s3, s3, s14
  s_lshl_b32 s3, s3, 12
  buffer_store_dwordx4 v[148:151], v152, s[68:71], s3 offen offset:0 sc0 sc1
  buffer_store_dwordx4 v[148:151], v152, s[68:71], s3 offen offset:1024 sc0 sc1
  buffer_store_dwordx4 v[148:151], v152, s[68:71], s3 offen offset:2048 sc0 sc1
  buffer_store_dwordx4 v[148:151], v152, s[68:71], s3 offen offset:3072 sc0 sc1
  s_barrier
  v_and_b32 v2, 15, v0
  v_and_b32 v3, 15, v0
  v_and_b32 v3, 12, v3
  v_add_u32 v2, v2, v3
  v_lshlrev_b32 v2, 2, v2
  s_lshl_b32 s3, s25, 8
  s_add_u32 s3, s3, 132096
  v_add_u32 v2, s3, v2
  ds_read_b32 v144, v2 offset:0
  ds_read_b32 v145, v2 offset:16
  ds_read_b32 v146, v2 offset:128
  ds_read_b32 v147, v2 offset:144
  v_lshrrev_b32 v2, 4, v0
  v_lshlrev_b32 v2, 5, v2
  s_lshl_b32 s3, s24, 8
  s_add_u32 s3, s3, 131072
  v_add_u32 v2, s3, v2
  ds_read_b128 v[80:83], v2 offset:0
  ds_read_b128 v[96:99], v2 offset:512
  ds_read_b128 v[84:87], v2 offset:16
  ds_read_b128 v[100:103], v2 offset:528
  ds_read_b128 v[88:91], v2 offset:128
  ds_read_b128 v[104:107], v2 offset:640
  ds_read_b128 v[92:95], v2 offset:144
  ds_read_b128 v[108:111], v2 offset:656
  s_and_b32 s3, s13, 7
  s_lshl_b32 s3, s3, 3
  s_lshl_b32 s19, s25, 2
  s_add_u32 s3, s3, s19
  s_lshl_b32 s3, s3, 7
  s_lshr_b32 s19, s13, 3
  s_lshl_b32 s19, s19, 6
  s_add_u32 s3, s3, s19
  s_lshl_b32 s19, s12, 2
  s_add_u32 s3, s3, s19
  s_lshl_b32 s19, s24, 1
  s_add_u32 s3, s3, s19
  s_lshl_b32 s3, s3, 10
  v_lshlrev_b32 v3, 4, v0
  s_waitcnt lgkmcnt(0)
  s_add_u32 s26, s3, 0
  v_pk_mul_f32 v[16:17], v[16:17], v[80:81] op_sel:[0,0] op_sel_hi:[1,1]
  v_pk_fma_f32 v[16:17], v[96:97], v[144:145], v[16:17] op_sel:[0,0,0] op_sel_hi:[1,0,1]
  v_pk_mul_f32 v[18:19], v[18:19], v[82:83] op_sel:[0,0] op_sel_hi:[1,1]
  v_pk_fma_f32 v[18:19], v[98:99], v[144:145], v[18:19] op_sel:[0,0,0] op_sel_hi:[1,0,1]
  v_cvt_pk_bf16_f32 v112, v16, v17
  v_cvt_pk_bf16_f32 v113, v18, v19
  v_pk_mul_f32 v[32:33], v[32:33], v[84:85] op_sel:[0,0] op_sel_hi:[1,1]
  v_pk_fma_f32 v[32:33], v[100:101], v[144:145], v[32:33] op_sel:[0,0,0] op_sel_hi:[1,0,1]
  v_pk_mul_f32 v[34:35], v[34:35], v[86:87] op_sel:[0,0] op_sel_hi:[1,1]
  v_pk_fma_f32 v[34:35], v[102:103], v[144:145], v[34:35] op_sel:[0,0,0] op_sel_hi:[1,0,1]
  v_cvt_pk_bf16_f32 v114, v32, v33
  v_cvt_pk_bf16_f32 v115, v34, v35
  buffer_store_dwordx4 v[112:115], v3, s[28:31], s26 offen offset:0 sc0 sc1
  v_pk_mul_f32 v[48:49], v[48:49], v[88:89] op_sel:[0,0] op_sel_hi:[1,1]
  v_pk_fma_f32 v[48:49], v[104:105], v[144:145], v[48:49] op_sel:[0,0,0] op_sel_hi:[1,0,1]
  v_pk_mul_f32 v[50:51], v[50:51], v[90:91] op_sel:[0,0] op_sel_hi:[1,1]
  v_pk_fma_f32 v[50:51], v[106:107], v[144:145], v[50:51] op_sel:[0,0,0] op_sel_hi:[1,0,1]
  v_cvt_pk_bf16_f32 v116, v48, v49
  v_cvt_pk_bf16_f32 v117, v50, v51
  v_pk_mul_f32 v[64:65], v[64:65], v[92:93] op_sel:[0,0] op_sel_hi:[1,1]
  v_pk_fma_f32 v[64:65], v[108:109], v[144:145], v[64:65] op_sel:[0,0,0] op_sel_hi:[1,0,1]
  v_pk_mul_f32 v[66:67], v[66:67], v[94:95] op_sel:[0,0] op_sel_hi:[1,1]
  v_pk_fma_f32 v[66:67], v[110:111], v[144:145], v[66:67] op_sel:[0,0,0] op_sel_hi:[1,0,1]
  v_cvt_pk_bf16_f32 v118, v64, v65
  v_cvt_pk_bf16_f32 v119, v66, v67
  buffer_store_dwordx4 v[116:119], v3, s[28:31], s26 offen offset:1024 sc0 sc1
  s_add_u32 s26, s3, 131072
  v_pk_mul_f32 v[20:21], v[20:21], v[80:81] op_sel:[0,0] op_sel_hi:[1,1]
  v_pk_fma_f32 v[20:21], v[96:97], v[144:145], v[20:21] op_sel:[0,1,0] op_sel_hi:[1,1,1]
  v_pk_mul_f32 v[22:23], v[22:23], v[82:83] op_sel:[0,0] op_sel_hi:[1,1]
  v_pk_fma_f32 v[22:23], v[98:99], v[144:145], v[22:23] op_sel:[0,1,0] op_sel_hi:[1,1,1]
  v_cvt_pk_bf16_f32 v120, v20, v21
  v_cvt_pk_bf16_f32 v121, v22, v23
  v_pk_mul_f32 v[36:37], v[36:37], v[84:85] op_sel:[0,0] op_sel_hi:[1,1]
  v_pk_fma_f32 v[36:37], v[100:101], v[144:145], v[36:37] op_sel:[0,1,0] op_sel_hi:[1,1,1]
  v_pk_mul_f32 v[38:39], v[38:39], v[86:87] op_sel:[0,0] op_sel_hi:[1,1]
  v_pk_fma_f32 v[38:39], v[102:103], v[144:145], v[38:39] op_sel:[0,1,0] op_sel_hi:[1,1,1]
  v_cvt_pk_bf16_f32 v122, v36, v37
  v_cvt_pk_bf16_f32 v123, v38, v39
  buffer_store_dwordx4 v[120:123], v3, s[28:31], s26 offen offset:0 sc0 sc1
  v_pk_mul_f32 v[52:53], v[52:53], v[88:89] op_sel:[0,0] op_sel_hi:[1,1]
  v_pk_fma_f32 v[52:53], v[104:105], v[144:145], v[52:53] op_sel:[0,1,0] op_sel_hi:[1,1,1]
  v_pk_mul_f32 v[54:55], v[54:55], v[90:91] op_sel:[0,0] op_sel_hi:[1,1]
  v_pk_fma_f32 v[54:55], v[106:107], v[144:145], v[54:55] op_sel:[0,1,0] op_sel_hi:[1,1,1]
  v_cvt_pk_bf16_f32 v124, v52, v53
  v_cvt_pk_bf16_f32 v125, v54, v55
  v_pk_mul_f32 v[68:69], v[68:69], v[92:93] op_sel:[0,0] op_sel_hi:[1,1]
  v_pk_fma_f32 v[68:69], v[108:109], v[144:145], v[68:69] op_sel:[0,1,0] op_sel_hi:[1,1,1]
  v_pk_mul_f32 v[70:71], v[70:71], v[94:95] op_sel:[0,0] op_sel_hi:[1,1]
  v_pk_fma_f32 v[70:71], v[110:111], v[144:145], v[70:71] op_sel:[0,1,0] op_sel_hi:[1,1,1]
  v_cvt_pk_bf16_f32 v126, v68, v69
  v_cvt_pk_bf16_f32 v127, v70, v71
  buffer_store_dwordx4 v[124:127], v3, s[28:31], s26 offen offset:1024 sc0 sc1
  s_add_u32 s26, s3, 262144
  v_pk_mul_f32 v[24:25], v[24:25], v[80:81] op_sel:[0,0] op_sel_hi:[1,1]
  v_pk_fma_f32 v[24:25], v[96:97], v[146:147], v[24:25] op_sel:[0,0,0] op_sel_hi:[1,0,1]
  v_pk_mul_f32 v[26:27], v[26:27], v[82:83] op_sel:[0,0] op_sel_hi:[1,1]
  v_pk_fma_f32 v[26:27], v[98:99], v[146:147], v[26:27] op_sel:[0,0,0] op_sel_hi:[1,0,1]
  v_cvt_pk_bf16_f32 v112, v24, v25
  v_cvt_pk_bf16_f32 v113, v26, v27
  v_pk_mul_f32 v[40:41], v[40:41], v[84:85] op_sel:[0,0] op_sel_hi:[1,1]
  v_pk_fma_f32 v[40:41], v[100:101], v[146:147], v[40:41] op_sel:[0,0,0] op_sel_hi:[1,0,1]
  v_pk_mul_f32 v[42:43], v[42:43], v[86:87] op_sel:[0,0] op_sel_hi:[1,1]
  v_pk_fma_f32 v[42:43], v[102:103], v[146:147], v[42:43] op_sel:[0,0,0] op_sel_hi:[1,0,1]
  v_cvt_pk_bf16_f32 v114, v40, v41
  v_cvt_pk_bf16_f32 v115, v42, v43
  buffer_store_dwordx4 v[112:115], v3, s[28:31], s26 offen offset:0 sc0 sc1
  v_pk_mul_f32 v[56:57], v[56:57], v[88:89] op_sel:[0,0] op_sel_hi:[1,1]
  v_pk_fma_f32 v[56:57], v[104:105], v[146:147], v[56:57] op_sel:[0,0,0] op_sel_hi:[1,0,1]
  v_pk_mul_f32 v[58:59], v[58:59], v[90:91] op_sel:[0,0] op_sel_hi:[1,1]
  v_pk_fma_f32 v[58:59], v[106:107], v[146:147], v[58:59] op_sel:[0,0,0] op_sel_hi:[1,0,1]
  v_cvt_pk_bf16_f32 v116, v56, v57
  v_cvt_pk_bf16_f32 v117, v58, v59
  v_pk_mul_f32 v[72:73], v[72:73], v[92:93] op_sel:[0,0] op_sel_hi:[1,1]
  v_pk_fma_f32 v[72:73], v[108:109], v[146:147], v[72:73] op_sel:[0,0,0] op_sel_hi:[1,0,1]
  v_pk_mul_f32 v[74:75], v[74:75], v[94:95] op_sel:[0,0] op_sel_hi:[1,1]
  v_pk_fma_f32 v[74:75], v[110:111], v[146:147], v[74:75] op_sel:[0,0,0] op_sel_hi:[1,0,1]
  v_cvt_pk_bf16_f32 v118, v72, v73
  v_cvt_pk_bf16_f32 v119, v74, v75
  buffer_store_dwordx4 v[116:119], v3, s[28:31], s26 offen offset:1024 sc0 sc1
  s_add_u32 s26, s3, 393216
  v_pk_mul_f32 v[28:29], v[28:29], v[80:81] op_sel:[0,0] op_sel_hi:[1,1]
  v_pk_fma_f32 v[28:29], v[96:97], v[146:147], v[28:29] op_sel:[0,1,0] op_sel_hi:[1,1,1]
  v_pk_mul_f32 v[30:31], v[30:31], v[82:83] op_sel:[0,0] op_sel_hi:[1,1]
  v_pk_fma_f32 v[30:31], v[98:99], v[146:147], v[30:31] op_sel:[0,1,0] op_sel_hi:[1,1,1]
  v_cvt_pk_bf16_f32 v120, v28, v29
  v_cvt_pk_bf16_f32 v121, v30, v31
  v_pk_mul_f32 v[44:45], v[44:45], v[84:85] op_sel:[0,0] op_sel_hi:[1,1]
  v_pk_fma_f32 v[44:45], v[100:101], v[146:147], v[44:45] op_sel:[0,1,0] op_sel_hi:[1,1,1]
  v_pk_mul_f32 v[46:47], v[46:47], v[86:87] op_sel:[0,0] op_sel_hi:[1,1]
  v_pk_fma_f32 v[46:47], v[102:103], v[146:147], v[46:47] op_sel:[0,1,0] op_sel_hi:[1,1,1]
  v_cvt_pk_bf16_f32 v122, v44, v45
  v_cvt_pk_bf16_f32 v123, v46, v47
  buffer_store_dwordx4 v[120:123], v3, s[28:31], s26 offen offset:0 sc0 sc1
  v_pk_mul_f32 v[60:61], v[60:61], v[88:89] op_sel:[0,0] op_sel_hi:[1,1]
  v_pk_fma_f32 v[60:61], v[104:105], v[146:147], v[60:61] op_sel:[0,1,0] op_sel_hi:[1,1,1]
  v_pk_mul_f32 v[62:63], v[62:63], v[90:91] op_sel:[0,0] op_sel_hi:[1,1]
  v_pk_fma_f32 v[62:63], v[106:107], v[146:147], v[62:63] op_sel:[0,1,0] op_sel_hi:[1,1,1]
  v_cvt_pk_bf16_f32 v124, v60, v61
  v_cvt_pk_bf16_f32 v125, v62, v63
  v_pk_mul_f32 v[76:77], v[76:77], v[92:93] op_sel:[0,0] op_sel_hi:[1,1]
  v_pk_fma_f32 v[76:77], v[108:109], v[146:147], v[76:77] op_sel:[0,1,0] op_sel_hi:[1,1,1]
  v_pk_mul_f32 v[78:79], v[78:79], v[94:95] op_sel:[0,0] op_sel_hi:[1,1]
  v_pk_fma_f32 v[78:79], v[110:111], v[146:147], v[78:79] op_sel:[0,1,0] op_sel_hi:[1,1,1]
  v_cvt_pk_bf16_f32 v126, v76, v77
  v_cvt_pk_bf16_f32 v127, v78, v79
  buffer_store_dwordx4 v[124:127], v3, s[28:31], s26 offen offset:1024 sc0 sc1
g1_kernel_fin:
g1_kernel_end:
  s_endpgm
.p2align 6
g1b_kernel_fe:
  s_load_dwordx2 s[4:5], s[0:1], 96
  s_load_dwordx2 s[8:9], s[0:1], 24
  s_load_dwordx2 s[22:23], s[0:1], 32
  s_and_b32 s3, s2, 7
  s_lshr_b32 s16, s2, 3
  s_and_b32 s12, s3, 1
  s_mul_i32 s12, s12, 8
  s_lshr_b32 s13, s3, 1
  s_mul_i32 s13, s13, 4
  s_and_b32 s3, s16, 7
  s_add_u32 s12, s12, s3
  s_lshr_b32 s16, s16, 3
  s_add_u32 s13, s13, s16
  s_mov_b32 s15, 0
  s_cmp_lt_u32 s14, 4
  s_cbranch_scc1 g1b_kernel_comp
  s_sub_u32 s24, s14, 4
  s_setprio 2
  s_mul_i32 s82, s12, 262144
  s_lshr_b32 s3, s24, 1
  s_mul_i32 s3, s3, 32768
  s_add_u32 s82, s82, s3
  s_and_b32 s3, s24, 1
  s_lshl_b32 s3, s3, 10
  s_add_u32 s82, s82, s3
  s_mul_i32 s84, s24, 1024
  v_lshlrev_b32 v6, 4, v0
  v_add_u32 v6, s82, v6
  s_and_b32 s3, s13, 7
  s_mul_i32 s83, s3, 262144
  s_mul_i32 s3, s24, 16384
  s_add_u32 s83, s83, s3
  s_mul_i32 s85, s24, 1024
  s_add_u32 s85, s85, 16384
  v_lshrrev_b32 v7, 3, v0
  v_lshlrev_b32 v7, 11, v7
  v_lshrrev_b32 v3, 4, v0
  v_and_b32 v3, 1, v3
  v_xor_b32 v2, v0, v3
  v_and_b32 v2, 7, v2
  v_lshlrev_b32 v2, 4, v2
  v_add_u32 v7, v7, v2
  s_lshl_b32 s3, s24, 5
  v_xor_b32 v7, s3, v7
  v_add_u32 v7, s83, v7
  s_mov_b32 s17, 0
  s_mov_b32 s18, 0
  s_mov_b32 s80, 0
  s_mul_i32 s81, s12, 1
  s_mul_i32 s3, s13, 1
  s_add_u32 s81, s81, s3
  s_mov_b32 s16, 0
  s_waitcnt lgkmcnt(0)
  s_add_u32 s4, s4, 67108864
  s_addc_u32 s5, s5, 0
  s_mov_b32 s6, 4194304
  s_mov_b32 s7, 0x20000
  s_mov_b32 s10, 2097152
  s_mov_b32 s11, 0x20000
  s_cmp_ge_u32 s13, 8
  s_cselect_b32 s8, s22, s8
  s_cselect_b32 s9, s23, s9
  s_add_u32 s3, s80, s81
  s_and_b32 s3, s3, 3
  s_andn2_b32 s19, s80, 3
  s_or_b32 s3, s3, s19
  s_mul_i32 s17, s3, 2048
  s_mul_i32 s18, s3, 128
  s_barrier
g1b_kernel_nsg3:
  s_add_u32 s26, s15, s85
  s_mov_b32 m0, s26
  s_nop 0
  buffer_load_dwordx4 v7, s[8:11], s18 offen lds
  s_add_u32 m0, s26, 4096
  s_add_u32 s27, s18, 65536
  buffer_load_dwordx4 v7, s[8:11], s27 offen lds
  s_add_u32 m0, s26, 8192
  s_add_u32 s27, s18, 131072
  buffer_load_dwordx4 v7, s[8:11], s27 offen lds
  s_add_u32 m0, s26, 12288
  s_add_u32 s27, s18, 196608
  buffer_load_dwordx4 v7, s[8:11], s27 offen lds
  s_add_u32 s15, s15, 32768
  s_cmp_eq_u32 s15, 131072
  s_cselect_b32 s15, 0, s15
  s_add_u32 s80, s80, 1
  s_add_u32 s3, s80, s81
  s_and_b32 s3, s3, 3
  s_andn2_b32 s19, s80, 3
  s_or_b32 s3, s3, s19
  s_mul_i32 s17, s3, 2048
  s_mul_i32 s18, s3, 128
  s_add_u32 s26, s15, s85
  s_mov_b32 m0, s26
  s_nop 0
  buffer_load_dwordx4 v7, s[8:11], s18 offen lds
  s_add_u32 m0, s26, 4096
  s_add_u32 s27, s18, 65536
  buffer_load_dwordx4 v7, s[8:11], s27 offen lds
  s_add_u32 m0, s26, 8192
  s_add_u32 s27, s18, 131072
  buffer_load_dwordx4 v7, s[8:11], s27 offen lds
  s_add_u32 m0, s26, 12288
  s_add_u32 s27, s18, 196608
  buffer_load_dwordx4 v7, s[8:11], s27 offen lds
  s_add_u32 s15, s15, 32768
  s_cmp_eq_u32 s15, 131072
  s_cselect_b32 s15, 0, s15
  s_add_u32 s80, s80, 1
  s_add_u32 s3, s80, s81
  s_and_b32 s3, s3, 3
  s_andn2_b32 s19, s80, 3
  s_or_b32 s3, s3, s19
  s_mul_i32 s17, s3, 2048
  s_mul_i32 s18, s3, 128
  s_add_u32 s26, s15, s85
  s_mov_b32 m0, s26
  s_nop 0
  buffer_load_dwordx4 v7, s[8:11], s18 offen lds
  s_add_u32 m0, s26, 4096
  s_add_u32 s27, s18, 65536
  buffer_load_dwordx4 v7, s[8:11], s27 offen lds
  s_add_u32 m0, s26, 8192
  s_add_u32 s27, s18, 131072
  buffer_load_dwordx4 v7, s[8:11], s27 offen lds
  s_add_u32 m0, s26, 12288
  s_add_u32 s27, s18, 196608
  buffer_load_dwordx4 v7, s[8:11], s27 offen lds
  s_add_u32 s15, s15, 32768
  s_cmp_eq_u32 s15, 131072
  s_cselect_b32 s15, 0, s15
  s_add_u32 s80, s80, 1
  s_add_u32 s3, s80, s81
  s_and_b32 s3, s3, 3
  s_andn2_b32 s19, s80, 3
  s_or_b32 s3, s3, s19
  s_mul_i32 s17, s3, 2048
  s_mul_i32 s18, s3, 128
  s_mov_b32 s15, 0
  s_mov_b32 s17, 0
  s_mov_b32 s18, 0
  s_mov_b32 s80, 0
  s_add_u32 s3, s80, s81
  s_and_b32 s3, s3, 3
  s_andn2_b32 s19, s80, 3
  s_or_b32 s3, s3, s19
  s_mul_i32 s17, s3, 2048
  s_mul_i32 s18, s3, 128
  s_load_dwordx2 s[28:29], s[0:1], 96
  v_and_b32 v2, 15, v0
  v_lshlrev_b32 v2, 7, v2
  s_cmp_lg_u32 s90, 0
  s_cselect_b32 s32, -4, 0
  s_lshl_b32 s32, s32, 15
  s_lshl_b32 s3, s12, 8
  s_lshr_b32 s3, s3, 4
  s_lshl_b32 s3, s3, 7
  s_add_u32 s32, s32, s3
  s_mov_b32 s33, 0
  s_waitcnt lgkmcnt(0)
  s_add_u32 s28, s28, 63963136
  s_addc_u32 s29, s29, 0
  s_mov_b32 s30, 262144
  s_mov_b32 s31, 0x20000
  s_cmp_lg_u32 s24, 0
  s_cbranch_scc1 g1b_kernel_dd5
g1b_kernel_dp4:
  buffer_load_dword v8, v2, s[28:31], s32 offen sc1
  s_add_u32 s33, s33, 1
  s_waitcnt vmcnt(0)
  v_cmp_eq_u32 vcc, -1, v8
  s_cmp_ge_u32 s33, 0x8000
  s_cbranch_vccz g1b_kernel_dd5
  s_cbranch_scc0 g1b_kernel_dp4
g1b_kernel_dd5:
  s_barrier
  s_add_u32 s26, s15, s84
  s_mov_b32 m0, s26
  s_nop 0
  buffer_load_dwordx4 v6, s[4:7], s17 offen lds
  s_add_u32 m0, s26, 4096
  s_add_u32 s27, s17, 65536
  buffer_load_dwordx4 v6, s[4:7], s27 offen lds
  s_add_u32 m0, s26, 8192
  s_add_u32 s27, s17, 131072
  buffer_load_dwordx4 v6, s[4:7], s27 offen lds
  s_add_u32 m0, s26, 12288
  s_add_u32 s27, s17, 196608
  buffer_load_dwordx4 v6, s[4:7], s27 offen lds
  s_add_u32 s15, s15, 32768
  s_cmp_eq_u32 s15, 131072
  s_cselect_b32 s15, 0, s15
  s_add_u32 s80, s80, 1
  s_add_u32 s3, s80, s81
  s_and_b32 s3, s3, 3
  s_andn2_b32 s19, s80, 3
  s_or_b32 s3, s3, s19
  s_mul_i32 s17, s3, 2048
  s_mul_i32 s18, s3, 128
  s_add_u32 s26, s15, s84
  s_mov_b32 m0, s26
  s_nop 0
  buffer_load_dwordx4 v6, s[4:7], s17 offen lds
  s_add_u32 m0, s26, 4096
  s_add_u32 s27, s17, 65536
  buffer_load_dwordx4 v6, s[4:7], s27 offen lds
  s_add_u32 m0, s26, 8192
  s_add_u32 s27, s17, 131072
  buffer_load_dwordx4 v6, s[4:7], s27 offen lds
  s_add_u32 m0, s26, 12288
  s_add_u32 s27, s17, 196608
  buffer_load_dwordx4 v6, s[4:7], s27 offen lds
  s_add_u32 s15, s15, 32768
  s_cmp_eq_u32 s15, 131072
  s_cselect_b32 s15, 0, s15
  s_add_u32 s80, s80, 1
  s_add_u32 s3, s80, s81
  s_and_b32 s3, s3, 3
  s_andn2_b32 s19, s80, 3
  s_or_b32 s3, s3, s19
  s_mul_i32 s17, s3, 2048
  s_mul_i32 s18, s3, 128
  s_add_u32 s26, s15, s84
  s_mov_b32 m0, s26
  s_nop 0
  buffer_load_dwordx4 v6, s[4:7], s17 offen lds
  s_add_u32 m0, s26, 4096
  s_add_u32 s27, s17, 65536
  buffer_load_dwordx4 v6, s[4:7], s27 offen lds
  s_add_u32 m0, s26, 8192
  s_add_u32 s27, s17, 131072
  buffer_load_dwordx4 v6, s[4:7], s27 offen lds
  s_add_u32 m0, s26, 12288
  s_add_u32 s27, s17, 196608
  buffer_load_dwordx4 v6, s[4:7], s27 offen lds
  s_add_u32 s15, s15, 32768
  s_cmp_eq_u32 s15, 131072
  s_cselect_b32 s15, 0, s15
  s_add_u32 s80, s80, 1
  s_add_u32 s3, s80, s81
  s_and_b32 s3, s3, 3
  s_andn2_b32 s19, s80, 3
  s_or_b32 s3, s3, s19
  s_mul_i32 s17, s3, 2048
  s_mul_i32 s18, s3, 128
  s_waitcnt vmcnt(8)
  s_barrier
  s_add_u32 s26, s15, s84
  s_mov_b32 m0, s26
  s_nop 0
  buffer_load_dwordx4 v6, s[4:7], s17 offen lds
  s_add_u32 m0, s26, 4096
  s_add_u32 s27, s17, 65536
  buffer_load_dwordx4 v6, s[4:7], s27 offen lds
  s_add_u32 m0, s26, 8192
  s_add_u32 s27, s17, 131072
  buffer_load_dwordx4 v6, s[4:7], s27 offen lds
  s_add_u32 m0, s26, 12288
  s_add_u32 s27, s17, 196608
  buffer_load_dwordx4 v6, s[4:7], s27 offen lds
  s_add_u32 s26, s15, s85
  s_mov_b32 m0, s26
  s_nop 0
  buffer_load_dwordx4 v7, s[8:11], s18 offen lds
  s_add_u32 m0, s26, 4096
  s_add_u32 s27, s18, 65536
  buffer_load_dwordx4 v7, s[8:11], s27 offen lds
  s_add_u32 m0, s26, 8192
  s_add_u32 s27, s18, 131072
  buffer_load_dwordx4 v7, s[8:11], s27 offen lds
  s_add_u32 m0, s26, 12288
  s_add_u32 s27, s18, 196608
  buffer_load_dwordx4 v7, s[8:11], s27 offen lds
  s_add_u32 s15, s15, 32768
  s_cmp_eq_u32 s15, 131072
  s_cselect_b32 s15, 0, s15
  s_add_u32 s80, s80, 1
  s_add_u32 s3, s80, s81
  s_and_b32 s3, s3, 3
  s_andn2_b32 s19, s80, 3
  s_or_b32 s3, s3, s19
  s_mul_i32 s17, s3, 2048
  s_mul_i32 s18, s3, 128
  s_waitcnt vmcnt(12)
  s_barrier
  s_add_u32 s26, s15, s84
  s_mov_b32 m0, s26
  s_nop 0
  buffer_load_dwordx4 v6, s[4:7], s17 offen lds
  s_add_u32 m0, s26, 4096
  s_add_u32 s27, s17, 65536
  buffer_load_dwordx4 v6, s[4:7], s27 offen lds
  s_add_u32 m0, s26, 8192
  s_add_u32 s27, s17, 131072
  buffer_load_dwordx4 v6, s[4:7], s27 offen lds
  s_add_u32 m0, s26, 12288
  s_add_u32 s27, s17, 196608
  buffer_load_dwordx4 v6, s[4:7], s27 offen lds
  s_add_u32 s26, s15, s85
  s_mov_b32 m0, s26
  s_nop 0
  buffer_load_dwordx4 v7, s[8:11], s18 offen lds
  s_add_u32 m0, s26, 4096
  s_add_u32 s27, s18, 65536
  buffer_load_dwordx4 v7, s[8:11], s27 offen lds
  s_add_u32 m0, s26, 8192
  s_add_u32 s27, s18, 131072
  buffer_load_dwordx4 v7, s[8:11], s27 offen lds
  s_add_u32 m0, s26, 12288
  s_add_u32 s27, s18, 196608
  buffer_load_dwordx4 v7, s[8:11], s27 offen lds
  s_add_u32 s15, s15, 32768
  s_cmp_eq_u32 s15, 131072
  s_cselect_b32 s15, 0, s15
  s_add_u32 s80, s80, 1
  s_add_u32 s3, s80, s81
  s_and_b32 s3, s3, 3
  s_andn2_b32 s19, s80, 3
  s_or_b32 s3, s3, s19
  s_mul_i32 s17, s3, 2048
  s_mul_i32 s18, s3, 128
  s_mov_b32 s16, 5
g1b_kernel_ldloop1:
  s_waitcnt vmcnt(16)
  s_barrier
g1b_kernel_ldissue2:
  s_add_u32 s26, s15, s84
  s_mov_b32 m0, s26
  s_nop 0
  buffer_load_dwordx4 v6, s[4:7], s17 offen lds
  s_add_u32 m0, s26, 4096
  s_add_u32 s27, s17, 65536
  buffer_load_dwordx4 v6, s[4:7], s27 offen lds
  s_add_u32 m0, s26, 8192
  s_add_u32 s27, s17, 131072
  buffer_load_dwordx4 v6, s[4:7], s27 offen lds
  s_add_u32 m0, s26, 12288
  s_add_u32 s27, s17, 196608
  buffer_load_dwordx4 v6, s[4:7], s27 offen lds
  s_add_u32 s26, s15, s85
  s_mov_b32 m0, s26
  s_nop 0
  buffer_load_dwordx4 v7, s[8:11], s18 offen lds
  s_add_u32 m0, s26, 4096
  s_add_u32 s27, s18, 65536
  buffer_load_dwordx4 v7, s[8:11], s27 offen lds
  s_add_u32 m0, s26, 8192
  s_add_u32 s27, s18, 131072
  buffer_load_dwordx4 v7, s[8:11], s27 offen lds
  s_add_u32 m0, s26, 12288
  s_add_u32 s27, s18, 196608
  buffer_load_dwordx4 v7, s[8:11], s27 offen lds
  s_add_u32 s15, s15, 32768
  s_cmp_eq_u32 s15, 131072
  s_cselect_b32 s15, 0, s15
  s_add_u32 s80, s80, 1
  s_add_u32 s3, s80, s81
  s_and_b32 s3, s3, 3
  s_andn2_b32 s19, s80, 3
  s_or_b32 s3, s3, s19
  s_mul_i32 s17, s3, 2048
  s_mul_i32 s18, s3, 128
  s_add_u32 s16, s16, 1
  s_cmp_lt_u32 s16, 16
  s_cbranch_scc1 g1b_kernel_ldloop1
  s_load_dwordx2 s[32:33], s[0:1], 96
  s_and_b32 s3, s24, 1
  s_lshl_b32 s3, s3, 6
  v_add_u32 v44, s3, v0
  v_lshlrev_b32 v2, 3, v44
  s_lshl_b32 s57, s12, 14
  s_waitcnt lgkmcnt(0)
  s_add_u32 s32, s32, 66060288
  s_addc_u32 s33, s33, 0
  s_mov_b32 s34, 262144
  s_mov_b32 s35, 0x20000
  buffer_load_dwordx2 v[12:13], v2, s[32:35], s57 offen offset:0
  buffer_load_dwordx2 v[14:15], v2, s[32:35], s57 offen offset:1024
  buffer_load_dwordx2 v[16:17], v2, s[32:35], s57 offen offset:2048
  buffer_load_dwordx2 v[18:19], v2, s[32:35], s57 offen offset:3072
  s_add_u32 s57, s57, 4096
  buffer_load_dwordx2 v[20:21], v2, s[32:35], s57 offen offset:0
  buffer_load_dwordx2 v[22:23], v2, s[32:35], s57 offen offset:1024
  buffer_load_dwordx2 v[24:25], v2, s[32:35], s57 offen offset:2048
  buffer_load_dwordx2 v[26:27], v2, s[32:35], s57 offen offset:3072
  s_add_u32 s57, s57, 4096
  buffer_load_dwordx2 v[28:29], v2, s[32:35], s57 offen offset:0
  buffer_load_dwordx2 v[30:31], v2, s[32:35], s57 offen offset:1024
  buffer_load_dwordx2 v[32:33], v2, s[32:35], s57 offen offset:2048
  buffer_load_dwordx2 v[34:35], v2, s[32:35], s57 offen offset:3072
  s_add_u32 s57, s57, 4096
  buffer_load_dwordx2 v[36:37], v2, s[32:35], s57 offen offset:0
  buffer_load_dwordx2 v[38:39], v2, s[32:35], s57 offen offset:1024
  buffer_load_dwordx2 v[40:41], v2, s[32:35], s57 offen offset:2048
  buffer_load_dwordx2 v[42:43], v2, s[32:35], s57 offen offset:3072
  s_waitcnt vmcnt(32)
  s_barrier
  s_waitcnt vmcnt(24)
  s_barrier
  s_waitcnt vmcnt(16)
  s_barrier
  s_cmp_ge_u32 s13, 8
  s_cselect_b32 s56, 3212836864, 1065353216
  s_waitcnt vmcnt(0)
  v_pk_add_f32 v[12:13], v[12:13], v[28:29] op_sel:[0,0] op_sel_hi:[1,1]
  v_pk_add_f32 v[14:15], v[14:15], v[30:31] op_sel:[0,0] op_sel_hi:[1,1]
  v_pk_add_f32 v[16:17], v[16:17], v[32:33] op_sel:[0,0] op_sel_hi:[1,1]
  v_pk_add_f32 v[18:19], v[18:19], v[34:35] op_sel:[0,0] op_sel_hi:[1,1]
  v_pk_add_f32 v[20:21], v[20:21], v[36:37] op_sel:[0,0] op_sel_hi:[1,1]
  v_pk_add_f32 v[22:23], v[22:23], v[38:39] op_sel:[0,0] op_sel_hi:[1,1]
  v_pk_add_f32 v[24:25], v[24:25], v[40:41] op_sel:[0,0] op_sel_hi:[1,1]
  v_pk_add_f32 v[26:27], v[26:27], v[42:43] op_sel:[0,0] op_sel_hi:[1,1]
  v_pk_add_f32 v[12:13], v[12:13], v[20:21] op_sel:[0,0] op_sel_hi:[1,1]
  v_pk_add_f32 v[14:15], v[14:15], v[22:23] op_sel:[0,0] op_sel_hi:[1,1]
  v_pk_add_f32 v[16:17], v[16:17], v[24:25] op_sel:[0,0] op_sel_hi:[1,1]
  v_pk_add_f32 v[18:19], v[18:19], v[26:27] op_sel:[0,0] op_sel_hi:[1,1]
  v_pk_add_f32 v[12:13], v[12:13], v[16:17] op_sel:[0,0] op_sel_hi:[1,1]
  v_pk_add_f32 v[14:15], v[14:15], v[18:19] op_sel:[0,0] op_sel_hi:[1,1]
  v_pk_add_f32 v[12:13], v[12:13], v[14:15] op_sel:[0,0] op_sel_hi:[1,1]
  v_mul_f32 v12, 981467136, v12
  v_mul_f32 v13, 981467136, v13
  v_fma_f32 v13, -v12, v12, v13
  v_max_f32 v13, 0, v13
  v_add_f32 v13, 925353388, v13
  v_rsq_f32 v13, v13
  s_nop 0
  v_mul_f32 v13, s56, v13
  v_mul_f32 v12, v12, v13
  v_sub_f32 v12, 0, v12
  v_lshlrev_b32 v3, 2, v44
  v_add_u32 v3, 131072, v3
  ds_write_b32 v3, v13
  ds_write_b32 v3, v12 offset:512
  s_waitcnt lgkmcnt(0)
  s_barrier
  s_lshl_b32 s86, s13, 4
  s_add_u32 s86, s86, s12
  s_lshl_b32 s86, s86, 7
  s_branch g2_kernel_fe
g1b_kernel_comp:
  s_load_dwordx2 s[28:29], s[0:1], 96
  s_load_dwordx2 s[36:37], s[0:1], 96
  s_and_b32 s24, s14, 1
  s_lshr_b32 s25, s14, 1
  v_lshlrev_b32 v6, 4, v0
  s_mul_i32 s3, s24, 8192
  v_add_u32 v6, s3, v6
  v_mov_b32 v7, v6
  v_mov_b32 v8, v6
  v_and_b32 v9, 15, v0
  v_and_b32 v2, 15, v0
  v_and_b32 v2, 12, v2
  v_add_u32 v9, v9, v2
  v_lshlrev_b32 v9, 7, v9
  v_lshrrev_b32 v2, 4, v0
  v_and_b32 v3, 15, v0
  v_and_b32 v4, 15, v0
  v_and_b32 v4, 12, v4
  v_add_u32 v3, v3, v4
  v_lshrrev_b32 v3, 1, v3
  v_and_b32 v3, 1, v3
  v_and_b32 v4, 15, v0
  v_and_b32 v5, 15, v0
  v_and_b32 v5, 12, v5
  v_add_u32 v4, v4, v5
  v_lshrrev_b32 v4, 2, v4
  v_and_b32 v4, 6, v4
  v_add_u32 v3, v3, v4
  v_xor_b32 v2, v2, v3
  v_and_b32 v2, 7, v2
  v_lshlrev_b32 v2, 4, v2
  v_add_u32 v9, v9, v2
  s_mul_i32 s3, s25, 8192
  s_add_u32 s3, s3, 16384
  v_add_u32 v9, s3, v9
  v_mov_b32 v10, v9
  v_and_b32 v11, 15, v0
  v_and_b32 v2, 15, v0
  v_and_b32 v2, 12, v2
  v_add_u32 v11, v11, v2
  v_lshlrev_b32 v11, 7, v11
  v_lshrrev_b32 v2, 4, v0
  v_xor_b32 v2, 4, v2
  v_and_b32 v3, 15, v0
  v_and_b32 v4, 15, v0
  v_and_b32 v4, 12, v4
  v_add_u32 v3, v3, v4
  v_lshrrev_b32 v3, 1, v3
  v_and_b32 v3, 1, v3
  v_and_b32 v4, 15, v0
  v_and_b32 v5, 15, v0
  v_and_b32 v5, 12, v5
  v_add_u32 v4, v4, v5
  v_lshrrev_b32 v4, 2, v4
  v_and_b32 v4, 6, v4
  v_add_u32 v3, v3, v4
  v_xor_b32 v2, v2, v3
  v_and_b32 v2, 7, v2
  v_lshlrev_b32 v2, 4, v2
  v_add_u32 v11, v11, v2
  s_mul_i32 s3, s25, 8192
  s_add_u32 s3, s3, 16384
  v_add_u32 v11, s3, v11
  v_mov_b32 v12, v11
  s_waitcnt lgkmcnt(0)
  s_add_u32 s28, s28, 8388608
  s_addc_u32 s29, s29, 0
  s_cmp_eq_u32 s90, 0
  s_cselect_b32 s30, 67108864, 0
  s_add_u32 s28, s28, s30
  s_addc_u32 s29, s29, 0
  s_mov_b32 s30, 8388608
  s_mov_b32 s31, 0x20000
  s_add_u32 s36, s36, 44040192
  s_addc_u32 s37, s37, 0
  s_mov_b32 s38, 8192
  s_mov_b32 s39, 0x20000
  v_and_b32 v2, 15, v0
  v_and_b32 v3, 15, v0
  v_and_b32 v3, 12, v3
  v_add_u32 v2, v2, v3
  v_lshlrev_b32 v2, 2, v2
  s_lshl_b32 s3, s13, 9
  s_lshl_b32 s19, s25, 8
  s_add_u32 s3, s3, s19
  buffer_load_dword v144, v2, s[36:39], s3 offen offset:0
  buffer_load_dword v145, v2, s[36:39], s3 offen offset:16
  buffer_load_dword v146, v2, s[36:39], s3 offen offset:128
  buffer_load_dword v147, v2, s[36:39], s3 offen offset:144
  s_waitcnt lgkmcnt(0)
  s_barrier
  s_barrier
  ds_read_b128 v[80:83], v7 offset:0
  ds_read_b128 v[96:99], v10 offset:0
  ds_read_b128 v[84:87], v7 offset:2048
  ds_read_b128 v[100:103], v10 offset:512
  ds_read_b128 v[88:91], v7 offset:4096
  ds_read_b128 v[104:107], v10 offset:4096
  ds_read_b128 v[92:95], v7 offset:6144
  ds_read_b128 v[108:111], v10 offset:4608
  s_waitcnt lgkmcnt(6)
  v_mfma_f32_16x16x32_bf16 v[16:19], v[80:83], v[96:99], 0
  ds_read_b128 v[112:115], v8 offset:1024
  s_waitcnt lgkmcnt(5)
  v_mfma_f32_16x16x32_bf16 v[20:23], v[80:83], v[100:103], 0
  ds_read_b128 v[128:131], v12 offset:0
  v_mfma_f32_16x16x32_bf16 v[32:35], v[84:87], v[96:99], 0
  ds_read_b128 v[116:119], v8 offset:3072
  v_mfma_f32_16x16x32_bf16 v[36:39], v[84:87], v[100:103], 0
  ds_read_b128 v[132:135], v12 offset:512
  s_waitcnt lgkmcnt(6)
  v_mfma_f32_16x16x32_bf16 v[24:27], v[80:83], v[104:107], 0
  ds_read_b128 v[120:123], v8 offset:5120
  v_mfma_f32_16x16x32_bf16 v[40:43], v[84:87], v[104:107], 0
  ds_read_b128 v[136:139], v12 offset:4096
  v_mfma_f32_16x16x32_bf16 v[48:51], v[88:91], v[96:99], 0
  ds_read_b128 v[124:127], v8 offset:7168
  v_mfma_f32_16x16x32_bf16 v[52:55], v[88:91], v[100:103], 0
  ds_read_b128 v[140:143], v12 offset:4608
  v_mfma_f32_16x16x32_bf16 v[56:59], v[88:91], v[104:107], 0
  s_add_u32 s15, s15, 32768
  s_cmp_ge_u32 s15, 131072
  s_cselect_b32 s3, 131072, 0
  s_sub_u32 s15, s15, s3
  s_waitcnt lgkmcnt(8)
  v_mfma_f32_16x16x32_bf16 v[28:31], v[80:83], v[108:111], 0
  v_add_u32 v7, s15, v6
  v_mfma_f32_16x16x32_bf16 v[44:47], v[84:87], v[108:111], 0
  v_add_u32 v10, s15, v9
  v_mfma_f32_16x16x32_bf16 v[60:63], v[88:91], v[108:111], 0
  v_mfma_f32_16x16x32_bf16 v[64:67], v[92:95], v[96:99], 0
  v_mfma_f32_16x16x32_bf16 v[68:71], v[92:95], v[100:103], 0
  v_mfma_f32_16x16x32_bf16 v[72:75], v[92:95], v[104:107], 0
  v_mfma_f32_16x16x32_bf16 v[76:79], v[92:95], v[108:111], 0
  s_waitcnt lgkmcnt(6)
  v_mfma_f32_16x16x32_bf16 v[16:19], v[112:115], v[128:131], v[16:19]
  v_add_u32 v8, s15, v6
  s_waitcnt lgkmcnt(4)
  v_mfma_f32_16x16x32_bf16 v[20:23], v[112:115], v[132:135], v[20:23]
  v_add_u32 v12, s15, v11
  s_waitcnt lgkmcnt(0)
  s_barrier
  v_mfma_f32_16x16x32_bf16 v[32:35], v[116:119], v[128:131], v[32:35]
  ds_read_b128 v[80:83], v7 offset:0
  v_mfma_f32_16x16x32_bf16 v[36:39], v[116:119], v[132:135], v[36:39]
  ds_read_b128 v[96:99], v10 offset:0
  v_mfma_f32_16x16x32_bf16 v[24:27], v[112:115], v[136:139], v[24:27]
  ds_read_b128 v[84:87], v7 offset:2048
  v_mfma_f32_16x16x32_bf16 v[40:43], v[116:119], v[136:139], v[40:43]
  ds_read_b128 v[100:103], v10 offset:512
  v_mfma_f32_16x16x32_bf16 v[48:51], v[120:123], v[128:131], v[48:51]
  ds_read_b128 v[88:91], v7 offset:4096
  v_mfma_f32_16x16x32_bf16 v[52:55], v[120:123], v[132:135], v[52:55]
  ds_read_b128 v[104:107], v10 offset:4096
  v_mfma_f32_16x16x32_bf16 v[56:59], v[120:123], v[136:139], v[56:59]
  ds_read_b128 v[92:95], v7 offset:6144
  v_mfma_f32_16x16x32_bf16 v[28:31], v[112:115], v[140:143], v[28:31]
  ds_read_b128 v[108:111], v10 offset:4608
  v_mfma_f32_16x16x32_bf16 v[44:47], v[116:119], v[140:143], v[44:47]
  v_mfma_f32_16x16x32_bf16 v[60:63], v[120:123], v[140:143], v[60:63]
  v_mfma_f32_16x16x32_bf16 v[64:67], v[124:127], v[128:131], v[64:67]
  v_mfma_f32_16x16x32_bf16 v[68:71], v[124:127], v[132:135], v[68:71]
  v_mfma_f32_16x16x32_bf16 v[72:75], v[124:127], v[136:139], v[72:75]
  v_mfma_f32_16x16x32_bf16 v[76:79], v[124:127], v[140:143], v[76:79]
  s_mov_b32 s16, 14
  .p2align 3
g1b_kernel_cloop6:
  s_waitcnt lgkmcnt(6)
  v_mfma_f32_16x16x32_bf16 v[16:19], v[80:83], v[96:99], v[16:19]
  ds_read_b128 v[112:115], v8 offset:1024
  s_waitcnt lgkmcnt(5)
  v_mfma_f32_16x16x32_bf16 v[20:23], v[80:83], v[100:103], v[20:23]
  ds_read_b128 v[128:131], v12 offset:0
  v_mfma_f32_16x16x32_bf16 v[32:35], v[84:87], v[96:99], v[32:35]
  ds_read_b128 v[116:119], v8 offset:3072
  v_mfma_f32_16x16x32_bf16 v[36:39], v[84:87], v[100:103], v[36:39]
  ds_read_b128 v[132:135], v12 offset:512
  s_waitcnt lgkmcnt(6)
  v_mfma_f32_16x16x32_bf16 v[24:27], v[80:83], v[104:107], v[24:27]
  ds_read_b128 v[120:123], v8 offset:5120
  v_mfma_f32_16x16x32_bf16 v[40:43], v[84:87], v[104:107], v[40:43]
  ds_read_b128 v[136:139], v12 offset:4096
  v_mfma_f32_16x16x32_bf16 v[48:51], v[88:91], v[96:99], v[48:51]
  ds_read_b128 v[124:127], v8 offset:7168
  v_mfma_f32_16x16x32_bf16 v[52:55], v[88:91], v[100:103], v[52:55]
  ds_read_b128 v[140:143], v12 offset:4608
  v_mfma_f32_16x16x32_bf16 v[56:59], v[88:91], v[104:107], v[56:59]
  s_add_u32 s15, s15, 32768
  s_cmp_ge_u32 s15, 131072
  s_cselect_b32 s3, 131072, 0
  s_sub_u32 s15, s15, s3
  s_waitcnt lgkmcnt(8)
  v_mfma_f32_16x16x32_bf16 v[28:31], v[80:83], v[108:111], v[28:31]
  v_add_u32 v7, s15, v6
  v_mfma_f32_16x16x32_bf16 v[44:47], v[84:87], v[108:111], v[44:47]
  v_add_u32 v10, s15, v9
  v_mfma_f32_16x16x32_bf16 v[60:63], v[88:91], v[108:111], v[60:63]
  v_mfma_f32_16x16x32_bf16 v[64:67], v[92:95], v[96:99], v[64:67]
  v_mfma_f32_16x16x32_bf16 v[68:71], v[92:95], v[100:103], v[68:71]
  v_mfma_f32_16x16x32_bf16 v[72:75], v[92:95], v[104:107], v[72:75]
  v_mfma_f32_16x16x32_bf16 v[76:79], v[92:95], v[108:111], v[76:79]
  s_waitcnt lgkmcnt(6)
  v_mfma_f32_16x16x32_bf16 v[16:19], v[112:115], v[128:131], v[16:19]
  v_add_u32 v8, s15, v6
  s_waitcnt lgkmcnt(4)
  v_mfma_f32_16x16x32_bf16 v[20:23], v[112:115], v[132:135], v[20:23]
  v_add_u32 v12, s15, v11
  s_waitcnt lgkmcnt(0)
  s_barrier
  v_mfma_f32_16x16x32_bf16 v[32:35], v[116:119], v[128:131], v[32:35]
  ds_read_b128 v[80:83], v7 offset:0
  v_mfma_f32_16x16x32_bf16 v[36:39], v[116:119], v[132:135], v[36:39]
  ds_read_b128 v[96:99], v10 offset:0
  v_mfma_f32_16x16x32_bf16 v[24:27], v[112:115], v[136:139], v[24:27]
  ds_read_b128 v[84:87], v7 offset:2048
  v_mfma_f32_16x16x32_bf16 v[40:43], v[116:119], v[136:139], v[40:43]
  ds_read_b128 v[100:103], v10 offset:512
  v_mfma_f32_16x16x32_bf16 v[48:51], v[120:123], v[128:131], v[48:51]
  ds_read_b128 v[88:91], v7 offset:4096
  v_mfma_f32_16x16x32_bf16 v[52:55], v[120:123], v[132:135], v[52:55]
  ds_read_b128 v[104:107], v10 offset:4096
  v_mfma_f32_16x16x32_bf16 v[56:59], v[120:123], v[136:139], v[56:59]
  ds_read_b128 v[92:95], v7 offset:6144
  v_mfma_f32_16x16x32_bf16 v[28:31], v[112:115], v[140:143], v[28:31]
  ds_read_b128 v[108:111], v10 offset:4608
  v_mfma_f32_16x16x32_bf16 v[44:47], v[116:119], v[140:143], v[44:47]
  v_mfma_f32_16x16x32_bf16 v[60:63], v[120:123], v[140:143], v[60:63]
  v_mfma_f32_16x16x32_bf16 v[64:67], v[124:127], v[128:131], v[64:67]
  v_mfma_f32_16x16x32_bf16 v[68:71], v[124:127], v[132:135], v[68:71]
  v_mfma_f32_16x16x32_bf16 v[72:75], v[124:127], v[136:139], v[72:75]
  v_mfma_f32_16x16x32_bf16 v[76:79], v[124:127], v[140:143], v[76:79]
  s_sub_u32 s16, s16, 1
  s_cmp_lg_u32 s16, 0
  s_cbranch_scc1 g1b_kernel_cloop6
  s_waitcnt lgkmcnt(6)
  v_mfma_f32_16x16x32_bf16 v[16:19], v[80:83], v[96:99], v[16:19]
  ds_read_b128 v[112:115], v8 offset:1024
  s_waitcnt lgkmcnt(5)
  v_mfma_f32_16x16x32_bf16 v[20:23], v[80:83], v[100:103], v[20:23]
  ds_read_b128 v[128:131], v12 offset:0
  v_mfma_f32_16x16x32_bf16 v[32:35], v[84:87], v[96:99], v[32:35]
  ds_read_b128 v[116:119], v8 offset:3072
  v_mfma_f32_16x16x32_bf16 v[36:39], v[84:87], v[100:103], v[36:39]
  ds_read_b128 v[132:135], v12 offset:512
  s_waitcnt lgkmcnt(6)
  v_mfma_f32_16x16x32_bf16 v[24:27], v[80:83], v[104:107], v[24:27]
  ds_read_b128 v[120:123], v8 offset:5120
  v_mfma_f32_16x16x32_bf16 v[40:43], v[84:87], v[104:107], v[40:43]
  ds_read_b128 v[136:139], v12 offset:4096
  v_mfma_f32_16x16x32_bf16 v[48:51], v[88:91], v[96:99], v[48:51]
  ds_read_b128 v[124:127], v8 offset:7168
  v_mfma_f32_16x16x32_bf16 v[52:55], v[88:91], v[100:103], v[52:55]
  ds_read_b128 v[140:143], v12 offset:4608
  v_mfma_f32_16x16x32_bf16 v[56:59], v[88:91], v[104:107], v[56:59]
  s_waitcnt lgkmcnt(8)
  v_mfma_f32_16x16x32_bf16 v[28:31], v[80:83], v[108:111], v[28:31]
  v_mfma_f32_16x16x32_bf16 v[44:47], v[84:87], v[108:111], v[44:47]
  v_mfma_f32_16x16x32_bf16 v[60:63], v[88:91], v[108:111], v[60:63]
  v_mfma_f32_16x16x32_bf16 v[64:67], v[92:95], v[96:99], v[64:67]
  v_mfma_f32_16x16x32_bf16 v[68:71], v[92:95], v[100:103], v[68:71]
  v_mfma_f32_16x16x32_bf16 v[72:75], v[92:95], v[104:107], v[72:75]
  v_mfma_f32_16x16x32_bf16 v[76:79], v[92:95], v[108:111], v[76:79]
  s_waitcnt lgkmcnt(6)
  v_mfma_f32_16x16x32_bf16 v[16:19], v[112:115], v[128:131], v[16:19]
  s_waitcnt lgkmcnt(4)
  v_mfma_f32_16x16x32_bf16 v[20:23], v[112:115], v[132:135], v[20:23]
  v_mfma_f32_16x16x32_bf16 v[32:35], v[116:119], v[128:131], v[32:35]
  v_mfma_f32_16x16x32_bf16 v[36:39], v[116:119], v[132:135], v[36:39]
  s_waitcnt lgkmcnt(2)
  v_mfma_f32_16x16x32_bf16 v[24:27], v[112:115], v[136:139], v[24:27]
  v_mfma_f32_16x16x32_bf16 v[40:43], v[116:119], v[136:139], v[40:43]
  v_mfma_f32_16x16x32_bf16 v[48:51], v[120:123], v[128:131], v[48:51]
  v_mfma_f32_16x16x32_bf16 v[52:55], v[120:123], v[132:135], v[52:55]
  v_mfma_f32_16x16x32_bf16 v[56:59], v[120:123], v[136:139], v[56:59]
  s_waitcnt lgkmcnt(0)
  v_mfma_f32_16x16x32_bf16 v[28:31], v[112:115], v[140:143], v[28:31]
  v_mfma_f32_16x16x32_bf16 v[44:47], v[116:119], v[140:143], v[44:47]
  v_mfma_f32_16x16x32_bf16 v[60:63], v[120:123], v[140:143], v[60:63]
  v_mfma_f32_16x16x32_bf16 v[64:67], v[124:127], v[128:131], v[64:67]
  v_mfma_f32_16x16x32_bf16 v[68:71], v[124:127], v[132:135], v[68:71]
  v_mfma_f32_16x16x32_bf16 v[72:75], v[124:127], v[136:139], v[72:75]
  v_mfma_f32_16x16x32_bf16 v[76:79], v[124:127], v[140:143], v[76:79]
  s_barrier
  v_lshrrev_b32 v2, 4, v0
  v_lshlrev_b32 v2, 5, v2
  s_lshl_b32 s3, s24, 8
  s_add_u32 s3, s3, 131072
  v_add_u32 v2, s3, v2
  ds_read_b128 v[80:83], v2 offset:0
  ds_read_b128 v[96:99], v2 offset:512
  ds_read_b128 v[84:87], v2 offset:16
  ds_read_b128 v[100:103], v2 offset:528
  ds_read_b128 v[88:91], v2 offset:128
  ds_read_b128 v[104:107], v2 offset:640
  ds_read_b128 v[92:95], v2 offset:144
  ds_read_b128 v[108:111], v2 offset:656
  s_and_b32 s3, s13, 7
  s_lshl_b32 s3, s3, 3
  s_lshl_b32 s19, s25, 2
  s_add_u32 s3, s3, s19
  s_lshl_b32 s3, s3, 7
  s_lshr_b32 s19, s13, 3
  s_lshl_b32 s19, s19, 6
  s_add_u32 s3, s3, s19
  s_lshl_b32 s19, s12, 2
  s_add_u32 s3, s3, s19
  s_lshl_b32 s19, s24, 1
  s_add_u32 s3, s3, s19
  s_lshl_b32 s3, s3, 10
  v_lshlrev_b32 v3, 4, v0
  s_waitcnt vmcnt(0) lgkmcnt(0)
  s_add_u32 s26, s3, 0
  v_pk_mul_f32 v[16:17], v[16:17], v[80:81] op_sel:[0,0] op_sel_hi:[1,1]
  v_pk_fma_f32 v[16:17], v[96:97], v[144:145], v[16:17] op_sel:[0,0,0] op_sel_hi:[1,0,1]
  v_pk_mul_f32 v[18:19], v[18:19], v[82:83] op_sel:[0,0] op_sel_hi:[1,1]
  v_pk_fma_f32 v[18:19], v[98:99], v[144:145], v[18:19] op_sel:[0,0,0] op_sel_hi:[1,0,1]
  v_cvt_pk_bf16_f32 v112, v16, v17
  v_cvt_pk_bf16_f32 v113, v18, v19
  v_pk_mul_f32 v[32:33], v[32:33], v[84:85] op_sel:[0,0] op_sel_hi:[1,1]
  v_pk_fma_f32 v[32:33], v[100:101], v[144:145], v[32:33] op_sel:[0,0,0] op_sel_hi:[1,0,1]
  v_pk_mul_f32 v[34:35], v[34:35], v[86:87] op_sel:[0,0] op_sel_hi:[1,1]
  v_pk_fma_f32 v[34:35], v[102:103], v[144:145], v[34:35] op_sel:[0,0,0] op_sel_hi:[1,0,1]
  v_cvt_pk_bf16_f32 v114, v32, v33
  v_cvt_pk_bf16_f32 v115, v34, v35
  buffer_store_dwordx4 v[112:115], v3, s[28:31], s26 offen offset:0 sc0 sc1
  v_pk_mul_f32 v[48:49], v[48:49], v[88:89] op_sel:[0,0] op_sel_hi:[1,1]
  v_pk_fma_f32 v[48:49], v[104:105], v[144:145], v[48:49] op_sel:[0,0,0] op_sel_hi:[1,0,1]
  v_pk_mul_f32 v[50:51], v[50:51], v[90:91] op_sel:[0,0] op_sel_hi:[1,1]
  v_pk_fma_f32 v[50:51], v[106:107], v[144:145], v[50:51] op_sel:[0,0,0] op_sel_hi:[1,0,1]
  v_cvt_pk_bf16_f32 v116, v48, v49
  v_cvt_pk_bf16_f32 v117, v50, v51
  v_pk_mul_f32 v[64:65], v[64:65], v[92:93] op_sel:[0,0] op_sel_hi:[1,1]
  v_pk_fma_f32 v[64:65], v[108:109], v[144:145], v[64:65] op_sel:[0,0,0] op_sel_hi:[1,0,1]
  v_pk_mul_f32 v[66:67], v[66:67], v[94:95] op_sel:[0,0] op_sel_hi:[1,1]
  v_pk_fma_f32 v[66:67], v[110:111], v[144:145], v[66:67] op_sel:[0,0,0] op_sel_hi:[1,0,1]
  v_cvt_pk_bf16_f32 v118, v64, v65
  v_cvt_pk_bf16_f32 v119, v66, v67
  buffer_store_dwordx4 v[116:119], v3, s[28:31], s26 offen offset:1024 sc0 sc1
  s_add_u32 s26, s3, 131072
  v_pk_mul_f32 v[20:21], v[20:21], v[80:81] op_sel:[0,0] op_sel_hi:[1,1]
  v_pk_fma_f32 v[20:21], v[96:97], v[144:145], v[20:21] op_sel:[0,1,0] op_sel_hi:[1,1,1]
  v_pk_mul_f32 v[22:23], v[22:23], v[82:83] op_sel:[0,0] op_sel_hi:[1,1]
  v_pk_fma_f32 v[22:23], v[98:99], v[144:145], v[22:23] op_sel:[0,1,0] op_sel_hi:[1,1,1]
  v_cvt_pk_bf16_f32 v120, v20, v21
  v_cvt_pk_bf16_f32 v121, v22, v23
  v_pk_mul_f32 v[36:37], v[36:37], v[84:85] op_sel:[0,0] op_sel_hi:[1,1]
  v_pk_fma_f32 v[36:37], v[100:101], v[144:145], v[36:37] op_sel:[0,1,0] op_sel_hi:[1,1,1]
  v_pk_mul_f32 v[38:39], v[38:39], v[86:87] op_sel:[0,0] op_sel_hi:[1,1]
  v_pk_fma_f32 v[38:39], v[102:103], v[144:145], v[38:39] op_sel:[0,1,0] op_sel_hi:[1,1,1]
  v_cvt_pk_bf16_f32 v122, v36, v37
  v_cvt_pk_bf16_f32 v123, v38, v39
  buffer_store_dwordx4 v[120:123], v3, s[28:31], s26 offen offset:0 sc0 sc1
  v_pk_mul_f32 v[52:53], v[52:53], v[88:89] op_sel:[0,0] op_sel_hi:[1,1]
  v_pk_fma_f32 v[52:53], v[104:105], v[144:145], v[52:53] op_sel:[0,1,0] op_sel_hi:[1,1,1]
  v_pk_mul_f32 v[54:55], v[54:55], v[90:91] op_sel:[0,0] op_sel_hi:[1,1]
  v_pk_fma_f32 v[54:55], v[106:107], v[144:145], v[54:55] op_sel:[0,1,0] op_sel_hi:[1,1,1]
  v_cvt_pk_bf16_f32 v124, v52, v53
  v_cvt_pk_bf16_f32 v125, v54, v55
  v_pk_mul_f32 v[68:69], v[68:69], v[92:93] op_sel:[0,0] op_sel_hi:[1,1]
  v_pk_fma_f32 v[68:69], v[108:109], v[144:145], v[68:69] op_sel:[0,1,0] op_sel_hi:[1,1,1]
  v_pk_mul_f32 v[70:71], v[70:71], v[94:95] op_sel:[0,0] op_sel_hi:[1,1]
  v_pk_fma_f32 v[70:71], v[110:111], v[144:145], v[70:71] op_sel:[0,1,0] op_sel_hi:[1,1,1]
  v_cvt_pk_bf16_f32 v126, v68, v69
  v_cvt_pk_bf16_f32 v127, v70, v71
  buffer_store_dwordx4 v[124:127], v3, s[28:31], s26 offen offset:1024 sc0 sc1
  s_add_u32 s26, s3, 262144
  v_pk_mul_f32 v[24:25], v[24:25], v[80:81] op_sel:[0,0] op_sel_hi:[1,1]
  v_pk_fma_f32 v[24:25], v[96:97], v[146:147], v[24:25] op_sel:[0,0,0] op_sel_hi:[1,0,1]
  v_pk_mul_f32 v[26:27], v[26:27], v[82:83] op_sel:[0,0] op_sel_hi:[1,1]
  v_pk_fma_f32 v[26:27], v[98:99], v[146:147], v[26:27] op_sel:[0,0,0] op_sel_hi:[1,0,1]
  v_cvt_pk_bf16_f32 v112, v24, v25
  v_cvt_pk_bf16_f32 v113, v26, v27
  v_pk_mul_f32 v[40:41], v[40:41], v[84:85] op_sel:[0,0] op_sel_hi:[1,1]
  v_pk_fma_f32 v[40:41], v[100:101], v[146:147], v[40:41] op_sel:[0,0,0] op_sel_hi:[1,0,1]
  v_pk_mul_f32 v[42:43], v[42:43], v[86:87] op_sel:[0,0] op_sel_hi:[1,1]
  v_pk_fma_f32 v[42:43], v[102:103], v[146:147], v[42:43] op_sel:[0,0,0] op_sel_hi:[1,0,1]
  v_cvt_pk_bf16_f32 v114, v40, v41
  v_cvt_pk_bf16_f32 v115, v42, v43
  buffer_store_dwordx4 v[112:115], v3, s[28:31], s26 offen offset:0 sc0 sc1
  v_pk_mul_f32 v[56:57], v[56:57], v[88:89] op_sel:[0,0] op_sel_hi:[1,1]
  v_pk_fma_f32 v[56:57], v[104:105], v[146:147], v[56:57] op_sel:[0,0,0] op_sel_hi:[1,0,1]
  v_pk_mul_f32 v[58:59], v[58:59], v[90:91] op_sel:[0,0] op_sel_hi:[1,1]
  v_pk_fma_f32 v[58:59], v[106:107], v[146:147], v[58:59] op_sel:[0,0,0] op_sel_hi:[1,0,1]
  v_cvt_pk_bf16_f32 v116, v56, v57
  v_cvt_pk_bf16_f32 v117, v58, v59
  v_pk_mul_f32 v[72:73], v[72:73], v[92:93] op_sel:[0,0] op_sel_hi:[1,1]
  v_pk_fma_f32 v[72:73], v[108:109], v[146:147], v[72:73] op_sel:[0,0,0] op_sel_hi:[1,0,1]
  v_pk_mul_f32 v[74:75], v[74:75], v[94:95] op_sel:[0,0] op_sel_hi:[1,1]
  v_pk_fma_f32 v[74:75], v[110:111], v[146:147], v[74:75] op_sel:[0,0,0] op_sel_hi:[1,0,1]
  v_cvt_pk_bf16_f32 v118, v72, v73
  v_cvt_pk_bf16_f32 v119, v74, v75
  buffer_store_dwordx4 v[116:119], v3, s[28:31], s26 offen offset:1024 sc0 sc1
  s_add_u32 s26, s3, 393216
  v_pk_mul_f32 v[28:29], v[28:29], v[80:81] op_sel:[0,0] op_sel_hi:[1,1]
  v_pk_fma_f32 v[28:29], v[96:97], v[146:147], v[28:29] op_sel:[0,1,0] op_sel_hi:[1,1,1]
  v_pk_mul_f32 v[30:31], v[30:31], v[82:83] op_sel:[0,0] op_sel_hi:[1,1]
  v_pk_fma_f32 v[30:31], v[98:99], v[146:147], v[30:31] op_sel:[0,1,0] op_sel_hi:[1,1,1]
  v_cvt_pk_bf16_f32 v120, v28, v29
  v_cvt_pk_bf16_f32 v121, v30, v31
  v_pk_mul_f32 v[44:45], v[44:45], v[84:85] op_sel:[0,0] op_sel_hi:[1,1]
  v_pk_fma_f32 v[44:45], v[100:101], v[146:147], v[44:45] op_sel:[0,1,0] op_sel_hi:[1,1,1]
  v_pk_mul_f32 v[46:47], v[46:47], v[86:87] op_sel:[0,0] op_sel_hi:[1,1]
  v_pk_fma_f32 v[46:47], v[102:103], v[146:147], v[46:47] op_sel:[0,1,0] op_sel_hi:[1,1,1]
  v_cvt_pk_bf16_f32 v122, v44, v45
  v_cvt_pk_bf16_f32 v123, v46, v47
  buffer_store_dwordx4 v[120:123], v3, s[28:31], s26 offen offset:0 sc0 sc1
  v_pk_mul_f32 v[60:61], v[60:61], v[88:89] op_sel:[0,0] op_sel_hi:[1,1]
  v_pk_fma_f32 v[60:61], v[104:105], v[146:147], v[60:61] op_sel:[0,1,0] op_sel_hi:[1,1,1]
  v_pk_mul_f32 v[62:63], v[62:63], v[90:91] op_sel:[0,0] op_sel_hi:[1,1]
  v_pk_fma_f32 v[62:63], v[106:107], v[146:147], v[62:63] op_sel:[0,1,0] op_sel_hi:[1,1,1]
  v_cvt_pk_bf16_f32 v124, v60, v61
  v_cvt_pk_bf16_f32 v125, v62, v63
  v_pk_mul_f32 v[76:77], v[76:77], v[92:93] op_sel:[0,0] op_sel_hi:[1,1]
  v_pk_fma_f32 v[76:77], v[108:109], v[146:147], v[76:77] op_sel:[0,1,0] op_sel_hi:[1,1,1]
  v_pk_mul_f32 v[78:79], v[78:79], v[94:95] op_sel:[0,0] op_sel_hi:[1,1]
  v_pk_fma_f32 v[78:79], v[110:111], v[146:147], v[78:79] op_sel:[0,1,0] op_sel_hi:[1,1,1]
  v_cvt_pk_bf16_f32 v126, v76, v77
  v_cvt_pk_bf16_f32 v127, v78, v79
  buffer_store_dwordx4 v[124:127], v3, s[28:31], s26 offen offset:1024 sc0 sc1
g1b_kernel_fin:
  s_load_dwordx2 s[96:97], s[0:1], 96
  s_cmp_lg_u32 s90, 0
  s_cselect_b32 s19, 0, 4
  s_lshl_b32 s19, s19, 15
  s_lshl_b32 s3, s13, 4
  s_add_u32 s3, s3, s12
  s_lshl_b32 s3, s3, 7
  s_add_u32 s3, s3, s19
  v_mov_b32 v2, 0
  v_mov_b32 v3, 1
  s_waitcnt lgkmcnt(0)
  s_add_u32 s96, s96, 63963136
  s_addc_u32 s97, s97, 0
  s_mov_b32 s98, 262144
  s_mov_b32 s99, 0x20000
  s_waitcnt vmcnt(0)
  s_barrier
  s_cmp_lg_u32 s14, 0
  s_cbranch_scc1 g1b_kernel_nb7
  buffer_store_dword v3, v2, s[96:99], s3 offen sc1
g1b_kernel_nb7:
  s_branch g2_kernel_fe
g1b_kernel_end:
  s_endpgm
.globl g2_kernel
.p2align 8
.type g2_kernel,@function
g2_kernel:
  s_mov_b32 s90, 1
  s_mov_b32 s86, 0
g2_kernel_body:
  s_cmp_ge_u32 s2, 256
  s_cbranch_scc1 g2_kernel_end
  v_lshrrev_b32 v1, 6, v0
  v_and_b32 v0, 63, v0
  v_readfirstlane_b32 s14, v1
g2_kernel_fe:
  s_load_dwordx2 s[4:5], s[0:1], 96
  s_load_dwordx2 s[8:9], s[0:1], 8
  s_load_dwordx2 s[22:23], s[0:1], 16
  s_cmp_lg_u32 s90, 0
  s_cselect_b32 s87, 3, 3
  s_cmp_lg_u32 s90, 0
  s_cselect_b32 s88, 1, 1
  s_cmp_lg_u32 s90, 0
  s_cselect_b32 s89, 1, 1
  s_and_b32 s3, s2, 7
  s_lshr_b32 s16, s2, 3
  s_and_b32 s12, s3, 3
  s_mul_i32 s12, s12, 4
  s_lshr_b32 s13, s3, 2
  s_mul_i32 s13, s13, 8
  s_and_b32 s3, s16, 3
  s_add_u32 s12, s12, s3
  s_lshr_b32 s16, s16, 2
  s_add_u32 s13, s13, s16
  s_mov_b32 s15, 0
  s_cmp_lt_u32 s14, 4
  s_cbranch_scc1 g2_kernel_comp
  s_sub_u32 s24, s14, 4
  s_setprio 2
  s_and_b32 s3, s12, 7
  s_mul_i32 s82, s3, 1048576
  s_lshr_b32 s3, s12, 3
  s_mul_i32 s3, s3, 65536
  s_add_u32 s82, s82, s3
  s_lshr_b32 s3, s24, 1
  s_mul_i32 s3, s3, 131072
  s_add_u32 s82, s82, s3
  s_and_b32 s3, s24, 1
  s_lshl_b32 s3, s3, 10
  s_add_u32 s82, s82, s3
  s_mul_i32 s84, s24, 1024
  v_lshlrev_b32 v6, 4, v0
  v_add_u32 v6, s82, v6
  s_mul_i32 s83, s13, 524288
  s_lshr_b32 s3, s12, 3
  s_mul_i32 s97, s3, 131072
  s_mul_i32 s3, s24, 32768
  s_add_u32 s83, s83, s3
  s_mul_i32 s85, s24, 1024
  s_add_u32 s85, s85, 16384
  v_lshrrev_b32 v7, 3, v0
  v_lshlrev_b32 v7, 12, v7
  v_lshrrev_b32 v3, 4, v0
  v_and_b32 v3, 1, v3
  v_xor_b32 v2, v0, v3
  v_and_b32 v2, 7, v2
  v_lshlrev_b32 v2, 4, v2
  v_add_u32 v7, v7, v2
  s_lshl_b32 s3, s24, 5
  v_xor_b32 v7, s3, v7
  v_add_u32 v7, s83, v7
  s_mov_b32 s17, 0
  s_mov_b32 s18, 0
  s_mov_b32 s80, 0
  s_mul_i32 s81, s12, s88
  s_mul_i32 s3, s13, s89
  s_add_u32 s81, s81, s3
  s_mov_b32 s16, 0
  s_waitcnt lgkmcnt(0)
  s_add_u32 s4, s4, 8388608
  s_addc_u32 s5, s5, 0
  s_cmp_eq_u32 s90, 0
  s_cselect_b32 s6, 67108864, 0
  s_add_u32 s4, s4, s6
  s_addc_u32 s5, s5, 0
  s_mov_b32 s6, 8388608
  s_mov_b32 s7, 0x20000
  s_mov_b32 s10, 8388608
  s_mov_b32 s11, 0x20000
  s_lshr_b32 s3, s12, 3
  s_cmp_ge_u32 s3, 1
  s_cselect_b32 s8, s22, s8
  s_cselect_b32 s9, s23, s9
  s_add_u32 s3, s80, s81
  s_and_b32 s3, s3, s87
  s_andn2_b32 s19, s80, s87
  s_or_b32 s3, s3, s19
  s_mul_i32 s17, s3, 2048
  s_mul_i32 s18, s3, 128
  s_cmp_lg_u32 s90, 0
  s_cbranch_scc1 g2_kernel_nsg3
  s_barrier
g2_kernel_nsg3:
  s_add_u32 s26, s15, s85
  s_mov_b32 m0, s26
  s_add_u32 s27, s18, 0
  s_add_u32 s27, s27, s97
  buffer_load_dwordx4 v7, s[8:11], s27 offen lds
  s_add_u32 m0, s26, 4096
  s_add_u32 s27, s18, 131072
  s_sub_u32 s27, s27, s97
  buffer_load_dwordx4 v7, s[8:11], s27 offen lds
  s_add_u32 m0, s26, 8192
  s_add_u32 s27, s18, 262144
  s_add_u32 s27, s27, s97
  buffer_load_dwordx4 v7, s[8:11], s27 offen lds
  s_add_u32 m0, s26, 12288
  s_add_u32 s27, s18, 393216
  s_sub_u32 s27, s27, s97
  buffer_load_dwordx4 v7, s[8:11], s27 offen lds
  s_add_u32 s15, s15, 32768
  s_cmp_eq_u32 s15, 131072
  s_cselect_b32 s15, 0, s15
  s_add_u32 s80, s80, 1
  s_add_u32 s3, s80, s81
  s_and_b32 s3, s3, s87
  s_andn2_b32 s19, s80, s87
  s_or_b32 s3, s3, s19
  s_mul_i32 s17, s3, 2048
  s_mul_i32 s18, s3, 128
  s_add_u32 s26, s15, s85
  s_mov_b32 m0, s26
  s_add_u32 s27, s18, 0
  s_add_u32 s27, s27, s97
  buffer_load_dwordx4 v7, s[8:11], s27 offen lds
  s_add_u32 m0, s26, 4096
  s_add_u32 s27, s18, 131072
  s_sub_u32 s27, s27, s97
  buffer_load_dwordx4 v7, s[8:11], s27 offen lds
  s_add_u32 m0, s26, 8192
  s_add_u32 s27, s18, 262144
  s_add_u32 s27, s27, s97
  buffer_load_dwordx4 v7, s[8:11], s27 offen lds
  s_add_u32 m0, s26, 12288
  s_add_u32 s27, s18, 393216
  s_sub_u32 s27, s27, s97
  buffer_load_dwordx4 v7, s[8:11], s27 offen lds
  s_add_u32 s15, s15, 32768
  s_cmp_eq_u32 s15, 131072
  s_cselect_b32 s15, 0, s15
  s_add_u32 s80, s80, 1
  s_add_u32 s3, s80, s81
  s_and_b32 s3, s3, s87
  s_andn2_b32 s19, s80, s87
  s_or_b32 s3, s3, s19
  s_mul_i32 s17, s3, 2048
  s_mul_i32 s18, s3, 128
  s_add_u32 s26, s15, s85
  s_mov_b32 m0, s26
  s_add_u32 s27, s18, 0
  s_add_u32 s27, s27, s97
  buffer_load_dwordx4 v7, s[8:11], s27 offen lds
  s_add_u32 m0, s26, 4096
  s_add_u32 s27, s18, 131072
  s_sub_u32 s27, s27, s97
  buffer_load_dwordx4 v7, s[8:11], s27 offen lds
  s_add_u32 m0, s26, 8192
  s_add_u32 s27, s18, 262144
  s_add_u32 s27, s27, s97
  buffer_load_dwordx4 v7, s[8:11], s27 offen lds
  s_add_u32 m0, s26, 12288
  s_add_u32 s27, s18, 393216
  s_sub_u32 s27, s27, s97
  buffer_load_dwordx4 v7, s[8:11], s27 offen lds
  s_add_u32 s15, s15, 32768
  s_cmp_eq_u32 s15, 131072
  s_cselect_b32 s15, 0, s15
  s_add_u32 s80, s80, 1
  s_add_u32 s3, s80, s81
  s_and_b32 s3, s3, s87
  s_andn2_b32 s19, s80, s87
  s_or_b32 s3, s3, s19
  s_mul_i32 s17, s3, 2048
  s_mul_i32 s18, s3, 128
  s_mov_b32 s15, 0
  s_mov_b32 s17, 0
  s_mov_b32 s18, 0
  s_mov_b32 s80, 0
  s_add_u32 s3, s80, s81
  s_and_b32 s3, s3, s87
  s_andn2_b32 s19, s80, s87
  s_or_b32 s3, s3, s19
  s_mul_i32 s17, s3, 2048
  s_mul_i32 s18, s3, 128
  s_load_dwordx2 s[28:29], s[0:1], 96
  v_and_b32 v2, 15, v0
  v_lshlrev_b32 v2, 7, v2
  s_cmp_lg_u32 s90, 0
  s_cselect_b32 s32, 0, 4
  s_lshl_b32 s32, s32, 15
  s_lshl_b32 s3, s12, 8
  s_lshr_b32 s3, s3, 4
  s_lshl_b32 s3, s3, 7
  s_add_u32 s32, s32, s3
  s_mov_b32 s33, 0
  s_waitcnt lgkmcnt(0)
  s_add_u32 s28, s28, 63963136
  s_addc_u32 s29, s29, 0
  s_mov_b32 s30, 262144
  s_mov_b32 s31, 0x20000
  s_cmp_lg_u32 s90, 0
  s_cbranch_scc1 g2_kernel_dd5
  s_cmp_lg_u32 s24, 0
  s_cbranch_scc1 g2_kernel_dd5
g2_kernel_dp4:
  buffer_load_dword v8, v2, s[28:31], s32 offen sc1
  s_add_u32 s33, s33, 1
  s_waitcnt vmcnt(0)
  v_cmp_eq_u32 vcc, -1, v8
  s_cmp_ge_u32 s33, 0x8000
  s_cbranch_vccz g2_kernel_dd5
  s_cbranch_scc0 g2_kernel_dp4
g2_kernel_dd5:
  s_barrier
  s_add_u32 s26, s15, s84
  s_mov_b32 m0, s26
  s_nop 0
  buffer_load_dwordx4 v6, s[4:7], s17 offen lds
  s_add_u32 m0, s26, 4096
  s_add_u32 s27, s17, 262144
  buffer_load_dwordx4 v6, s[4:7], s27 offen lds
  s_add_u32 m0, s26, 8192
  s_add_u32 s27, s17, 524288
  buffer_load_dwordx4 v6, s[4:7], s27 offen lds
  s_add_u32 m0, s26, 12288
  s_add_u32 s27, s17, 786432
  buffer_load_dwordx4 v6, s[4:7], s27 offen lds
  s_add_u32 s15, s15, 32768
  s_cmp_eq_u32 s15, 131072
  s_cselect_b32 s15, 0, s15
  s_add_u32 s80, s80, 1
  s_add_u32 s3, s80, s81
  s_and_b32 s3, s3, s87
  s_andn2_b32 s19, s80, s87
  s_or_b32 s3, s3, s19
  s_mul_i32 s17, s3, 2048
  s_mul_i32 s18, s3, 128
  s_add_u32 s26, s15, s84
  s_mov_b32 m0, s26
  s_nop 0
  buffer_load_dwordx4 v6, s[4:7], s17 offen lds
  s_add_u32 m0, s26, 4096
  s_add_u32 s27, s17, 262144
  buffer_load_dwordx4 v6, s[4:7], s27 offen lds
  s_add_u32 m0, s26, 8192
  s_add_u32 s27, s17, 524288
  buffer_load_dwordx4 v6, s[4:7], s27 offen lds
  s_add_u32 m0, s26, 12288
  s_add_u32 s27, s17, 786432
  buffer_load_dwordx4 v6, s[4:7], s27 offen lds
  s_add_u32 s15, s15, 32768
  s_cmp_eq_u32 s15, 131072
  s_cselect_b32 s15, 0, s15
  s_add_u32 s80, s80, 1
  s_add_u32 s3, s80, s81
  s_and_b32 s3, s3, s87
  s_andn2_b32 s19, s80, s87
  s_or_b32 s3, s3, s19
  s_mul_i32 s17, s3, 2048
  s_mul_i32 s18, s3, 128
  s_add_u32 s26, s15, s84
  s_mov_b32 m0, s26
  s_nop 0
  buffer_load_dwordx4 v6, s[4:7], s17 offen lds
  s_add_u32 m0, s26, 4096
  s_add_u32 s27, s17, 262144
  buffer_load_dwordx4 v6, s[4:7], s27 offen lds
  s_add_u32 m0, s26, 8192
  s_add_u32 s27, s17, 524288
  buffer_load_dwordx4 v6, s[4:7], s27 offen lds
  s_add_u32 m0, s26, 12288
  s_add_u32 s27, s17, 786432
  buffer_load_dwordx4 v6, s[4:7], s27 offen lds
  s_add_u32 s15, s15, 32768
  s_cmp_eq_u32 s15, 131072
  s_cselect_b32 s15, 0, s15
  s_add_u32 s80, s80, 1
  s_add_u32 s3, s80, s81
  s_and_b32 s3, s3, s87
  s_andn2_b32 s19, s80, s87
  s_or_b32 s3, s3, s19
  s_mul_i32 s17, s3, 2048
  s_mul_i32 s18, s3, 128
  s_waitcnt vmcnt(8)
  s_barrier
  s_add_u32 s26, s15, s84
  s_mov_b32 m0, s26
  s_nop 0
  buffer_load_dwordx4 v6, s[4:7], s17 offen lds
  s_add_u32 m0, s26, 4096
  s_add_u32 s27, s17, 262144
  buffer_load_dwordx4 v6, s[4:7], s27 offen lds
  s_add_u32 m0, s26, 8192
  s_add_u32 s27, s17, 524288
  buffer_load_dwordx4 v6, s[4:7], s27 offen lds
  s_add_u32 m0, s26, 12288
  s_add_u32 s27, s17, 786432
  buffer_load_dwordx4 v6, s[4:7], s27 offen lds
  s_add_u32 s26, s15, s85
  s_mov_b32 m0, s26
  s_add_u32 s27, s18, 0
  s_add_u32 s27, s27, s97
  buffer_load_dwordx4 v7, s[8:11], s27 offen lds
  s_add_u32 m0, s26, 4096
  s_add_u32 s27, s18, 131072
  s_sub_u32 s27, s27, s97
  buffer_load_dwordx4 v7, s[8:11], s27 offen lds
  s_add_u32 m0, s26, 8192
  s_add_u32 s27, s18, 262144
  s_add_u32 s27, s27, s97
  buffer_load_dwordx4 v7, s[8:11], s27 offen lds
  s_add_u32 m0, s26, 12288
  s_add_u32 s27, s18, 393216
  s_sub_u32 s27, s27, s97
  buffer_load_dwordx4 v7, s[8:11], s27 offen lds
  s_add_u32 s15, s15, 32768
  s_cmp_eq_u32 s15, 131072
  s_cselect_b32 s15, 0, s15
  s_add_u32 s80, s80, 1
  s_add_u32 s3, s80, s81
  s_and_b32 s3, s3, s87
  s_andn2_b32 s19, s80, s87
  s_or_b32 s3, s3, s19
  s_mul_i32 s17, s3, 2048
  s_mul_i32 s18, s3, 128
  s_waitcnt vmcnt(12)
  s_barrier
  s_add_u32 s26, s15, s84
  s_mov_b32 m0, s26
  s_nop 0
  buffer_load_dwordx4 v6, s[4:7], s17 offen lds
  s_add_u32 m0, s26, 4096
  s_add_u32 s27, s17, 262144
  buffer_load_dwordx4 v6, s[4:7], s27 offen lds
  s_add_u32 m0, s26, 8192
  s_add_u32 s27, s17, 524288
  buffer_load_dwordx4 v6, s[4:7], s27 offen lds
  s_add_u32 m0, s26, 12288
  s_add_u32 s27, s17, 786432
  buffer_load_dwordx4 v6, s[4:7], s27 offen lds
  s_add_u32 s26, s15, s85
  s_mov_b32 m0, s26
  s_add_u32 s27, s18, 0
  s_add_u32 s27, s27, s97
  buffer_load_dwordx4 v7, s[8:11], s27 offen lds
  s_add_u32 m0, s26, 4096
  s_add_u32 s27, s18, 131072
  s_sub_u32 s27, s27, s97
  buffer_load_dwordx4 v7, s[8:11], s27 offen lds
  s_add_u32 m0, s26, 8192
  s_add_u32 s27, s18, 262144
  s_add_u32 s27, s27, s97
  buffer_load_dwordx4 v7, s[8:11], s27 offen lds
  s_add_u32 m0, s26, 12288
  s_add_u32 s27, s18, 393216
  s_sub_u32 s27, s27, s97
  buffer_load_dwordx4 v7, s[8:11], s27 offen lds
  s_add_u32 s15, s15, 32768
  s_cmp_eq_u32 s15, 131072
  s_cselect_b32 s15, 0, s15
  s_add_u32 s80, s80, 1
  s_add_u32 s3, s80, s81
  s_and_b32 s3, s3, s87
  s_andn2_b32 s19, s80, s87
  s_or_b32 s3, s3, s19
  s_mul_i32 s17, s3, 2048
  s_mul_i32 s18, s3, 128
  s_mov_b32 s16, 5
g2_kernel_ldloop1:
  s_waitcnt vmcnt(16)
  s_barrier
g2_kernel_ldissue2:
  s_add_u32 s26, s15, s84
  s_mov_b32 m0, s26
  s_nop 0
  buffer_load_dwordx4 v6, s[4:7], s17 offen lds
  s_add_u32 m0, s26, 4096
  s_add_u32 s27, s17, 262144
  buffer_load_dwordx4 v6, s[4:7], s27 offen lds
  s_add_u32 m0, s26, 8192
  s_add_u32 s27, s17, 524288
  buffer_load_dwordx4 v6, s[4:7], s27 offen lds
  s_add_u32 m0, s26, 12288
  s_add_u32 s27, s17, 786432
  buffer_load_dwordx4 v6, s[4:7], s27 offen lds
  s_add_u32 s26, s15, s85
  s_mov_b32 m0, s26
  s_add_u32 s27, s18, 0
  s_add_u32 s27, s27, s97
  buffer_load_dwordx4 v7, s[8:11], s27 offen lds
  s_add_u32 m0, s26, 4096
  s_add_u32 s27, s18, 131072
  s_sub_u32 s27, s27, s97
  buffer_load_dwordx4 v7, s[8:11], s27 offen lds
  s_add_u32 m0, s26, 8192
  s_add_u32 s27, s18, 262144
  s_add_u32 s27, s27, s97
  buffer_load_dwordx4 v7, s[8:11], s27 offen lds
  s_add_u32 m0, s26, 12288
  s_add_u32 s27, s18, 393216
  s_sub_u32 s27, s27, s97
  buffer_load_dwordx4 v7, s[8:11], s27 offen lds
  s_add_u32 s15, s15, 32768
  s_cmp_eq_u32 s15, 131072
  s_cselect_b32 s15, 0, s15
  s_add_u32 s80, s80, 1
  s_add_u32 s3, s80, s81
  s_and_b32 s3, s3, s87
  s_andn2_b32 s19, s80, s87
  s_or_b32 s3, s3, s19
  s_mul_i32 s17, s3, 2048
  s_mul_i32 s18, s3, 128
  s_add_u32 s16, s16, 1
  s_cmp_lt_u32 s16, 32
  s_cbranch_scc1 g2_kernel_ldloop1
  s_waitcnt vmcnt(16)
  s_barrier
  s_waitcnt vmcnt(8)
  s_barrier
  s_waitcnt vmcnt(0)
  s_barrier
  s_barrier
  s_lshl_b32 s86, s13, 4
  s_add_u32 s86, s86, s12
  s_lshl_b32 s86, s86, 7
  s_branch g3_kernel_fe
g2_kernel_comp:
  s_load_dwordx2 s[28:29], s[0:1], 96
  s_load_dwordx2 s[32:33], s[0:1], 96
  s_load_dwordx2 s[72:73], s[0:1], 96
  s_load_dwordx2 s[36:37], s[0:1], 0
  s_load_dwordx2 s[64:65], s[0:1], 96
  s_load_dwordx2 s[68:69], s[0:1], 96
  s_and_b32 s24, s14, 1
  s_lshr_b32 s25, s14, 1
  v_lshlrev_b32 v6, 4, v0
  s_mul_i32 s3, s24, 8192
  v_add_u32 v6, s3, v6
  v_mov_b32 v7, v6
  v_mov_b32 v8, v6
  v_and_b32 v9, 15, v0
  v_and_b32 v2, 15, v0
  v_and_b32 v2, 12, v2
  v_add_u32 v9, v9, v2
  v_lshlrev_b32 v9, 7, v9
  v_lshrrev_b32 v2, 4, v0
  v_and_b32 v3, 15, v0
  v_and_b32 v4, 15, v0
  v_and_b32 v4, 12, v4
  v_add_u32 v3, v3, v4
  v_lshrrev_b32 v3, 1, v3
  v_and_b32 v3, 1, v3
  v_and_b32 v4, 15, v0
  v_and_b32 v5, 15, v0
  v_and_b32 v5, 12, v5
  v_add_u32 v4, v4, v5
  v_lshrrev_b32 v4, 2, v4
  v_and_b32 v4, 6, v4
  v_add_u32 v3, v3, v4
  v_xor_b32 v2, v2, v3
  v_and_b32 v2, 7, v2
  v_lshlrev_b32 v2, 4, v2
  v_add_u32 v9, v9, v2
  s_mul_i32 s3, s25, 8192
  s_add_u32 s3, s3, 16384
  v_add_u32 v9, s3, v9
  v_mov_b32 v10, v9
  v_and_b32 v11, 15, v0
  v_and_b32 v2, 15, v0
  v_and_b32 v2, 12, v2
  v_add_u32 v11, v11, v2
  v_lshlrev_b32 v11, 7, v11
  v_lshrrev_b32 v2, 4, v0
  v_xor_b32 v2, 4, v2
  v_and_b32 v3, 15, v0
  v_and_b32 v4, 15, v0
  v_and_b32 v4, 12, v4
  v_add_u32 v3, v3, v4
  v_lshrrev_b32 v3, 1, v3
  v_and_b32 v3, 1, v3
  v_and_b32 v4, 15, v0
  v_and_b32 v5, 15, v0
  v_and_b32 v5, 12, v5
  v_add_u32 v4, v4, v5
  v_lshrrev_b32 v4, 2, v4
  v_and_b32 v4, 6, v4
  v_add_u32 v3, v3, v4
  v_xor_b32 v2, v2, v3
  v_and_b32 v2, 7, v2
  v_lshlrev_b32 v2, 4, v2
  v_add_u32 v11, v11, v2
  s_mul_i32 s3, s25, 8192
  s_add_u32 s3, s3, 16384
  v_add_u32 v11, s3, v11
  v_mov_b32 v12, v11
  s_waitcnt lgkmcnt(0)
  s_cmp_eq_u32 s90, 0
  s_cselect_b32 s30, 58720256, 0
  s_add_u32 s28, s28, s30
  s_addc_u32 s29, s29, 0
  s_mov_b32 s30, 4194304
  s_mov_b32 s31, 0x20000
  s_add_u32 s32, s32, 41943040
  s_addc_u32 s33, s33, 0
  s_cmp_eq_u32 s90, 0
  s_cselect_b32 s34, 23068672, 0
  s_add_u32 s32, s32, s34
  s_addc_u32 s33, s33, 0
  s_mov_b32 s34, 262144
  s_mov_b32 s35, 0x20000
  s_add_u32 s72, s72, 67108864
  s_addc_u32 s73, s73, 0
  s_mov_b32 s74, 4194304
  s_mov_b32 s75, 0x20000
  s_mov_b32 s38, 4194304
  s_mov_b32 s39, 0x20000
  s_add_u32 s64, s64, 54525952
  s_addc_u32 s65, s65, 0
  s_mov_b32 s66, 4194304
  s_mov_b32 s67, 0x20000
  s_and_b32 s60, s12, 7
  s_lshr_b32 s62, s12, 3
  s_lshl_b32 s61, s13, 2
  s_lshl_b32 s19, s25, 1
  s_add_u32 s61, s61, s19
  s_add_u32 s61, s61, s62
  s_mul_i32 s63, s13, 8
  s_add_u32 s63, s63, s60
  s_lshl_b32 s63, s63, 1
  s_add_u32 s63, s63, s62
  s_lshl_b32 s63, s63, 2
  s_add_u32 s63, s63, s14
  s_lshl_b32 s56, s61, 6
  s_mul_i32 s19, s60, 4
  s_add_u32 s56, s56, s19
  s_mul_i32 s19, s24, 2
  s_add_u32 s56, s56, s19
  s_lshl_b32 s56, s56, 10
  v_lshlrev_b32 v160, 4, v0
  s_add_u32 s68, s68, 42991616
  s_addc_u32 s69, s69, 0
  s_mov_b32 s70, 524288
  s_mov_b32 s71, 0x20000
  v_lshlrev_b32 v84, 3, v0
  v_mov_b32 v80, -1
  v_mov_b32 v81, -1
  s_lshl_b32 s3, s13, 4
  s_add_u32 s3, s3, s12
  s_lshl_b32 s3, s3, 2
  s_add_u32 s3, s3, s14
  s_lshl_b32 s3, s3, 9
  buffer_store_dwordx2 v[80:81], v84, s[68:71], s3 offen offset:0 sc0 sc1
  s_waitcnt lgkmcnt(0)
  s_barrier
  s_barrier
  ds_read_b128 v[80:83], v7 offset:0
  ds_read_b128 v[96:99], v10 offset:0
  ds_read_b128 v[84:87], v7 offset:2048
  ds_read_b128 v[100:103], v10 offset:512
  ds_read_b128 v[88:91], v7 offset:4096
  ds_read_b128 v[104:107], v10 offset:4096
  ds_read_b128 v[92:95], v7 offset:6144
  ds_read_b128 v[108:111], v10 offset:4608
  s_waitcnt lgkmcnt(6)
  v_mfma_f32_16x16x32_bf16 v[16:19], v[80:83], v[96:99], 0
  ds_read_b128 v[112:115], v8 offset:1024
  s_waitcnt lgkmcnt(5)
  v_mfma_f32_16x16x32_bf16 v[20:23], v[80:83], v[100:103], 0
  ds_read_b128 v[128:131], v12 offset:0
  v_mfma_f32_16x16x32_bf16 v[32:35], v[84:87], v[96:99], 0
  ds_read_b128 v[116:119], v8 offset:3072
  v_mfma_f32_16x16x32_bf16 v[36:39], v[84:87], v[100:103], 0
  ds_read_b128 v[132:135], v12 offset:512
  s_waitcnt lgkmcnt(6)
  v_mfma_f32_16x16x32_bf16 v[24:27], v[80:83], v[104:107], 0
  ds_read_b128 v[120:123], v8 offset:5120
  v_mfma_f32_16x16x32_bf16 v[40:43], v[84:87], v[104:107], 0
  ds_read_b128 v[136:139], v12 offset:4096
  v_mfma_f32_16x16x32_bf16 v[48:51], v[88:91], v[96:99], 0
  ds_read_b128 v[124:127], v8 offset:7168
  v_mfma_f32_16x16x32_bf16 v[52:55], v[88:91], v[100:103], 0
  ds_read_b128 v[140:143], v12 offset:4608
  v_mfma_f32_16x16x32_bf16 v[56:59], v[88:91], v[104:107], 0
  s_add_u32 s15, s15, 32768
  s_cmp_ge_u32 s15, 131072
  s_cselect_b32 s3, 131072, 0
  s_sub_u32 s15, s15, s3
  s_waitcnt lgkmcnt(8)
  v_mfma_f32_16x16x32_bf16 v[28:31], v[80:83], v[108:111], 0
  v_add_u32 v7, s15, v6
  v_mfma_f32_16x16x32_bf16 v[44:47], v[84:87], v[108:111], 0
  v_add_u32 v10, s15, v9
  v_mfma_f32_16x16x32_bf16 v[60:63], v[88:91], v[108:111], 0
  v_mfma_f32_16x16x32_bf16 v[64:67], v[92:95], v[96:99], 0
  v_mfma_f32_16x16x32_bf16 v[68:71], v[92:95], v[100:103], 0
  v_mfma_f32_16x16x32_bf16 v[72:75], v[92:95], v[104:107], 0
  v_mfma_f32_16x16x32_bf16 v[76:79], v[92:95], v[108:111], 0
  s_waitcnt lgkmcnt(6)
  v_mfma_f32_16x16x32_bf16 v[16:19], v[112:115], v[128:131], v[16:19]
  v_add_u32 v8, s15, v6
  s_waitcnt lgkmcnt(4)
  v_mfma_f32_16x16x32_bf16 v[20:23], v[112:115], v[132:135], v[20:23]
  v_add_u32 v12, s15, v11
  s_waitcnt lgkmcnt(0)
  s_barrier
  v_mfma_f32_16x16x32_bf16 v[32:35], v[116:119], v[128:131], v[32:35]
  ds_read_b128 v[80:83], v7 offset:0
  v_mfma_f32_16x16x32_bf16 v[36:39], v[116:119], v[132:135], v[36:39]
  ds_read_b128 v[96:99], v10 offset:0
  v_mfma_f32_16x16x32_bf16 v[24:27], v[112:115], v[136:139], v[24:27]
  ds_read_b128 v[84:87], v7 offset:2048
  v_mfma_f32_16x16x32_bf16 v[40:43], v[116:119], v[136:139], v[40:43]
  ds_read_b128 v[100:103], v10 offset:512
  v_mfma_f32_16x16x32_bf16 v[48:51], v[120:123], v[128:131], v[48:51]
  ds_read_b128 v[88:91], v7 offset:4096
  v_mfma_f32_16x16x32_bf16 v[52:55], v[120:123], v[132:135], v[52:55]
  ds_read_b128 v[104:107], v10 offset:4096
  v_mfma_f32_16x16x32_bf16 v[56:59], v[120:123], v[136:139], v[56:59]
  ds_read_b128 v[92:95], v7 offset:6144
  v_mfma_f32_16x16x32_bf16 v[28:31], v[112:115], v[140:143], v[28:31]
  ds_read_b128 v[108:111], v10 offset:4608
  v_mfma_f32_16x16x32_bf16 v[44:47], v[116:119], v[140:143], v[44:47]
  v_mfma_f32_16x16x32_bf16 v[60:63], v[120:123], v[140:143], v[60:63]
  v_mfma_f32_16x16x32_bf16 v[64:67], v[124:127], v[128:131], v[64:67]
  v_mfma_f32_16x16x32_bf16 v[68:71], v[124:127], v[132:135], v[68:71]
  v_mfma_f32_16x16x32_bf16 v[72:75], v[124:127], v[136:139], v[72:75]
  v_mfma_f32_16x16x32_bf16 v[76:79], v[124:127], v[140:143], v[76:79]
  s_mov_b32 s16, 30
  .p2align 3
g2_kernel_cloop6:
  s_waitcnt lgkmcnt(6)
  v_mfma_f32_16x16x32_bf16 v[16:19], v[80:83], v[96:99], v[16:19]
  ds_read_b128 v[112:115], v8 offset:1024
  s_waitcnt lgkmcnt(5)
  v_mfma_f32_16x16x32_bf16 v[20:23], v[80:83], v[100:103], v[20:23]
  ds_read_b128 v[128:131], v12 offset:0
  v_mfma_f32_16x16x32_bf16 v[32:35], v[84:87], v[96:99], v[32:35]
  ds_read_b128 v[116:119], v8 offset:3072
  v_mfma_f32_16x16x32_bf16 v[36:39], v[84:87], v[100:103], v[36:39]
  ds_read_b128 v[132:135], v12 offset:512
  s_waitcnt lgkmcnt(6)
  v_mfma_f32_16x16x32_bf16 v[24:27], v[80:83], v[104:107], v[24:27]
  ds_read_b128 v[120:123], v8 offset:5120
  v_mfma_f32_16x16x32_bf16 v[40:43], v[84:87], v[104:107], v[40:43]
  ds_read_b128 v[136:139], v12 offset:4096
  v_mfma_f32_16x16x32_bf16 v[48:51], v[88:91], v[96:99], v[48:51]
  ds_read_b128 v[124:127], v8 offset:7168
  v_mfma_f32_16x16x32_bf16 v[52:55], v[88:91], v[100:103], v[52:55]
  ds_read_b128 v[140:143], v12 offset:4608
  v_mfma_f32_16x16x32_bf16 v[56:59], v[88:91], v[104:107], v[56:59]
  s_add_u32 s15, s15, 32768
  s_cmp_ge_u32 s15, 131072
  s_cselect_b32 s3, 131072, 0
  s_sub_u32 s15, s15, s3
  s_waitcnt lgkmcnt(8)
  v_mfma_f32_16x16x32_bf16 v[28:31], v[80:83], v[108:111], v[28:31]
  v_add_u32 v7, s15, v6
  v_mfma_f32_16x16x32_bf16 v[44:47], v[84:87], v[108:111], v[44:47]
  v_add_u32 v10, s15, v9
  v_mfma_f32_16x16x32_bf16 v[60:63], v[88:91], v[108:111], v[60:63]
  v_mfma_f32_16x16x32_bf16 v[64:67], v[92:95], v[96:99], v[64:67]
  v_mfma_f32_16x16x32_bf16 v[68:71], v[92:95], v[100:103], v[68:71]
  v_mfma_f32_16x16x32_bf16 v[72:75], v[92:95], v[104:107], v[72:75]
  v_mfma_f32_16x16x32_bf16 v[76:79], v[92:95], v[108:111], v[76:79]
  s_waitcnt lgkmcnt(6)
  v_mfma_f32_16x16x32_bf16 v[16:19], v[112:115], v[128:131], v[16:19]
  v_add_u32 v8, s15, v6
  s_waitcnt lgkmcnt(4)
  v_mfma_f32_16x16x32_bf16 v[20:23], v[112:115], v[132:135], v[20:23]
  v_add_u32 v12, s15, v11
  s_waitcnt lgkmcnt(0)
  s_barrier
  v_mfma_f32_16x16x32_bf16 v[32:35], v[116:119], v[128:131], v[32:35]
  ds_read_b128 v[80:83], v7 offset:0
  v_mfma_f32_16x16x32_bf16 v[36:39], v[116:119], v[132:135], v[36:39]
  ds_read_b128 v[96:99], v10 offset:0
  v_mfma_f32_16x16x32_bf16 v[24:27], v[112:115], v[136:139], v[24:27]
  ds_read_b128 v[84:87], v7 offset:2048
  v_mfma_f32_16x16x32_bf16 v[40:43], v[116:119], v[136:139], v[40:43]
  ds_read_b128 v[100:103], v10 offset:512
  v_mfma_f32_16x16x32_bf16 v[48:51], v[120:123], v[128:131], v[48:51]
  ds_read_b128 v[88:91], v7 offset:4096
  v_mfma_f32_16x16x32_bf16 v[52:55], v[120:123], v[132:135], v[52:55]
  ds_read_b128 v[104:107], v10 offset:4096
  v_mfma_f32_16x16x32_bf16 v[56:59], v[120:123], v[136:139], v[56:59]
  ds_read_b128 v[92:95], v7 offset:6144
  v_mfma_f32_16x16x32_bf16 v[28:31], v[112:115], v[140:143], v[28:31]
  ds_read_b128 v[108:111], v10 offset:4608
  v_mfma_f32_16x16x32_bf16 v[44:47], v[116:119], v[140:143], v[44:47]
  v_mfma_f32_16x16x32_bf16 v[60:63], v[120:123], v[140:143], v[60:63]
  v_mfma_f32_16x16x32_bf16 v[64:67], v[124:127], v[128:131], v[64:67]
  v_mfma_f32_16x16x32_bf16 v[68:71], v[124:127], v[132:135], v[68:71]
  v_mfma_f32_16x16x32_bf16 v[72:75], v[124:127], v[136:139], v[72:75]
  v_mfma_f32_16x16x32_bf16 v[76:79], v[124:127], v[140:143], v[76:79]
  s_cmp_lg_u32 s16, 2
  s_cbranch_scc1 g2_kernel_late7
  s_cmp_eq_u32 s90, 0
  s_cbranch_scc1 g2_kernel_xf8
  v_and_b32 v2, 15, v0
  v_and_b32 v3, 15, v0
  v_and_b32 v3, 12, v3
  v_add_u32 v2, v2, v3
  v_lshlrev_b32 v2, 11, v2
  v_lshrrev_b32 v3, 4, v0
  v_lshlrev_b32 v3, 4, v3
  v_add_u32 v2, v2, v3
  s_lshl_b32 s57, s61, 16
  s_mul_i32 s19, s60, 256
  s_add_u32 s57, s57, s19
  s_mul_i32 s19, s24, 128
  s_add_u32 s57, s57, s19
  s_add_u32 s26, s57, 0
  buffer_load_dwordx4 v[144:147], v2, s[36:39], s26 offen offset:0
  buffer_load_dwordx4 v[148:151], v2, s[36:39], s26 offen offset:64
  s_add_u32 s26, s57, 8192
  buffer_load_dwordx4 v[152:155], v2, s[36:39], s26 offen offset:0
  buffer_load_dwordx4 v[156:159], v2, s[36:39], s26 offen offset:64
  s_branch g2_kernel_xe9
g2_kernel_xf8:
  s_add_u32 s26, s56, 0
  buffer_load_dwordx4 v[144:147], v160, s[72:75], s26 offen offset:0
  buffer_load_dwordx4 v[148:151], v160, s[72:75], s26 offen offset:1024
  s_add_u32 s26, s56, 32768
  buffer_load_dwordx4 v[152:155], v160, s[72:75], s26 offen offset:0
  buffer_load_dwordx4 v[156:159], v160, s[72:75], s26 offen offset:1024
g2_kernel_xe9:
g2_kernel_late7:
  s_sub_u32 s16, s16, 1
  s_cmp_lg_u32 s16, 0
  s_cbranch_scc1 g2_kernel_cloop6
  s_waitcnt lgkmcnt(6)
  v_mfma_f32_16x16x32_bf16 v[16:19], v[80:83], v[96:99], v[16:19]
  ds_read_b128 v[112:115], v8 offset:1024
  s_waitcnt lgkmcnt(5)
  v_mfma_f32_16x16x32_bf16 v[20:23], v[80:83], v[100:103], v[20:23]
  ds_read_b128 v[128:131], v12 offset:0
  v_mfma_f32_16x16x32_bf16 v[32:35], v[84:87], v[96:99], v[32:35]
  ds_read_b128 v[116:119], v8 offset:3072
  v_mfma_f32_16x16x32_bf16 v[36:39], v[84:87], v[100:103], v[36:39]
  ds_read_b128 v[132:135], v12 offset:512
  s_waitcnt lgkmcnt(6)
  v_mfma_f32_16x16x32_bf16 v[24:27], v[80:83], v[104:107], v[24:27]
  ds_read_b128 v[120:123], v8 offset:5120
  v_mfma_f32_16x16x32_bf16 v[40:43], v[84:87], v[104:107], v[40:43]
  ds_read_b128 v[136:139], v12 offset:4096
  v_mfma_f32_16x16x32_bf16 v[48:51], v[88:91], v[96:99], v[48:51]
  ds_read_b128 v[124:127], v8 offset:7168
  v_mfma_f32_16x16x32_bf16 v[52:55], v[88:91], v[100:103], v[52:55]
  ds_read_b128 v[140:143], v12 offset:4608
  v_mfma_f32_16x16x32_bf16 v[56:59], v[88:91], v[104:107], v[56:59]
  s_waitcnt lgkmcnt(8)
  v_mfma_f32_16x16x32_bf16 v[28:31], v[80:83], v[108:111], v[28:31]
  v_mfma_f32_16x16x32_bf16 v[44:47], v[84:87], v[108:111], v[44:47]
  v_mfma_f32_16x16x32_bf16 v[60:63], v[88:91], v[108:111], v[60:63]
  v_mfma_f32_16x16x32_bf16 v[64:67], v[92:95], v[96:99], v[64:67]
  v_mfma_f32_16x16x32_bf16 v[68:71], v[92:95], v[100:103], v[68:71]
  v_mfma_f32_16x16x32_bf16 v[72:75], v[92:95], v[104:107], v[72:75]
  v_mfma_f32_16x16x32_bf16 v[76:79], v[92:95], v[108:111], v[76:79]
  s_waitcnt lgkmcnt(6)
  v_mfma_f32_16x16x32_bf16 v[16:19], v[112:115], v[128:131], v[16:19]
  s_waitcnt lgkmcnt(4)
  v_mfma_f32_16x16x32_bf16 v[20:23], v[112:115], v[132:135], v[20:23]
  v_mfma_f32_16x16x32_bf16 v[32:35], v[116:119], v[128:131], v[32:35]
  v_mfma_f32_16x16x32_bf16 v[36:39], v[116:119], v[132:135], v[36:39]
  s_waitcnt lgkmcnt(2)
  v_mfma_f32_16x16x32_bf16 v[24:27], v[112:115], v[136:139], v[24:27]
  v_mfma_f32_16x16x32_bf16 v[40:43], v[116:119], v[136:139], v[40:43]
  v_mfma_f32_16x16x32_bf16 v[48:51], v[120:123], v[128:131], v[48:51]
  v_mfma_f32_16x16x32_bf16 v[52:55], v[120:123], v[132:135], v[52:55]
  v_mfma_f32_16x16x32_bf16 v[56:59], v[120:123], v[136:139], v[56:59]
  s_waitcnt lgkmcnt(0)
  v_mfma_f32_16x16x32_bf16 v[28:31], v[112:115], v[140:143], v[28:31]
  v_mfma_f32_16x16x32_bf16 v[44:47], v[116:119], v[140:143], v[44:47]
  v_mfma_f32_16x16x32_bf16 v[60:63], v[120:123], v[140:143], v[60:63]
  v_mfma_f32_16x16x32_bf16 v[64:67], v[124:127], v[128:131], v[64:67]
  v_mfma_f32_16x16x32_bf16 v[68:71], v[124:127], v[132:135], v[68:71]
  v_mfma_f32_16x16x32_bf16 v[72:75], v[124:127], v[136:139], v[72:75]
  v_mfma_f32_16x16x32_bf16 v[76:79], v[124:127], v[140:143], v[76:79]
  s_barrier
  s_lshl_b32 s26, s63, 12
  s_mov_b32 s58, 0
  v_cvt_pk_bf16_f32 v80, v24, v25
  v_cvt_pk_bf16_f32 v81, v26, v27
  v_cvt_pk_bf16_f32 v82, v28, v29
  v_cvt_pk_bf16_f32 v83, v30, v31
  v_and_or_b32 v80, v80, -2, s58
  buffer_store_dwordx4 v[80:83], v160, s[64:67], s26 offen offset:0 sc1
  v_cvt_pk_bf16_f32 v84, v40, v41
  v_cvt_pk_bf16_f32 v85, v42, v43
  v_cvt_pk_bf16_f32 v86, v44, v45
  v_cvt_pk_bf16_f32 v87, v46, v47
  v_and_or_b32 v84, v84, -2, s58
  buffer_store_dwordx4 v[84:87], v160, s[64:67], s26 offen offset:1024 sc1
  v_cvt_pk_bf16_f32 v88, v56, v57
  v_cvt_pk_bf16_f32 v89, v58, v59
  v_cvt_pk_bf16_f32 v90, v60, v61
  v_cvt_pk_bf16_f32 v91, v62, v63
  v_and_or_b32 v88, v88, -2, s58
  buffer_store_dwordx4 v[88:91], v160, s[64:67], s26 offen offset:2048 sc1
  v_cvt_pk_bf16_f32 v92, v72, v73
  v_cvt_pk_bf16_f32 v93, v74, v75
  v_cvt_pk_bf16_f32 v94, v76, v77
  v_cvt_pk_bf16_f32 v95, v78, v79
  v_and_or_b32 v92, v92, -2, s58
  buffer_store_dwordx4 v[92:95], v160, s[64:67], s26 offen offset:3072 sc1
  s_xor_b32 s27, s26, 0x4000
  s_mov_b32 s59, 0
  s_mov_b32 s19, 0xffff0000
  s_waitcnt vmcnt(4)
  v_lshlrev_b32 v96, 16, v144
  v_and_b32 v97, s19, v144
  v_pk_add_f32 v[16:17], v[16:17], v[96:97] op_sel:[0,0] op_sel_hi:[1,1]
  v_lshlrev_b32 v98, 16, v145
  v_and_b32 v99, s19, v145
  v_pk_add_f32 v[18:19], v[18:19], v[98:99] op_sel:[0,0] op_sel_hi:[1,1]
  v_lshlrev_b32 v100, 16, v146
  v_and_b32 v101, s19, v146
  v_pk_add_f32 v[32:33], v[32:33], v[100:101] op_sel:[0,0] op_sel_hi:[1,1]
  v_lshlrev_b32 v102, 16, v147
  v_and_b32 v103, s19, v147
  v_pk_add_f32 v[34:35], v[34:35], v[102:103] op_sel:[0,0] op_sel_hi:[1,1]
  v_lshlrev_b32 v96, 16, v148
  v_and_b32 v97, s19, v148
  v_pk_add_f32 v[48:49], v[48:49], v[96:97] op_sel:[0,0] op_sel_hi:[1,1]
  v_lshlrev_b32 v98, 16, v149
  v_and_b32 v99, s19, v149
  v_pk_add_f32 v[50:51], v[50:51], v[98:99] op_sel:[0,0] op_sel_hi:[1,1]
  v_lshlrev_b32 v100, 16, v150
  v_and_b32 v101, s19, v150
  v_pk_add_f32 v[64:65], v[64:65], v[100:101] op_sel:[0,0] op_sel_hi:[1,1]
  v_lshlrev_b32 v102, 16, v151
  v_and_b32 v103, s19, v151
  v_pk_add_f32 v[66:67], v[66:67], v[102:103] op_sel:[0,0] op_sel_hi:[1,1]
  v_lshlrev_b32 v96, 16, v152
  v_and_b32 v97, s19, v152
  v_pk_add_f32 v[20:21], v[20:21], v[96:97] op_sel:[0,0] op_sel_hi:[1,1]
  v_lshlrev_b32 v98, 16, v153
  v_and_b32 v99, s19, v153
  v_pk_add_f32 v[22:23], v[22:23], v[98:99] op_sel:[0,0] op_sel_hi:[1,1]
  v_lshlrev_b32 v100, 16, v154
  v_and_b32 v101, s19, v154
  v_pk_add_f32 v[36:37], v[36:37], v[100:101] op_sel:[0,0] op_sel_hi:[1,1]
  v_lshlrev_b32 v102, 16, v155
  v_and_b32 v103, s19, v155
  v_pk_add_f32 v[38:39], v[38:39], v[102:103] op_sel:[0,0] op_sel_hi:[1,1]
  v_lshlrev_b32 v96, 16, v156
  v_and_b32 v97, s19, v156
  v_pk_add_f32 v[52:53], v[52:53], v[96:97] op_sel:[0,0] op_sel_hi:[1,1]
  v_lshlrev_b32 v98, 16, v157
  v_and_b32 v99, s19, v157
  v_pk_add_f32 v[54:55], v[54:55], v[98:99] op_sel:[0,0] op_sel_hi:[1,1]
  v_lshlrev_b32 v100, 16, v158
  v_and_b32 v101, s19, v158
  v_pk_add_f32 v[68:69], v[68:69], v[100:101] op_sel:[0,0] op_sel_hi:[1,1]
  v_lshlrev_b32 v102, 16, v159
  v_and_b32 v103, s19, v159
  v_pk_add_f32 v[70:71], v[70:71], v[102:103] op_sel:[0,0] op_sel_hi:[1,1]
  s_waitcnt vmcnt(0)
g2_kernel_xp10:
  buffer_load_dwordx4 v[112:115], v160, s[64:67], s27 offen offset:0 sc1
  buffer_load_dwordx4 v[116:119], v160, s[64:67], s27 offen offset:1024 sc1
  buffer_load_dwordx4 v[120:123], v160, s[64:67], s27 offen offset:2048 sc1
  buffer_load_dwordx4 v[124:127], v160, s[64:67], s27 offen offset:3072 sc1
  s_add_u32 s59, s59, 1
  s_waitcnt vmcnt(0)
  v_xor_b32 v2, s58, v112
  v_xor_b32 v3, s58, v116
  v_xor_b32 v4, s58, v120
  v_xor_b32 v5, s58, v124
  v_or3_b32 v2, v2, v3, v4
  v_or_b32 v2, v2, v5
  v_and_b32 v2, 1, v2
  v_cmp_eq_u32 vcc, 1, v2
  s_cmp_ge_u32 s59, 0x10000
  s_cbranch_vccz g2_kernel_xd11
  s_cbranch_scc0 g2_kernel_xp10
g2_kernel_xd11:
  v_lshlrev_b32 v96, 16, v112
  v_and_b32 v97, s19, v112
  v_pk_add_f32 v[16:17], v[16:17], v[96:97] op_sel:[0,0] op_sel_hi:[1,1]
  v_lshlrev_b32 v98, 16, v113
  v_and_b32 v99, s19, v113
  v_pk_add_f32 v[18:19], v[18:19], v[98:99] op_sel:[0,0] op_sel_hi:[1,1]
  v_lshlrev_b32 v100, 16, v116
  v_and_b32 v101, s19, v116
  v_pk_add_f32 v[32:33], v[32:33], v[100:101] op_sel:[0,0] op_sel_hi:[1,1]
  v_lshlrev_b32 v102, 16, v117
  v_and_b32 v103, s19, v117
  v_pk_add_f32 v[34:35], v[34:35], v[102:103] op_sel:[0,0] op_sel_hi:[1,1]
  v_lshlrev_b32 v96, 16, v120
  v_and_b32 v97, s19, v120
  v_pk_add_f32 v[48:49], v[48:49], v[96:97] op_sel:[0,0] op_sel_hi:[1,1]
  v_lshlrev_b32 v98, 16, v121
  v_and_b32 v99, s19, v121
  v_pk_add_f32 v[50:51], v[50:51], v[98:99] op_sel:[0,0] op_sel_hi:[1,1]
  v_lshlrev_b32 v100, 16, v124
  v_and_b32 v101, s19, v124
  v_pk_add_f32 v[64:65], v[64:65], v[100:101] op_sel:[0,0] op_sel_hi:[1,1]
  v_lshlrev_b32 v102, 16, v125
  v_and_b32 v103, s19, v125
  v_pk_add_f32 v[66:67], v[66:67], v[102:103] op_sel:[0,0] op_sel_hi:[1,1]
  v_lshlrev_b32 v96, 16, v114
  v_and_b32 v97, s19, v114
  v_pk_add_f32 v[20:21], v[20:21], v[96:97] op_sel:[0,0] op_sel_hi:[1,1]
  v_lshlrev_b32 v98, 16, v115
  v_and_b32 v99, s19, v115
  v_pk_add_f32 v[22:23], v[22:23], v[98:99] op_sel:[0,0] op_sel_hi:[1,1]
  v_lshlrev_b32 v100, 16, v118
  v_and_b32 v101, s19, v118
  v_pk_add_f32 v[36:37], v[36:37], v[100:101] op_sel:[0,0] op_sel_hi:[1,1]
  v_lshlrev_b32 v102, 16, v119
  v_and_b32 v103, s19, v119
  v_pk_add_f32 v[38:39], v[38:39], v[102:103] op_sel:[0,0] op_sel_hi:[1,1]
  v_lshlrev_b32 v96, 16, v122
  v_and_b32 v97, s19, v122
  v_pk_add_f32 v[52:53], v[52:53], v[96:97] op_sel:[0,0] op_sel_hi:[1,1]
  v_lshlrev_b32 v98, 16, v123
  v_and_b32 v99, s19, v123
  v_pk_add_f32 v[54:55], v[54:55], v[98:99] op_sel:[0,0] op_sel_hi:[1,1]
  v_lshlrev_b32 v100, 16, v126
  v_and_b32 v101, s19, v126
  v_pk_add_f32 v[68:69], v[68:69], v[100:101] op_sel:[0,0] op_sel_hi:[1,1]
  v_lshlrev_b32 v102, 16, v127
  v_and_b32 v103, s19, v127
  v_pk_add_f32 v[70:71], v[70:71], v[102:103] op_sel:[0,0] op_sel_hi:[1,1]
  s_waitcnt vmcnt(0)
  s_mov_b32 s19, 0xffff0000
  s_add_u32 s26, s56, 0
  v_cvt_pk_bf16_f32 v144, v16, v17
  v_cvt_pk_bf16_f32 v145, v18, v19
  v_cvt_pk_bf16_f32 v146, v32, v33
  v_cvt_pk_bf16_f32 v147, v34, v35
  buffer_store_dwordx4 v[144:147], v160, s[28:31], s26 offen offset:0 sc0 sc1
  v_cvt_pk_bf16_f32 v148, v48, v49
  v_cvt_pk_bf16_f32 v149, v50, v51
  v_cvt_pk_bf16_f32 v150, v64, v65
  v_cvt_pk_bf16_f32 v151, v66, v67
  buffer_store_dwordx4 v[148:151], v160, s[28:31], s26 offen offset:1024 sc0 sc1
  s_add_u32 s26, s56, 32768
  v_cvt_pk_bf16_f32 v152, v20, v21
  v_cvt_pk_bf16_f32 v153, v22, v23
  v_cvt_pk_bf16_f32 v154, v36, v37
  v_cvt_pk_bf16_f32 v155, v38, v39
  buffer_store_dwordx4 v[152:155], v160, s[28:31], s26 offen offset:0 sc0 sc1
  v_cvt_pk_bf16_f32 v156, v52, v53
  v_cvt_pk_bf16_f32 v157, v54, v55
  v_cvt_pk_bf16_f32 v158, v68, v69
  v_cvt_pk_bf16_f32 v159, v70, v71
  buffer_store_dwordx4 v[156:159], v160, s[28:31], s26 offen offset:1024 sc0 sc1
  v_lshlrev_b32 v16, 16, v144
  v_and_b32 v17, s19, v144
  v_mov_b32 v112, v16
  v_mov_b32 v113, v17
  v_pk_mul_f32 v[114:115], v[16:17], v[16:17] op_sel:[0,0] op_sel_hi:[1,1]
  v_lshlrev_b32 v18, 16, v145
  v_and_b32 v19, s19, v145
  v_pk_add_f32 v[112:113], v[112:113], v[18:19] op_sel:[0,0] op_sel_hi:[1,1]
  v_pk_fma_f32 v[114:115], v[18:19], v[18:19], v[114:115] op_sel:[0,0,0] op_sel_hi:[1,1,1]
  v_lshlrev_b32 v32, 16, v146
  v_and_b32 v33, s19, v146
  v_pk_add_f32 v[112:113], v[112:113], v[32:33] op_sel:[0,0] op_sel_hi:[1,1]
  v_pk_fma_f32 v[114:115], v[32:33], v[32:33], v[114:115] op_sel:[0,0,0] op_sel_hi:[1,1,1]
  v_lshlrev_b32 v34, 16, v147
  v_and_b32 v35, s19, v147
  v_pk_add_f32 v[112:113], v[112:113], v[34:35] op_sel:[0,0] op_sel_hi:[1,1]
  v_pk_fma_f32 v[114:115], v[34:35], v[34:35], v[114:115] op_sel:[0,0,0] op_sel_hi:[1,1,1]
  v_lshlrev_b32 v48, 16, v148
  v_and_b32 v49, s19, v148
  v_pk_add_f32 v[112:113], v[112:113], v[48:49] op_sel:[0,0] op_sel_hi:[1,1]
  v_pk_fma_f32 v[114:115], v[48:49], v[48:49], v[114:115] op_sel:[0,0,0] op_sel_hi:[1,1,1]
  v_lshlrev_b32 v50, 16, v149
  v_and_b32 v51, s19, v149
  v_pk_add_f32 v[112:113], v[112:113], v[50:51] op_sel:[0,0] op_sel_hi:[1,1]
  v_pk_fma_f32 v[114:115], v[50:51], v[50:51], v[114:115] op_sel:[0,0,0] op_sel_hi:[1,1,1]
  v_lshlrev_b32 v64, 16, v150
  v_and_b32 v65, s19, v150
  v_pk_add_f32 v[112:113], v[112:113], v[64:65] op_sel:[0,0] op_sel_hi:[1,1]
  v_pk_fma_f32 v[114:115], v[64:65], v[64:65], v[114:115] op_sel:[0,0,0] op_sel_hi:[1,1,1]
  v_lshlrev_b32 v66, 16, v151
  v_and_b32 v67, s19, v151
  v_pk_add_f32 v[112:113], v[112:113], v[66:67] op_sel:[0,0] op_sel_hi:[1,1]
  v_pk_fma_f32 v[114:115], v[66:67], v[66:67], v[114:115] op_sel:[0,0,0] op_sel_hi:[1,1,1]
  v_lshlrev_b32 v20, 16, v152
  v_and_b32 v21, s19, v152
  v_mov_b32 v116, v20
  v_mov_b32 v117, v21
  v_pk_mul_f32 v[118:119], v[20:21], v[20:21] op_sel:[0,0] op_sel_hi:[1,1]
  v_lshlrev_b32 v22, 16, v153
  v_and_b32 v23, s19, v153
  v_pk_add_f32 v[116:117], v[116:117], v[22:23] op_sel:[0,0] op_sel_hi:[1,1]
  v_pk_fma_f32 v[118:119], v[22:23], v[22:23], v[118:119] op_sel:[0,0,0] op_sel_hi:[1,1,1]
  v_lshlrev_b32 v36, 16, v154
  v_and_b32 v37, s19, v154
  v_pk_add_f32 v[116:117], v[116:117], v[36:37] op_sel:[0,0] op_sel_hi:[1,1]
  v_pk_fma_f32 v[118:119], v[36:37], v[36:37], v[118:119] op_sel:[0,0,0] op_sel_hi:[1,1,1]
  v_lshlrev_b32 v38, 16, v155
  v_and_b32 v39, s19, v155
  v_pk_add_f32 v[116:117], v[116:117], v[38:39] op_sel:[0,0] op_sel_hi:[1,1]
  v_pk_fma_f32 v[118:119], v[38:39], v[38:39], v[118:119] op_sel:[0,0,0] op_sel_hi:[1,1,1]
  v_lshlrev_b32 v52, 16, v156
  v_and_b32 v53, s19, v156
  v_pk_add_f32 v[116:117], v[116:117], v[52:53] op_sel:[0,0] op_sel_hi:[1,1]
  v_pk_fma_f32 v[118:119], v[52:53], v[52:53], v[118:119] op_sel:[0,0,0] op_sel_hi:[1,1,1]
  v_lshlrev_b32 v54, 16, v157
  v_and_b32 v55, s19, v157
  v_pk_add_f32 v[116:117], v[116:117], v[54:55] op_sel:[0,0] op_sel_hi:[1,1]
  v_pk_fma_f32 v[118:119], v[54:55], v[54:55], v[118:119] op_sel:[0,0,0] op_sel_hi:[1,1,1]
  v_lshlrev_b32 v68, 16, v158
  v_and_b32 v69, s19, v158
  v_pk_add_f32 v[116:117], v[116:117], v[68:69] op_sel:[0,0] op_sel_hi:[1,1]
  v_pk_fma_f32 v[118:119], v[68:69], v[68:69], v[118:119] op_sel:[0,0,0] op_sel_hi:[1,1,1]
  v_lshlrev_b32 v70, 16, v159
  v_and_b32 v71, s19, v159
  v_pk_add_f32 v[116:117], v[116:117], v[70:71] op_sel:[0,0] op_sel_hi:[1,1]
  v_pk_fma_f32 v[118:119], v[70:71], v[70:71], v[118:119] op_sel:[0,0,0] op_sel_hi:[1,1,1]
  v_add_f32 v112, v112, v113
  v_add_f32 v114, v114, v115
  v_add_f32 v116, v116, v117
  v_add_f32 v118, v118, v119
  v_permlane32_swap_b32 v112, v114
  s_nop 0
  v_permlane32_swap_b32 v116, v118
  v_add_f32 v112, v112, v114
  v_add_f32 v116, v116, v118
  v_and_b32 v2, 15, v0
  v_and_b32 v3, 15, v0
  v_and_b32 v3, 12, v3
  v_add_u32 v2, v2, v3
  v_lshrrev_b32 v3, 4, v0
  v_and_b32 v3, 1, v3
  v_lshlrev_b32 v3, 2, v3
  v_add_u32 v2, v2, v3
  v_lshlrev_b32 v2, 3, v2
  v_lshrrev_b32 v3, 4, v0
  v_lshrrev_b32 v3, 1, v3
  v_lshlrev_b32 v3, 2, v3
  v_add_u32 v2, v2, v3
  s_lshr_b32 s3, s61, 2
  s_lshl_b32 s3, s3, 14
  s_and_b32 s19, s61, 3
  s_lshl_b32 s19, s19, 8
  s_add_u32 s3, s3, s19
  s_mul_i32 s19, s60, 2048
  s_add_u32 s3, s3, s19
  s_lshl_b32 s19, s24, 10
  s_add_u32 s3, s3, s19
  v_permlane16_swap_b32 v112, v116
  v_add_f32 v112, v112, v116
  buffer_store_dword v112, v2, s[32:35], s3 offen sc0 sc1
g2_kernel_fin:
  s_load_dwordx2 s[96:97], s[0:1], 96
  s_cmp_lg_u32 s90, 0
  s_cselect_b32 s19, 1, 5
  s_lshl_b32 s19, s19, 15
  s_lshl_b32 s3, s13, 4
  s_add_u32 s3, s3, s12
  s_lshl_b32 s3, s3, 7
  s_add_u32 s3, s3, s19
  v_mov_b32 v2, 0
  v_mov_b32 v3, 1
  s_waitcnt lgkmcnt(0)
  s_add_u32 s96, s96, 63963136
  s_addc_u32 s97, s97, 0
  s_mov_b32 s98, 262144
  s_mov_b32 s99, 0x20000
  s_waitcnt vmcnt(0)
  s_barrier
  s_cmp_lg_u32 s14, 0
  s_cbranch_scc1 g2_kernel_nb12
  buffer_store_dword v3, v2, s[96:99], s3 offen sc1
g2_kernel_nb12:
  s_branch g3_kernel_fe
g2_kernel_end:
  s_endpgm
.p2align 6
g3_kernel_fe:
  s_load_dwordx2 s[4:5], s[0:1], 96
  s_load_dwordx2 s[8:9], s[0:1], 96
  s_and_b32 s3, s2, 7
  s_lshr_b32 s16, s2, 3
  s_and_b32 s12, s3, 3
  s_mul_i32 s12, s12, 4
  s_lshr_b32 s13, s3, 2
  s_mul_i32 s13, s13, 8
  s_and_b32 s3, s16, 3
  s_add_u32 s12, s12, s3
  s_lshr_b32 s16, s16, 2
  s_add_u32 s13, s13, s16
  s_mov_b32 s15, 0
  s_cmp_lt_u32 s14, 4
  s_cbranch_scc1 g3_kernel_comp
  s_sub_u32 s24, s14, 4
  s_setprio 2
  s_mul_i32 s83, s13, 262144
  s_lshr_b32 s3, s24, 1
  s_mul_i32 s3, s3, 32768
  s_add_u32 s83, s83, s3
  s_and_b32 s3, s24, 1
  s_lshl_b32 s3, s3, 10
  s_add_u32 s83, s83, s3
  s_mul_i32 s85, s24, 1024
  s_add_u32 s85, s85, 28672
  v_lshlrev_b32 v6, 4, v0
  v_add_u32 v6, s83, v6
  s_mul_i32 s82, s12, 458752
  s_mul_i32 s3, s24, 1024
  s_add_u32 s82, s82, s3
  s_mul_i32 s84, s24, 1024
  v_lshlrev_b32 v7, 4, v0
  v_add_u32 v7, s82, v7
  s_mov_b32 s17, 0
  s_mov_b32 s18, 0
  s_mov_b32 s80, 0
  s_mul_i32 s81, s12, 1
  s_mul_i32 s3, s13, 1
  s_add_u32 s81, s81, s3
  s_mov_b32 s16, 0
  s_waitcnt lgkmcnt(0)
  s_add_u32 s4, s4, 46137344
  s_addc_u32 s5, s5, 0
  s_mov_b32 s6, 7340032
  s_mov_b32 s7, 0x20000
  s_cmp_eq_u32 s90, 0
  s_cselect_b32 s10, 58720256, 0
  s_add_u32 s8, s8, s10
  s_addc_u32 s9, s9, 0
  s_mov_b32 s10, 4194304
  s_mov_b32 s11, 0x20000
  s_add_u32 s3, s80, s81
  s_and_b32 s3, s3, 1
  s_andn2_b32 s19, s80, 1
  s_or_b32 s3, s3, s19
  s_mul_i32 s17, s3, 28672
  s_mul_i32 s18, s3, 2048
  s_barrier
g3_kernel_nsg3:
  s_add_u32 s26, s15, s84
  s_mov_b32 m0, s26
  s_nop 0
  buffer_load_dwordx4 v7, s[4:7], s17 offen lds
  s_add_u32 m0, s26, 4096
  s_add_u32 s27, s17, 4096
  buffer_load_dwordx4 v7, s[4:7], s27 offen lds
  s_add_u32 m0, s26, 8192
  s_add_u32 s27, s17, 8192
  buffer_load_dwordx4 v7, s[4:7], s27 offen lds
  s_add_u32 m0, s26, 12288
  s_add_u32 s27, s17, 12288
  buffer_load_dwordx4 v7, s[4:7], s27 offen lds
  s_add_u32 m0, s26, 16384
  s_add_u32 s27, s17, 16384
  buffer_load_dwordx4 v7, s[4:7], s27 offen lds
  s_add_u32 m0, s26, 20480
  s_add_u32 s27, s17, 20480
  buffer_load_dwordx4 v7, s[4:7], s27 offen lds
  s_add_u32 m0, s26, 24576
  s_add_u32 s27, s17, 24576
  buffer_load_dwordx4 v7, s[4:7], s27 offen lds
  s_add_u32 s15, s15, 45056
  s_cmp_eq_u32 s15, 135168
  s_cselect_b32 s15, 0, s15
  s_add_u32 s80, s80, 1
  s_add_u32 s3, s80, s81
  s_and_b32 s3, s3, 1
  s_andn2_b32 s19, s80, 1
  s_or_b32 s3, s3, s19
  s_mul_i32 s17, s3, 28672
  s_mul_i32 s18, s3, 2048
  s_add_u32 s26, s15, s84
  s_mov_b32 m0, s26
  s_nop 0
  buffer_load_dwordx4 v7, s[4:7], s17 offen lds
  s_add_u32 m0, s26, 4096
  s_add_u32 s27, s17, 4096
  buffer_load_dwordx4 v7, s[4:7], s27 offen lds
  s_add_u32 m0, s26, 8192
  s_add_u32 s27, s17, 8192
  buffer_load_dwordx4 v7, s[4:7], s27 offen lds
  s_add_u32 m0, s26, 12288
  s_add_u32 s27, s17, 12288
  buffer_load_dwordx4 v7, s[4:7], s27 offen lds
  s_add_u32 m0, s26, 16384
  s_add_u32 s27, s17, 16384
  buffer_load_dwordx4 v7, s[4:7], s27 offen lds
  s_add_u32 m0, s26, 20480
  s_add_u32 s27, s17, 20480
  buffer_load_dwordx4 v7, s[4:7], s27 offen lds
  s_add_u32 m0, s26, 24576
  s_add_u32 s27, s17, 24576
  buffer_load_dwordx4 v7, s[4:7], s27 offen lds
  s_add_u32 s15, s15, 45056
  s_cmp_eq_u32 s15, 135168
  s_cselect_b32 s15, 0, s15
  s_add_u32 s80, s80, 1
  s_add_u32 s3, s80, s81
  s_and_b32 s3, s3, 1
  s_andn2_b32 s19, s80, 1
  s_or_b32 s3, s3, s19
  s_mul_i32 s17, s3, 28672
  s_mul_i32 s18, s3, 2048
  s_mov_b32 s15, 0
  s_mov_b32 s17, 0
  s_mov_b32 s18, 0
  s_mov_b32 s80, 0
  s_add_u32 s3, s80, s81
  s_and_b32 s3, s3, 1
  s_andn2_b32 s19, s80, 1
  s_or_b32 s3, s3, s19
  s_mul_i32 s17, s3, 28672
  s_mul_i32 s18, s3, 2048
  s_load_dwordx2 s[28:29], s[0:1], 96
  v_and_b32 v2, 15, v0
  v_lshlrev_b32 v2, 7, v2
  s_cmp_lg_u32 s90, 0
  s_cselect_b32 s32, 1, 5
  s_lshl_b32 s32, s32, 15
  s_lshl_b32 s3, s13, 8
  s_lshr_b32 s3, s3, 4
  s_lshl_b32 s3, s3, 7
  s_add_u32 s32, s32, s3
  s_mov_b32 s33, 0
  s_waitcnt lgkmcnt(0)
  s_add_u32 s28, s28, 63963136
  s_addc_u32 s29, s29, 0
  s_mov_b32 s30, 262144
  s_mov_b32 s31, 0x20000
  s_cmp_lg_u32 s24, 0
  s_cbranch_scc1 g3_kernel_dd5
g3_kernel_dp4:
  buffer_load_dword v8, v2, s[28:31], s32 offen sc1
  s_add_u32 s33, s33, 1
  s_waitcnt vmcnt(0)
  v_cmp_eq_u32 vcc, -1, v8
  s_cmp_ge_u32 s33, 0x8000
  s_cbranch_vccz g3_kernel_dd5
  s_cbranch_scc0 g3_kernel_dp4
g3_kernel_dd5:
  s_barrier
  s_add_u32 s26, s15, s85
  s_mov_b32 m0, s26
  s_nop 0
  buffer_load_dwordx4 v6, s[8:11], s18 offen lds
  s_add_u32 m0, s26, 4096
  s_add_u32 s27, s18, 65536
  buffer_load_dwordx4 v6, s[8:11], s27 offen lds
  s_add_u32 m0, s26, 8192
  s_add_u32 s27, s18, 131072
  buffer_load_dwordx4 v6, s[8:11], s27 offen lds
  s_add_u32 m0, s26, 12288
  s_add_u32 s27, s18, 196608
  buffer_load_dwordx4 v6, s[8:11], s27 offen lds
  s_add_u32 s15, s15, 45056
  s_cmp_eq_u32 s15, 135168
  s_cselect_b32 s15, 0, s15
  s_add_u32 s80, s80, 1
  s_add_u32 s3, s80, s81
  s_and_b32 s3, s3, 1
  s_andn2_b32 s19, s80, 1
  s_or_b32 s3, s3, s19
  s_mul_i32 s17, s3, 28672
  s_mul_i32 s18, s3, 2048
  s_add_u32 s26, s15, s85
  s_mov_b32 m0, s26
  s_nop 0
  buffer_load_dwordx4 v6, s[8:11], s18 offen lds
  s_add_u32 m0, s26, 4096
  s_add_u32 s27, s18, 65536
  buffer_load_dwordx4 v6, s[8:11], s27 offen lds
  s_add_u32 m0, s26, 8192
  s_add_u32 s27, s18, 131072
  buffer_load_dwordx4 v6, s[8:11], s27 offen lds
  s_add_u32 m0, s26, 12288
  s_add_u32 s27, s18, 196608
  buffer_load_dwordx4 v6, s[8:11], s27 offen lds
  s_add_u32 s15, s15, 45056
  s_cmp_eq_u32 s15, 135168
  s_cselect_b32 s15, 0, s15
  s_add_u32 s80, s80, 1
  s_add_u32 s3, s80, s81
  s_and_b32 s3, s3, 1
  s_andn2_b32 s19, s80, 1
  s_or_b32 s3, s3, s19
  s_mul_i32 s17, s3, 28672
  s_mul_i32 s18, s3, 2048
  s_waitcnt vmcnt(4)
  s_barrier
  s_add_u32 s26, s15, s85
  s_mov_b32 m0, s26
  s_nop 0
  buffer_load_dwordx4 v6, s[8:11], s18 offen lds
  s_add_u32 m0, s26, 4096
  s_add_u32 s27, s18, 65536
  buffer_load_dwordx4 v6, s[8:11], s27 offen lds
  s_add_u32 m0, s26, 8192
  s_add_u32 s27, s18, 131072
  buffer_load_dwordx4 v6, s[8:11], s27 offen lds
  s_add_u32 m0, s26, 12288
  s_add_u32 s27, s18, 196608
  buffer_load_dwordx4 v6, s[8:11], s27 offen lds
  s_add_u32 s26, s15, s84
  s_mov_b32 m0, s26
  s_nop 0
  buffer_load_dwordx4 v7, s[4:7], s17 offen lds
  s_add_u32 m0, s26, 4096
  s_add_u32 s27, s17, 4096
  buffer_load_dwordx4 v7, s[4:7], s27 offen lds
  s_add_u32 m0, s26, 8192
  s_add_u32 s27, s17, 8192
  buffer_load_dwordx4 v7, s[4:7], s27 offen lds
  s_add_u32 m0, s26, 12288
  s_add_u32 s27, s17, 12288
  buffer_load_dwordx4 v7, s[4:7], s27 offen lds
  s_add_u32 m0, s26, 16384
  s_add_u32 s27, s17, 16384
  buffer_load_dwordx4 v7, s[4:7], s27 offen lds
  s_add_u32 m0, s26, 20480
  s_add_u32 s27, s17, 20480
  buffer_load_dwordx4 v7, s[4:7], s27 offen lds
  s_add_u32 m0, s26, 24576
  s_add_u32 s27, s17, 24576
  buffer_load_dwordx4 v7, s[4:7], s27 offen lds
  s_add_u32 s15, s15, 45056
  s_cmp_eq_u32 s15, 135168
  s_cselect_b32 s15, 0, s15
  s_add_u32 s80, s80, 1
  s_add_u32 s3, s80, s81
  s_and_b32 s3, s3, 1
  s_andn2_b32 s19, s80, 1
  s_or_b32 s3, s3, s19
  s_mul_i32 s17, s3, 28672
  s_mul_i32 s18, s3, 2048
  s_mov_b32 s16, 3
g3_kernel_ldloop1:
  s_waitcnt vmcnt(11)
  s_barrier
g3_kernel_ldissue2:
  s_add_u32 s26, s15, s85
  s_mov_b32 m0, s26
  s_nop 0
  buffer_load_dwordx4 v6, s[8:11], s18 offen lds
  s_add_u32 m0, s26, 4096
  s_add_u32 s27, s18, 65536
  buffer_load_dwordx4 v6, s[8:11], s27 offen lds
  s_add_u32 m0, s26, 8192
  s_add_u32 s27, s18, 131072
  buffer_load_dwordx4 v6, s[8:11], s27 offen lds
  s_add_u32 m0, s26, 12288
  s_add_u32 s27, s18, 196608
  buffer_load_dwordx4 v6, s[8:11], s27 offen lds
  s_add_u32 s26, s15, s84
  s_mov_b32 m0, s26
  s_nop 0
  buffer_load_dwordx4 v7, s[4:7], s17 offen lds
  s_add_u32 m0, s26, 4096
  s_add_u32 s27, s17, 4096
  buffer_load_dwordx4 v7, s[4:7], s27 offen lds
  s_add_u32 m0, s26, 8192
  s_add_u32 s27, s17, 8192
  buffer_load_dwordx4 v7, s[4:7], s27 offen lds
  s_add_u32 m0, s26, 12288
  s_add_u32 s27, s17, 12288
  buffer_load_dwordx4 v7, s[4:7], s27 offen lds
  s_add_u32 m0, s26, 16384
  s_add_u32 s27, s17, 16384
  buffer_load_dwordx4 v7, s[4:7], s27 offen lds
  s_add_u32 m0, s26, 20480
  s_add_u32 s27, s17, 20480
  buffer_load_dwordx4 v7, s[4:7], s27 offen lds
  s_add_u32 m0, s26, 24576
  s_add_u32 s27, s17, 24576
  buffer_load_dwordx4 v7, s[4:7], s27 offen lds
  s_add_u32 s15, s15, 45056
  s_cmp_eq_u32 s15, 135168
  s_cselect_b32 s15, 0, s15
  s_add_u32 s80, s80, 1
  s_add_u32 s3, s80, s81
  s_and_b32 s3, s3, 1
  s_andn2_b32 s19, s80, 1
  s_or_b32 s3, s3, s19
  s_mul_i32 s17, s3, 28672
  s_mul_i32 s18, s3, 2048
  s_add_u32 s16, s16, 1
  s_cmp_lt_u32 s16, 16
  s_cbranch_scc1 g3_kernel_ldloop1
  s_load_dwordx2 s[28:29], s[0:1], 96
  s_load_dwordx2 s[64:65], s[0:1], 96
  s_load_dwordx2 s[68:69], s[0:1], 96
  s_load_dwordx2 s[36:37], s[0:1], 96
  s_cmp_ge_u32 s24, 2
  s_cbranch_scc1 g3_kernel_tw6
  s_load_dwordx2 s[32:33], s[0:1], 96
  s_and_b32 s3, s24, 1
  s_lshl_b32 s3, s3, 6
  v_add_u32 v44, s3, v0
  v_lshlrev_b32 v2, 3, v44
  s_lshl_b32 s57, s13, 14
  s_waitcnt lgkmcnt(0)
  s_add_u32 s32, s32, 41943040
  s_addc_u32 s33, s33, 0
  s_cmp_eq_u32 s90, 0
  s_cselect_b32 s34, 23068672, 0
  s_add_u32 s32, s32, s34
  s_addc_u32 s33, s33, 0
  s_mov_b32 s34, 262144
  s_mov_b32 s35, 0x20000
  buffer_load_dwordx2 v[12:13], v2, s[32:35], s57 offen offset:0
  buffer_load_dwordx2 v[14:15], v2, s[32:35], s57 offen offset:1024
  buffer_load_dwordx2 v[16:17], v2, s[32:35], s57 offen offset:2048
  buffer_load_dwordx2 v[18:19], v2, s[32:35], s57 offen offset:3072
  s_add_u32 s57, s57, 4096
  buffer_load_dwordx2 v[20:21], v2, s[32:35], s57 offen offset:0
  buffer_load_dwordx2 v[22:23], v2, s[32:35], s57 offen offset:1024
  buffer_load_dwordx2 v[24:25], v2, s[32:35], s57 offen offset:2048
  buffer_load_dwordx2 v[26:27], v2, s[32:35], s57 offen offset:3072
  s_add_u32 s57, s57, 4096
  buffer_load_dwordx2 v[28:29], v2, s[32:35], s57 offen offset:0
  buffer_load_dwordx2 v[30:31], v2, s[32:35], s57 offen offset:1024
  buffer_load_dwordx2 v[32:33], v2, s[32:35], s57 offen offset:2048
  buffer_load_dwordx2 v[34:35], v2, s[32:35], s57 offen offset:3072
  s_add_u32 s57, s57, 4096
  buffer_load_dwordx2 v[36:37], v2, s[32:35], s57 offen offset:0
  buffer_load_dwordx2 v[38:39], v2, s[32:35], s57 offen offset:1024
  buffer_load_dwordx2 v[40:41], v2, s[32:35], s57 offen offset:2048
  buffer_load_dwordx2 v[42:43], v2, s[32:35], s57 offen offset:3072
  s_branch g3_kernel_te7
g3_kernel_tw6:
  v_min_u32 v44, 55, v0
  v_lshlrev_b32 v44, 3, v44
  s_mul_i32 s3, s12, 448
  s_cmp_eq_u32 s24, 2
  s_cselect_b32 s19, 7168, 0
  s_add_u32 s3, s3, s19
  s_waitcnt lgkmcnt(0)
  s_add_u32 s36, s36, 45088768
  s_addc_u32 s37, s37, 0
  s_mov_b32 s38, 229376
  s_mov_b32 s39, 0x20000
  buffer_load_dwordx2 v[12:13], v44, s[36:39], s3 offen
  s_add_u32 s3, s3, 14336
  buffer_load_dwordx2 v[14:15], v44, s[36:39], s3 offen
  s_add_u32 s3, s3, 14336
  buffer_load_dwordx2 v[16:17], v44, s[36:39], s3 offen
  s_add_u32 s3, s3, 14336
  buffer_load_dwordx2 v[18:19], v44, s[36:39], s3 offen
  s_add_u32 s3, s3, 14336
  buffer_load_dwordx2 v[20:21], v44, s[36:39], s3 offen
  s_add_u32 s3, s3, 14336
  buffer_load_dwordx2 v[22:23], v44, s[36:39], s3 offen
  s_add_u32 s3, s3, 14336
  buffer_load_dwordx2 v[24:25], v44, s[36:39], s3 offen
  s_add_u32 s3, s3, 14336
  buffer_load_dwordx2 v[26:27], v44, s[36:39], s3 offen
  s_add_u32 s3, s3, 14336
  buffer_load_dwordx2 v[28:29], v44, s[36:39], s3 offen
  s_add_u32 s3, s3, 14336
  buffer_load_dwordx2 v[30:31], v44, s[36:39], s3 offen
  s_add_u32 s3, s3, 14336
  buffer_load_dwordx2 v[32:33], v44, s[36:39], s3 offen
  s_add_u32 s3, s3, 14336
  buffer_load_dwordx2 v[34:35], v44, s[36:39], s3 offen
  s_add_u32 s3, s3, 14336
  buffer_load_dwordx2 v[36:37], v44, s[36:39], s3 offen
  s_add_u32 s3, s3, 14336
  buffer_load_dwordx2 v[38:39], v44, s[36:39], s3 offen
  s_add_u32 s3, s3, 14336
  buffer_load_dwordx2 v[40:41], v44, s[36:39], s3 offen
  s_add_u32 s3, s3, 14336
  buffer_load_dwordx2 v[42:43], v44, s[36:39], s3 offen
g3_kernel_te7:
  s_waitcnt vmcnt(27)
  s_barrier
  s_waitcnt vmcnt(16)
  s_barrier
  s_waitcnt vmcnt(0)
  s_cmp_ge_u32 s24, 2
  s_cbranch_scc1 g3_kernel_fw8
  v_pk_add_f32 v[12:13], v[12:13], v[28:29] op_sel:[0,0] op_sel_hi:[1,1]
  v_pk_add_f32 v[14:15], v[14:15], v[30:31] op_sel:[0,0] op_sel_hi:[1,1]
  v_pk_add_f32 v[16:17], v[16:17], v[32:33] op_sel:[0,0] op_sel_hi:[1,1]
  v_pk_add_f32 v[18:19], v[18:19], v[34:35] op_sel:[0,0] op_sel_hi:[1,1]
  v_pk_add_f32 v[20:21], v[20:21], v[36:37] op_sel:[0,0] op_sel_hi:[1,1]
  v_pk_add_f32 v[22:23], v[22:23], v[38:39] op_sel:[0,0] op_sel_hi:[1,1]
  v_pk_add_f32 v[24:25], v[24:25], v[40:41] op_sel:[0,0] op_sel_hi:[1,1]
  v_pk_add_f32 v[26:27], v[26:27], v[42:43] op_sel:[0,0] op_sel_hi:[1,1]
  v_pk_add_f32 v[12:13], v[12:13], v[20:21] op_sel:[0,0] op_sel_hi:[1,1]
  v_pk_add_f32 v[14:15], v[14:15], v[22:23] op_sel:[0,0] op_sel_hi:[1,1]
  v_pk_add_f32 v[16:17], v[16:17], v[24:25] op_sel:[0,0] op_sel_hi:[1,1]
  v_pk_add_f32 v[18:19], v[18:19], v[26:27] op_sel:[0,0] op_sel_hi:[1,1]
  v_pk_add_f32 v[12:13], v[12:13], v[16:17] op_sel:[0,0] op_sel_hi:[1,1]
  v_pk_add_f32 v[14:15], v[14:15], v[18:19] op_sel:[0,0] op_sel_hi:[1,1]
  v_pk_add_f32 v[12:13], v[12:13], v[14:15] op_sel:[0,0] op_sel_hi:[1,1]
  v_mul_f32 v12, 981467136, v12
  v_mul_f32 v13, 981467136, v13
  v_fma_f32 v13, -v12, v12, v13
  v_max_f32 v13, 0, v13
  v_add_f32 v13, 925353388, v13
  v_rsq_f32 v13, v13
  s_nop 0
  v_mul_f32 v12, v12, v13
  v_sub_f32 v12, 0, v12
  v_lshlrev_b32 v3, 2, v44
  v_add_u32 v3, 131072, v3
  ds_write_b32 v3, v13
  ds_write_b32 v3, v12 offset:512
  s_branch g3_kernel_fe9
g3_kernel_fw8:
  v_pk_add_f32 v[12:13], v[12:13], v[28:29] op_sel:[0,0] op_sel_hi:[1,1]
  v_pk_add_f32 v[14:15], v[14:15], v[30:31] op_sel:[0,0] op_sel_hi:[1,1]
  v_pk_add_f32 v[16:17], v[16:17], v[32:33] op_sel:[0,0] op_sel_hi:[1,1]
  v_pk_add_f32 v[18:19], v[18:19], v[34:35] op_sel:[0,0] op_sel_hi:[1,1]
  v_pk_add_f32 v[20:21], v[20:21], v[36:37] op_sel:[0,0] op_sel_hi:[1,1]
  v_pk_add_f32 v[22:23], v[22:23], v[38:39] op_sel:[0,0] op_sel_hi:[1,1]
  v_pk_add_f32 v[24:25], v[24:25], v[40:41] op_sel:[0,0] op_sel_hi:[1,1]
  v_pk_add_f32 v[26:27], v[26:27], v[42:43] op_sel:[0,0] op_sel_hi:[1,1]
  v_pk_add_f32 v[12:13], v[12:13], v[20:21] op_sel:[0,0] op_sel_hi:[1,1]
  v_pk_add_f32 v[14:15], v[14:15], v[22:23] op_sel:[0,0] op_sel_hi:[1,1]
  v_pk_add_f32 v[16:17], v[16:17], v[24:25] op_sel:[0,0] op_sel_hi:[1,1]
  v_pk_add_f32 v[18:19], v[18:19], v[26:27] op_sel:[0,0] op_sel_hi:[1,1]
  v_pk_add_f32 v[12:13], v[12:13], v[16:17] op_sel:[0,0] op_sel_hi:[1,1]
  v_pk_add_f32 v[14:15], v[14:15], v[18:19] op_sel:[0,0] op_sel_hi:[1,1]
  v_pk_add_f32 v[12:13], v[12:13], v[14:15] op_sel:[0,0] op_sel_hi:[1,1]
  s_sub_u32 s3, s24, 2
  s_mul_i32 s3, s3, 448
  s_add_u32 s3, s3, 132096
  v_add_u32 v44, s3, v44
  ds_write_b64 v44, v[12:13]
g3_kernel_fe9:
  s_waitcnt lgkmcnt(0)
  s_barrier
  s_setprio 0
  s_mov_b32 s14, s24
  s_and_b32 s24, s14, 1
  s_lshr_b32 s25, s14, 1
  s_mul_i32 s3, s14, 14336
  s_add_u32 s3, s3, 45056
  v_lshlrev_b32 v4, 4, v0
  v_add_u32 v4, s3, v4
  s_branch g3_kernel_ldjoin
  s_endpgm
g3_kernel_comp:
  s_load_dwordx2 s[28:29], s[0:1], 96
  s_load_dwordx2 s[64:65], s[0:1], 96
  s_load_dwordx2 s[68:69], s[0:1], 96
  s_and_b32 s24, s14, 1
  s_lshr_b32 s25, s14, 1
  v_and_b32 v6, 3, v0
  v_lshlrev_b32 v6, 3, v6
  v_lshrrev_b32 v5, 4, v0
  v_lshlrev_b32 v5, 3, v5
  v_lshrrev_b32 v2, 2, v0
  v_and_b32 v2, 3, v2
  v_add_u32 v5, v5, v2
  v_lshrrev_b32 v5, 3, v5
  v_and_b32 v5, 1, v5
  v_lshlrev_b32 v5, 5, v5
  v_xor_b32 v6, v6, v5
  v_lshrrev_b32 v5, 4, v0
  v_lshlrev_b32 v5, 3, v5
  v_lshrrev_b32 v2, 2, v0
  v_and_b32 v2, 3, v2
  v_add_u32 v5, v5, v2
  v_mul_u32_u24 v5, 448, v5
  v_add_u32 v6, v6, v5
  v_mov_b32 v7, v6
  v_mov_b32 v8, v6
  v_and_b32 v9, 3, v0
  v_lshlrev_b32 v9, 3, v9
  v_add_u32 v9, 32, v9
  v_lshrrev_b32 v5, 4, v0
  v_lshlrev_b32 v5, 3, v5
  v_lshrrev_b32 v2, 2, v0
  v_and_b32 v2, 3, v2
  v_add_u32 v5, v5, v2
  v_lshrrev_b32 v5, 3, v5
  v_and_b32 v5, 1, v5
  v_lshlrev_b32 v5, 5, v5
  v_xor_b32 v9, v9, v5
  v_lshrrev_b32 v5, 4, v0
  v_lshlrev_b32 v5, 3, v5
  v_lshrrev_b32 v2, 2, v0
  v_and_b32 v2, 3, v2
  v_add_u32 v5, v5, v2
  v_mul_u32_u24 v5, 448, v5
  v_add_u32 v9, v9, v5
  v_mov_b32 v10, v9
  v_mov_b32 v11, v9
  v_lshlrev_b32 v12, 4, v0
  s_mul_i32 s3, s25, 8192
  s_add_u32 s3, s3, 28672
  v_add_u32 v12, s3, v12
  v_mov_b32 v13, v12
  v_mov_b32 v14, v12
  s_waitcnt lgkmcnt(0)
  s_add_u32 s28, s28, 16777216
  s_addc_u32 s29, s29, 0
  s_cmp_eq_u32 s90, 0
  s_cselect_b32 s30, 67108864, 0
  s_add_u32 s28, s28, s30
  s_addc_u32 s29, s29, 0
  s_mov_b32 s30, 7340032
  s_mov_b32 s31, 0x20000
  s_add_u32 s64, s64, 25165824
  s_addc_u32 s65, s65, 0
  s_cmp_eq_u32 s90, 0
  s_cselect_b32 s66, 67108864, 0
  s_add_u32 s64, s64, s66
  s_addc_u32 s65, s65, 0
  s_mov_b32 s66, 7340032
  s_mov_b32 s67, 0x20000
  s_add_u32 s68, s68, 42991616
  s_addc_u32 s69, s69, 0
  s_mov_b32 s70, 524288
  s_mov_b32 s71, 0x20000
  s_mov_b32 s62, 3184710632
  s_mov_b32 s63, 3184710632
  s_mov_b32 s78, 1040628898
  s_mov_b32 s79, 1040629375
  s_mov_b32 s80, 3196220901
  s_mov_b32 s81, 1067829519
  s_mov_b32 s82, 1092275358
  s_mov_b32 s83, 1124867972
  s_mov_b32 s84, 1143086295
  s_lshl_b32 s59, s25, 1
  s_cmp_eq_u32 s24, 1
  s_cbranch_scc1 g3_kernel_path1
  s_waitcnt lgkmcnt(0)
  s_barrier
  s_barrier
  ds_read_b64_tr_b16 v[128:129], v7 offset:0
  ds_read_b64_tr_b16 v[130:131], v7 offset:1792
  ds_read_b128 v[156:159], v13 offset:0
  ds_read_b64_tr_b16 v[132:133], v10 offset:0
  ds_read_b64_tr_b16 v[134:135], v10 offset:1792
  ds_read_b128 v[160:163], v13 offset:2048
  ds_read_b64_tr_b16 v[136:137], v7 offset:64
  ds_read_b64_tr_b16 v[138:139], v7 offset:1856
  ds_read_b128 v[164:167], v13 offset:4096
  ds_read_b64_tr_b16 v[140:141], v10 offset:64
  ds_read_b64_tr_b16 v[142:143], v10 offset:1856
  ds_read_b128 v[168:171], v13 offset:6144
  ds_read_b64_tr_b16 v[144:145], v10 offset:192
  ds_read_b64_tr_b16 v[146:147], v10 offset:1984
  ds_read_b64_tr_b16 v[148:149], v7 offset:256
  ds_read_b64_tr_b16 v[150:151], v7 offset:2048
  ds_read_b64_tr_b16 v[152:153], v10 offset:256
  ds_read_b64_tr_b16 v[154:155], v10 offset:2048
  s_waitcnt lgkmcnt(15)
  v_mfma_f32_16x16x32_bf16 v[16:19], v[156:159], v[128:131], 0
  ds_read_b64_tr_b16 v[172:173], v8 offset:14336
  s_waitcnt lgkmcnt(13)
  v_mfma_f32_16x16x32_bf16 v[20:23], v[160:163], v[128:131], 0
  ds_read_b64_tr_b16 v[174:175], v8 offset:16128
  v_mfma_f32_16x16x32_bf16 v[32:35], v[156:159], v[132:135], 0
  ds_read_b128 v[200:203], v14 offset:1024
  v_mfma_f32_16x16x32_bf16 v[36:39], v[160:163], v[132:135], 0
  ds_read_b64_tr_b16 v[176:177], v11 offset:14336
  s_waitcnt lgkmcnt(13)
  v_mfma_f32_16x16x32_bf16 v[24:27], v[164:167], v[128:131], 0
  ds_read_b64_tr_b16 v[178:179], v11 offset:16128
  v_mfma_f32_16x16x32_bf16 v[40:43], v[164:167], v[132:135], 0
  ds_read_b128 v[204:207], v14 offset:3072
  v_mfma_f32_16x16x32_bf16 v[48:51], v[156:159], v[136:139], 0
  ds_read_b64_tr_b16 v[180:181], v8 offset:14400
  v_mfma_f32_16x16x32_bf16 v[52:55], v[160:163], v[136:139], 0
  ds_read_b64_tr_b16 v[182:183], v8 offset:16192
  v_mfma_f32_16x16x32_bf16 v[56:59], v[164:167], v[136:139], 0
  ds_read_b128 v[208:211], v14 offset:5120
  s_waitcnt lgkmcnt(15)
  v_mfma_f32_16x16x32_bf16 v[28:31], v[168:171], v[128:131], 0
  ds_read_b64_tr_b16 v[184:185], v11 offset:14400
  v_mfma_f32_16x16x32_bf16 v[44:47], v[168:171], v[132:135], 0
  ds_read_b64_tr_b16 v[186:187], v11 offset:16192
  v_mfma_f32_16x16x32_bf16 v[60:63], v[168:171], v[136:139], 0
  ds_read_b128 v[212:215], v14 offset:7168
  v_mfma_f32_16x16x32_bf16 v[64:67], v[156:159], v[140:143], 0
  ds_read_b64_tr_b16 v[188:189], v11 offset:14528
  v_mfma_f32_16x16x32_bf16 v[68:71], v[160:163], v[140:143], 0
  ds_read_b64_tr_b16 v[190:191], v11 offset:16320
  v_mfma_f32_16x16x32_bf16 v[72:75], v[164:167], v[140:143], 0
  ds_read_b64_tr_b16 v[192:193], v8 offset:14592
  v_mfma_f32_16x16x32_bf16 v[76:79], v[168:171], v[140:143], 0
  ds_read_b64_tr_b16 v[194:195], v8 offset:16384
  s_waitcnt lgkmcnt(15)
  v_mfma_f32_16x16x32_bf16 v[80:83], v[144:147], v[156:159], 0
  ds_read_b64_tr_b16 v[196:197], v11 offset:14592
  v_mfma_f32_16x16x32_bf16 v[84:87], v[144:147], v[160:163], 0
  ds_read_b64_tr_b16 v[198:199], v11 offset:16384
  v_mfma_f32_16x16x32_bf16 v[88:91], v[144:147], v[164:167], 0
  s_add_u32 s15, s15, 45056
  s_cmp_ge_u32 s15, 135168
  s_cselect_b32 s3, 135168, 0
  s_sub_u32 s15, s15, s3
  v_mfma_f32_16x16x32_bf16 v[92:95], v[144:147], v[168:171], 0
  v_add_u32 v7, s15, v6
  s_waitcnt lgkmcnt(15)
  v_mfma_f32_16x16x32_bf16 v[96:99], v[148:151], v[156:159], 0
  v_add_u32 v10, s15, v9
  v_mfma_f32_16x16x32_bf16 v[100:103], v[148:151], v[160:163], 0
  v_add_u32 v13, s15, v12
  v_mfma_f32_16x16x32_bf16 v[104:107], v[148:151], v[164:167], 0
  v_mfma_f32_16x16x32_bf16 v[108:111], v[148:151], v[168:171], 0
  s_waitcnt lgkmcnt(15)
  v_mfma_f32_16x16x32_bf16 v[112:115], v[152:155], v[156:159], 0
  v_mfma_f32_16x16x32_bf16 v[116:119], v[152:155], v[160:163], 0
  v_mfma_f32_16x16x32_bf16 v[120:123], v[152:155], v[164:167], 0
  v_mfma_f32_16x16x32_bf16 v[124:127], v[152:155], v[168:171], 0
  s_waitcnt lgkmcnt(15)
  v_mfma_f32_16x16x32_bf16 v[16:19], v[200:203], v[172:175], v[16:19]
  v_add_u32 v8, s15, v6
  s_waitcnt lgkmcnt(12)
  v_mfma_f32_16x16x32_bf16 v[20:23], v[204:207], v[172:175], v[20:23]
  v_add_u32 v11, s15, v9
  s_waitcnt lgkmcnt(0)
  s_barrier
  v_mfma_f32_16x16x32_bf16 v[32:35], v[200:203], v[176:179], v[32:35]
  ds_read_b64_tr_b16 v[128:129], v7 offset:0
  v_mfma_f32_16x16x32_bf16 v[36:39], v[204:207], v[176:179], v[36:39]
  ds_read_b64_tr_b16 v[130:131], v7 offset:1792
  v_mfma_f32_16x16x32_bf16 v[24:27], v[208:211], v[172:175], v[24:27]
  ds_read_b128 v[156:159], v13 offset:0
  v_mfma_f32_16x16x32_bf16 v[40:43], v[208:211], v[176:179], v[40:43]
  ds_read_b64_tr_b16 v[132:133], v10 offset:0
  v_mfma_f32_16x16x32_bf16 v[48:51], v[200:203], v[180:183], v[48:51]
  ds_read_b64_tr_b16 v[134:135], v10 offset:1792
  v_mfma_f32_16x16x32_bf16 v[52:55], v[204:207], v[180:183], v[52:55]
  ds_read_b128 v[160:163], v13 offset:2048
  v_mfma_f32_16x16x32_bf16 v[56:59], v[208:211], v[180:183], v[56:59]
  ds_read_b64_tr_b16 v[136:137], v7 offset:64
  v_mfma_f32_16x16x32_bf16 v[28:31], v[212:215], v[172:175], v[28:31]
  ds_read_b64_tr_b16 v[138:139], v7 offset:1856
  v_mfma_f32_16x16x32_bf16 v[44:47], v[212:215], v[176:179], v[44:47]
  ds_read_b128 v[164:167], v13 offset:4096
  v_mfma_f32_16x16x32_bf16 v[60:63], v[212:215], v[180:183], v[60:63]
  ds_read_b64_tr_b16 v[140:141], v10 offset:64
  v_mfma_f32_16x16x32_bf16 v[64:67], v[200:203], v[184:187], v[64:67]
  ds_read_b64_tr_b16 v[142:143], v10 offset:1856
  v_mfma_f32_16x16x32_bf16 v[68:71], v[204:207], v[184:187], v[68:71]
  ds_read_b128 v[168:171], v13 offset:6144
  v_mfma_f32_16x16x32_bf16 v[72:75], v[208:211], v[184:187], v[72:75]
  ds_read_b64_tr_b16 v[144:145], v10 offset:192
  v_mfma_f32_16x16x32_bf16 v[76:79], v[212:215], v[184:187], v[76:79]
  ds_read_b64_tr_b16 v[146:147], v10 offset:1984
  v_mfma_f32_16x16x32_bf16 v[80:83], v[188:191], v[200:203], v[80:83]
  ds_read_b64_tr_b16 v[148:149], v7 offset:256
  v_mfma_f32_16x16x32_bf16 v[84:87], v[188:191], v[204:207], v[84:87]
  ds_read_b64_tr_b16 v[150:151], v7 offset:2048
  v_mfma_f32_16x16x32_bf16 v[88:91], v[188:191], v[208:211], v[88:91]
  ds_read_b64_tr_b16 v[152:153], v10 offset:256
  v_mfma_f32_16x16x32_bf16 v[92:95], v[188:191], v[212:215], v[92:95]
  ds_read_b64_tr_b16 v[154:155], v10 offset:2048
  v_mfma_f32_16x16x32_bf16 v[96:99], v[192:195], v[200:203], v[96:99]
  v_add_u32 v14, s15, v12
  v_mfma_f32_16x16x32_bf16 v[100:103], v[192:195], v[204:207], v[100:103]
  v_mfma_f32_16x16x32_bf16 v[104:107], v[192:195], v[208:211], v[104:107]
  v_mfma_f32_16x16x32_bf16 v[108:111], v[192:195], v[212:215], v[108:111]
  v_mfma_f32_16x16x32_bf16 v[112:115], v[196:199], v[200:203], v[112:115]
  v_mfma_f32_16x16x32_bf16 v[116:119], v[196:199], v[204:207], v[116:119]
  v_mfma_f32_16x16x32_bf16 v[120:123], v[196:199], v[208:211], v[120:123]
  v_mfma_f32_16x16x32_bf16 v[124:127], v[196:199], v[212:215], v[124:127]
  s_mov_b32 s16, 14
  .p2align 3
g3_kernel_cloop10:
  s_waitcnt lgkmcnt(15)
  v_mfma_f32_16x16x32_bf16 v[16:19], v[156:159], v[128:131], v[16:19]
  ds_read_b64_tr_b16 v[172:173], v8 offset:14336
  s_waitcnt lgkmcnt(13)
  v_mfma_f32_16x16x32_bf16 v[20:23], v[160:163], v[128:131], v[20:23]
  ds_read_b64_tr_b16 v[174:175], v8 offset:16128
  v_mfma_f32_16x16x32_bf16 v[32:35], v[156:159], v[132:135], v[32:35]
  ds_read_b128 v[200:203], v14 offset:1024
  v_mfma_f32_16x16x32_bf16 v[36:39], v[160:163], v[132:135], v[36:39]
  ds_read_b64_tr_b16 v[176:177], v11 offset:14336
  s_waitcnt lgkmcnt(13)
  v_mfma_f32_16x16x32_bf16 v[24:27], v[164:167], v[128:131], v[24:27]
  ds_read_b64_tr_b16 v[178:179], v11 offset:16128
  v_mfma_f32_16x16x32_bf16 v[40:43], v[164:167], v[132:135], v[40:43]
  ds_read_b128 v[204:207], v14 offset:3072
  v_mfma_f32_16x16x32_bf16 v[48:51], v[156:159], v[136:139], v[48:51]
  ds_read_b64_tr_b16 v[180:181], v8 offset:14400
  v_mfma_f32_16x16x32_bf16 v[52:55], v[160:163], v[136:139], v[52:55]
  ds_read_b64_tr_b16 v[182:183], v8 offset:16192
  v_mfma_f32_16x16x32_bf16 v[56:59], v[164:167], v[136:139], v[56:59]
  ds_read_b128 v[208:211], v14 offset:5120
  s_waitcnt lgkmcnt(15)
  v_mfma_f32_16x16x32_bf16 v[28:31], v[168:171], v[128:131], v[28:31]
  ds_read_b64_tr_b16 v[184:185], v11 offset:14400
  v_mfma_f32_16x16x32_bf16 v[44:47], v[168:171], v[132:135], v[44:47]
  ds_read_b64_tr_b16 v[186:187], v11 offset:16192
  v_mfma_f32_16x16x32_bf16 v[60:63], v[168:171], v[136:139], v[60:63]
  ds_read_b128 v[212:215], v14 offset:7168
  v_mfma_f32_16x16x32_bf16 v[64:67], v[156:159], v[140:143], v[64:67]
  ds_read_b64_tr_b16 v[188:189], v11 offset:14528
  v_mfma_f32_16x16x32_bf16 v[68:71], v[160:163], v[140:143], v[68:71]
  ds_read_b64_tr_b16 v[190:191], v11 offset:16320
  v_mfma_f32_16x16x32_bf16 v[72:75], v[164:167], v[140:143], v[72:75]
  ds_read_b64_tr_b16 v[192:193], v8 offset:14592
  v_mfma_f32_16x16x32_bf16 v[76:79], v[168:171], v[140:143], v[76:79]
  ds_read_b64_tr_b16 v[194:195], v8 offset:16384
  s_waitcnt lgkmcnt(15)
  v_mfma_f32_16x16x32_bf16 v[80:83], v[144:147], v[156:159], v[80:83]
  ds_read_b64_tr_b16 v[196:197], v11 offset:14592
  v_mfma_f32_16x16x32_bf16 v[84:87], v[144:147], v[160:163], v[84:87]
  ds_read_b64_tr_b16 v[198:199], v11 offset:16384
  v_mfma_f32_16x16x32_bf16 v[88:91], v[144:147], v[164:167], v[88:91]
  s_add_u32 s15, s15, 45056
  s_cmp_ge_u32 s15, 135168
  s_cselect_b32 s3, 135168, 0
  s_sub_u32 s15, s15, s3
  v_mfma_f32_16x16x32_bf16 v[92:95], v[144:147], v[168:171], v[92:95]
  v_add_u32 v7, s15, v6
  s_waitcnt lgkmcnt(15)
  v_mfma_f32_16x16x32_bf16 v[96:99], v[148:151], v[156:159], v[96:99]
  v_add_u32 v10, s15, v9
  v_mfma_f32_16x16x32_bf16 v[100:103], v[148:151], v[160:163], v[100:103]
  v_add_u32 v13, s15, v12
  v_mfma_f32_16x16x32_bf16 v[104:107], v[148:151], v[164:167], v[104:107]
  v_mfma_f32_16x16x32_bf16 v[108:111], v[148:151], v[168:171], v[108:111]
  s_waitcnt lgkmcnt(15)
  v_mfma_f32_16x16x32_bf16 v[112:115], v[152:155], v[156:159], v[112:115]
  v_mfma_f32_16x16x32_bf16 v[116:119], v[152:155], v[160:163], v[116:119]
  v_mfma_f32_16x16x32_bf16 v[120:123], v[152:155], v[164:167], v[120:123]
  v_mfma_f32_16x16x32_bf16 v[124:127], v[152:155], v[168:171], v[124:127]
  s_waitcnt lgkmcnt(15)
  v_mfma_f32_16x16x32_bf16 v[16:19], v[200:203], v[172:175], v[16:19]
  v_add_u32 v8, s15, v6
  s_waitcnt lgkmcnt(12)
  v_mfma_f32_16x16x32_bf16 v[20:23], v[204:207], v[172:175], v[20:23]
  v_add_u32 v11, s15, v9
  s_waitcnt lgkmcnt(0)
  s_barrier
  v_mfma_f32_16x16x32_bf16 v[32:35], v[200:203], v[176:179], v[32:35]
  ds_read_b64_tr_b16 v[128:129], v7 offset:0
  v_mfma_f32_16x16x32_bf16 v[36:39], v[204:207], v[176:179], v[36:39]
  ds_read_b64_tr_b16 v[130:131], v7 offset:1792
  v_mfma_f32_16x16x32_bf16 v[24:27], v[208:211], v[172:175], v[24:27]
  ds_read_b128 v[156:159], v13 offset:0
  v_mfma_f32_16x16x32_bf16 v[40:43], v[208:211], v[176:179], v[40:43]
  ds_read_b64_tr_b16 v[132:133], v10 offset:0
  v_mfma_f32_16x16x32_bf16 v[48:51], v[200:203], v[180:183], v[48:51]
  ds_read_b64_tr_b16 v[134:135], v10 offset:1792
  v_mfma_f32_16x16x32_bf16 v[52:55], v[204:207], v[180:183], v[52:55]
  ds_read_b128 v[160:163], v13 offset:2048
  v_mfma_f32_16x16x32_bf16 v[56:59], v[208:211], v[180:183], v[56:59]
  ds_read_b64_tr_b16 v[136:137], v7 offset:64
  v_mfma_f32_16x16x32_bf16 v[28:31], v[212:215], v[172:175], v[28:31]
  ds_read_b64_tr_b16 v[138:139], v7 offset:1856
  v_mfma_f32_16x16x32_bf16 v[44:47], v[212:215], v[176:179], v[44:47]
  ds_read_b128 v[164:167], v13 offset:4096
  v_mfma_f32_16x16x32_bf16 v[60:63], v[212:215], v[180:183], v[60:63]
  ds_read_b64_tr_b16 v[140:141], v10 offset:64
  v_mfma_f32_16x16x32_bf16 v[64:67], v[200:203], v[184:187], v[64:67]
  ds_read_b64_tr_b16 v[142:143], v10 offset:1856
  v_mfma_f32_16x16x32_bf16 v[68:71], v[204:207], v[184:187], v[68:71]
  ds_read_b128 v[168:171], v13 offset:6144
  v_mfma_f32_16x16x32_bf16 v[72:75], v[208:211], v[184:187], v[72:75]
  ds_read_b64_tr_b16 v[144:145], v10 offset:192
  v_mfma_f32_16x16x32_bf16 v[76:79], v[212:215], v[184:187], v[76:79]
  ds_read_b64_tr_b16 v[146:147], v10 offset:1984
  v_mfma_f32_16x16x32_bf16 v[80:83], v[188:191], v[200:203], v[80:83]
  ds_read_b64_tr_b16 v[148:149], v7 offset:256
  v_mfma_f32_16x16x32_bf16 v[84:87], v[188:191], v[204:207], v[84:87]
  ds_read_b64_tr_b16 v[150:151], v7 offset:2048
  v_mfma_f32_16x16x32_bf16 v[88:91], v[188:191], v[208:211], v[88:91]
  ds_read_b64_tr_b16 v[152:153], v10 offset:256
  v_mfma_f32_16x16x32_bf16 v[92:95], v[188:191], v[212:215], v[92:95]
  ds_read_b64_tr_b16 v[154:155], v10 offset:2048
  v_mfma_f32_16x16x32_bf16 v[96:99], v[192:195], v[200:203], v[96:99]
  v_add_u32 v14, s15, v12
  v_mfma_f32_16x16x32_bf16 v[100:103], v[192:195], v[204:207], v[100:103]
  v_mfma_f32_16x16x32_bf16 v[104:107], v[192:195], v[208:211], v[104:107]
  v_mfma_f32_16x16x32_bf16 v[108:111], v[192:195], v[212:215], v[108:111]
  v_mfma_f32_16x16x32_bf16 v[112:115], v[196:199], v[200:203], v[112:115]
  v_mfma_f32_16x16x32_bf16 v[116:119], v[196:199], v[204:207], v[116:119]
  v_mfma_f32_16x16x32_bf16 v[120:123], v[196:199], v[208:211], v[120:123]
  v_mfma_f32_16x16x32_bf16 v[124:127], v[196:199], v[212:215], v[124:127]
  s_sub_u32 s16, s16, 1
  s_cmp_lg_u32 s16, 0
  s_cbranch_scc1 g3_kernel_cloop10
  s_waitcnt lgkmcnt(15)
  v_mfma_f32_16x16x32_bf16 v[16:19], v[156:159], v[128:131], v[16:19]
  ds_read_b64_tr_b16 v[172:173], v8 offset:14336
  s_waitcnt lgkmcnt(13)
  v_mfma_f32_16x16x32_bf16 v[20:23], v[160:163], v[128:131], v[20:23]
  ds_read_b64_tr_b16 v[174:175], v8 offset:16128
  v_mfma_f32_16x16x32_bf16 v[32:35], v[156:159], v[132:135], v[32:35]
  ds_read_b128 v[200:203], v14 offset:1024
  v_mfma_f32_16x16x32_bf16 v[36:39], v[160:163], v[132:135], v[36:39]
  ds_read_b64_tr_b16 v[176:177], v11 offset:14336
  s_waitcnt lgkmcnt(13)
  v_mfma_f32_16x16x32_bf16 v[24:27], v[164:167], v[128:131], v[24:27]
  ds_read_b64_tr_b16 v[178:179], v11 offset:16128
  v_mfma_f32_16x16x32_bf16 v[40:43], v[164:167], v[132:135], v[40:43]
  ds_read_b128 v[204:207], v14 offset:3072
  v_mfma_f32_16x16x32_bf16 v[48:51], v[156:159], v[136:139], v[48:51]
  ds_read_b64_tr_b16 v[180:181], v8 offset:14400
  v_mfma_f32_16x16x32_bf16 v[52:55], v[160:163], v[136:139], v[52:55]
  ds_read_b64_tr_b16 v[182:183], v8 offset:16192
  v_mfma_f32_16x16x32_bf16 v[56:59], v[164:167], v[136:139], v[56:59]
  ds_read_b128 v[208:211], v14 offset:5120
  s_waitcnt lgkmcnt(15)
  v_mfma_f32_16x16x32_bf16 v[28:31], v[168:171], v[128:131], v[28:31]
  ds_read_b64_tr_b16 v[184:185], v11 offset:14400
  v_mfma_f32_16x16x32_bf16 v[44:47], v[168:171], v[132:135], v[44:47]
  ds_read_b64_tr_b16 v[186:187], v11 offset:16192
  v_mfma_f32_16x16x32_bf16 v[60:63], v[168:171], v[136:139], v[60:63]
  ds_read_b128 v[212:215], v14 offset:7168
  v_mfma_f32_16x16x32_bf16 v[64:67], v[156:159], v[140:143], v[64:67]
  ds_read_b64_tr_b16 v[188:189], v11 offset:14528
  v_mfma_f32_16x16x32_bf16 v[68:71], v[160:163], v[140:143], v[68:71]
  ds_read_b64_tr_b16 v[190:191], v11 offset:16320
  v_mfma_f32_16x16x32_bf16 v[72:75], v[164:167], v[140:143], v[72:75]
  ds_read_b64_tr_b16 v[192:193], v8 offset:14592
  v_mfma_f32_16x16x32_bf16 v[76:79], v[168:171], v[140:143], v[76:79]
  ds_read_b64_tr_b16 v[194:195], v8 offset:16384
  s_waitcnt lgkmcnt(15)
  v_mfma_f32_16x16x32_bf16 v[80:83], v[144:147], v[156:159], v[80:83]
  ds_read_b64_tr_b16 v[196:197], v11 offset:14592
  v_mfma_f32_16x16x32_bf16 v[84:87], v[144:147], v[160:163], v[84:87]
  ds_read_b64_tr_b16 v[198:199], v11 offset:16384
  v_mfma_f32_16x16x32_bf16 v[88:91], v[144:147], v[164:167], v[88:91]
  v_mfma_f32_16x16x32_bf16 v[92:95], v[144:147], v[168:171], v[92:95]
  s_waitcnt lgkmcnt(15)
  v_mfma_f32_16x16x32_bf16 v[96:99], v[148:151], v[156:159], v[96:99]
  v_mfma_f32_16x16x32_bf16 v[100:103], v[148:151], v[160:163], v[100:103]
  v_mfma_f32_16x16x32_bf16 v[104:107], v[148:151], v[164:167], v[104:107]
  v_mfma_f32_16x16x32_bf16 v[108:111], v[148:151], v[168:171], v[108:111]
  s_waitcnt lgkmcnt(15)
  v_mfma_f32_16x16x32_bf16 v[112:115], v[152:155], v[156:159], v[112:115]
  v_mfma_f32_16x16x32_bf16 v[116:119], v[152:155], v[160:163], v[116:119]
  v_mfma_f32_16x16x32_bf16 v[120:123], v[152:155], v[164:167], v[120:123]
  v_mfma_f32_16x16x32_bf16 v[124:127], v[152:155], v[168:171], v[124:127]
  s_waitcnt lgkmcnt(15)
  v_mfma_f32_16x16x32_bf16 v[16:19], v[200:203], v[172:175], v[16:19]
  s_waitcnt lgkmcnt(12)
  v_mfma_f32_16x16x32_bf16 v[20:23], v[204:207], v[172:175], v[20:23]
  v_mfma_f32_16x16x32_bf16 v[32:35], v[200:203], v[176:179], v[32:35]
  v_mfma_f32_16x16x32_bf16 v[36:39], v[204:207], v[176:179], v[36:39]
  s_waitcnt lgkmcnt(9)
  v_mfma_f32_16x16x32_bf16 v[24:27], v[208:211], v[172:175], v[24:27]
  v_mfma_f32_16x16x32_bf16 v[40:43], v[208:211], v[176:179], v[40:43]
  v_mfma_f32_16x16x32_bf16 v[48:51], v[200:203], v[180:183], v[48:51]
  v_mfma_f32_16x16x32_bf16 v[52:55], v[204:207], v[180:183], v[52:55]
  v_mfma_f32_16x16x32_bf16 v[56:59], v[208:211], v[180:183], v[56:59]
  s_waitcnt lgkmcnt(6)
  v_mfma_f32_16x16x32_bf16 v[28:31], v[212:215], v[172:175], v[28:31]
  v_mfma_f32_16x16x32_bf16 v[44:47], v[212:215], v[176:179], v[44:47]
  v_mfma_f32_16x16x32_bf16 v[60:63], v[212:215], v[180:183], v[60:63]
  v_mfma_f32_16x16x32_bf16 v[64:67], v[200:203], v[184:187], v[64:67]
  v_mfma_f32_16x16x32_bf16 v[68:71], v[204:207], v[184:187], v[68:71]
  v_mfma_f32_16x16x32_bf16 v[72:75], v[208:211], v[184:187], v[72:75]
  v_mfma_f32_16x16x32_bf16 v[76:79], v[212:215], v[184:187], v[76:79]
  s_waitcnt lgkmcnt(4)
  v_mfma_f32_16x16x32_bf16 v[80:83], v[188:191], v[200:203], v[80:83]
  v_mfma_f32_16x16x32_bf16 v[84:87], v[188:191], v[204:207], v[84:87]
  v_mfma_f32_16x16x32_bf16 v[88:91], v[188:191], v[208:211], v[88:91]
  v_mfma_f32_16x16x32_bf16 v[92:95], v[188:191], v[212:215], v[92:95]
  s_waitcnt lgkmcnt(2)
  v_mfma_f32_16x16x32_bf16 v[96:99], v[192:195], v[200:203], v[96:99]
  v_mfma_f32_16x16x32_bf16 v[100:103], v[192:195], v[204:207], v[100:103]
  v_mfma_f32_16x16x32_bf16 v[104:107], v[192:195], v[208:211], v[104:107]
  v_mfma_f32_16x16x32_bf16 v[108:111], v[192:195], v[212:215], v[108:111]
  s_waitcnt lgkmcnt(0)
  v_mfma_f32_16x16x32_bf16 v[112:115], v[196:199], v[200:203], v[112:115]
  v_mfma_f32_16x16x32_bf16 v[116:119], v[196:199], v[204:207], v[116:119]
  v_mfma_f32_16x16x32_bf16 v[120:123], v[196:199], v[208:211], v[120:123]
  v_mfma_f32_16x16x32_bf16 v[124:127], v[196:199], v[212:215], v[124:127]
  s_mul_i32 s3, s14, 14336
  s_add_u32 s3, s3, 45056
  v_lshlrev_b32 v4, 4, v0
  v_add_u32 v4, s3, v4
  ds_write_b128 v4, v[24:27] offset:0
  ds_write_b128 v4, v[28:31] offset:1024
  ds_write_b128 v4, v[40:43] offset:2048
  ds_write_b128 v4, v[44:47] offset:3072
  ds_write_b128 v4, v[56:59] offset:4096
  ds_write_b128 v4, v[60:63] offset:5120
  ds_write_b128 v4, v[72:75] offset:6144
  ds_write_b128 v4, v[76:79] offset:7168
  ds_write_b128 v4, v[88:91] offset:8192
  ds_write_b128 v4, v[92:95] offset:9216
  ds_write_b128 v4, v[104:107] offset:10240
  ds_write_b128 v4, v[108:111] offset:11264
  ds_write_b128 v4, v[120:123] offset:12288
  ds_write_b128 v4, v[124:127] offset:13312
  s_waitcnt lgkmcnt(0)
  s_barrier
g3_kernel_epi0:
  v_lshrrev_b32 v168, 4, v0
  v_lshlrev_b32 v168, 5, v168
  s_lshl_b32 s3, s59, 7
  s_add_u32 s3, s3, 131072
  v_add_u32 v168, s3, v168
  ds_read_b128 v[128:131], v168 offset:0
  ds_read_b128 v[136:139], v168 offset:512
  ds_read_b128 v[132:135], v168 offset:16
  ds_read_b128 v[140:143], v168 offset:528
  v_and_b32 v5, 15, v0
  v_lshlrev_b32 v5, 2, v5
  v_add_u32 v5, 132096, v5
  ds_read_b32 v144, v5 offset:0
  ds_read_b32 v145, v5 offset:64
  ds_read_b32 v146, v5 offset:128
  ds_read_b32 v147, v5 offset:192
  v_lshrrev_b32 v5, 4, v0
  v_lshlrev_b32 v5, 4, v5
  v_add_u32 v5, 132096, v5
  ds_read_b128 v[152:155], v5 offset:448
  ds_read_b128 v[156:159], v5 offset:512
  ds_read_b128 v[160:163], v5 offset:576
  v_and_b32 v5, 15, v0
  v_and_b32 v2, 15, v0
  v_and_b32 v2, 12, v2
  v_add_u32 v5, v5, v2
  v_lshlrev_b32 v5, 2, v5
  v_add_u32 v5, s3, v5
  ds_read_b32 v148, v5 offset:0
  ds_read_b32 v150, v5 offset:512
  ds_read_b32 v149, v5 offset:16
  ds_read_b32 v151, v5 offset:528
  v_and_b32 v4, 15, v0
  v_lshrrev_b32 v4, 2, v4
  v_and_b32 v4, 1, v4
  v_lshlrev_b32 v4, 5, v4
  v_lshrrev_b32 v2, 4, v0
  v_lshlrev_b32 v2, 6, v2
  v_add_u32 v4, v4, v2
  v_and_b32 v2, 15, v0
  v_and_b32 v2, 3, v2
  v_lshlrev_b32 v2, 3, v2
  v_add_u32 v4, v4, v2
  v_and_b32 v2, 15, v0
  v_lshrrev_b32 v2, 3, v2
  v_lshlrev_b32 v2, 2, v2
  v_add_u32 v4, v4, v2
  s_lshl_b32 s56, s13, 15
  s_lshl_b32 s19, s59, 8
  s_add_u32 s56, s56, s19
  s_lshl_b32 s19, s12, 11
  s_add_u32 s26, s56, s19
  v_mov_b32 v2, 1152912344
  v_mov_b32 v3, 1152912344
  s_waitcnt lgkmcnt(0)
  s_setprio 3
  v_pk_mul_f32 v[16:17], v[16:17], v[128:129] op_sel:[0,0] op_sel_hi:[1,1]
  v_pk_fma_f32 v[16:17], v[136:137], v[144:145], v[16:17] op_sel:[0,0,0] op_sel_hi:[1,0,1]
  v_pk_mul_f32 v[18:19], v[18:19], v[130:131] op_sel:[0,0] op_sel_hi:[1,1]
  v_pk_fma_f32 v[18:19], v[138:139], v[144:145], v[18:19] op_sel:[0,0,0] op_sel_hi:[1,0,1]
  v_pk_mul_f32 v[20:21], v[20:21], v[132:133] op_sel:[0,0] op_sel_hi:[1,1]
  v_pk_fma_f32 v[20:21], v[140:141], v[144:145], v[20:21] op_sel:[0,0,0] op_sel_hi:[1,0,1]
  v_pk_mul_f32 v[22:23], v[22:23], v[134:135] op_sel:[0,0] op_sel_hi:[1,1]
  v_pk_fma_f32 v[22:23], v[142:143], v[144:145], v[22:23] op_sel:[0,0,0] op_sel_hi:[1,0,1]
  v_pk_fma_f32 v[172:173], v[16:17], s[78:79], 0.5 op_sel:[0,0,0] op_sel_hi:[1,0,0] clamp
  v_pk_fma_f32 v[174:175], v[18:19], s[78:79], 0.5 op_sel:[0,0,0] op_sel_hi:[1,0,0] clamp
  v_pk_fma_f32 v[176:177], v[20:21], s[78:79], 0.5 op_sel:[0,0,0] op_sel_hi:[1,0,0] clamp
  v_pk_fma_f32 v[178:179], v[22:23], s[78:79], 0.5 op_sel:[0,0,0] op_sel_hi:[1,0,0] clamp
  v_pk_fma_f32 v[172:173], v[172:173], v[172:173], v[172:173] neg_lo:[0,0,1] neg_hi:[0,0,1]
  v_pk_fma_f32 v[174:175], v[174:175], v[174:175], v[174:175] neg_lo:[0,0,1] neg_hi:[0,0,1]
  v_pk_fma_f32 v[176:177], v[176:177], v[176:177], v[176:177] neg_lo:[0,0,1] neg_hi:[0,0,1]
  v_pk_fma_f32 v[178:179], v[178:179], v[178:179], v[178:179] neg_lo:[0,0,1] neg_hi:[0,0,1]
  v_pk_fma_f32 v[24:25], v[2:3], v[172:173], s[84:85] op_sel:[0,0,0] op_sel_hi:[1,1,0]
  v_pk_fma_f32 v[26:27], v[2:3], v[174:175], s[84:85] op_sel:[0,0,0] op_sel_hi:[1,1,0]
  v_pk_fma_f32 v[28:29], v[2:3], v[176:177], s[84:85] op_sel:[0,0,0] op_sel_hi:[1,1,0]
  v_pk_fma_f32 v[30:31], v[2:3], v[178:179], s[84:85] op_sel:[0,0,0] op_sel_hi:[1,1,0]
  v_pk_fma_f32 v[24:25], v[24:25], v[172:173], s[82:83] op_sel:[0,0,1] op_sel_hi:[1,1,1]
  v_pk_fma_f32 v[26:27], v[26:27], v[174:175], s[82:83] op_sel:[0,0,1] op_sel_hi:[1,1,1]
  v_pk_fma_f32 v[28:29], v[28:29], v[176:177], s[82:83] op_sel:[0,0,1] op_sel_hi:[1,1,1]
  v_pk_fma_f32 v[30:31], v[30:31], v[178:179], s[82:83] op_sel:[0,0,1] op_sel_hi:[1,1,1]
  v_pk_fma_f32 v[24:25], v[24:25], v[172:173], s[82:83] op_sel:[0,0,0] op_sel_hi:[1,1,0]
  v_pk_fma_f32 v[26:27], v[26:27], v[174:175], s[82:83] op_sel:[0,0,0] op_sel_hi:[1,1,0]
  v_pk_fma_f32 v[28:29], v[28:29], v[176:177], s[82:83] op_sel:[0,0,0] op_sel_hi:[1,1,0]
  v_pk_fma_f32 v[30:31], v[30:31], v[178:179], s[82:83] op_sel:[0,0,0] op_sel_hi:[1,1,0]
  v_pk_fma_f32 v[24:25], v[24:25], v[172:173], s[80:81] op_sel:[0,0,1] op_sel_hi:[1,1,1]
  v_pk_fma_f32 v[26:27], v[26:27], v[174:175], s[80:81] op_sel:[0,0,1] op_sel_hi:[1,1,1]
  v_pk_fma_f32 v[28:29], v[28:29], v[176:177], s[80:81] op_sel:[0,0,1] op_sel_hi:[1,1,1]
  v_pk_fma_f32 v[30:31], v[30:31], v[178:179], s[80:81] op_sel:[0,0,1] op_sel_hi:[1,1,1]
  v_pk_fma_f32 v[24:25], v[24:25], v[172:173], s[80:81] op_sel:[0,0,0] op_sel_hi:[1,1,0]
  v_pk_fma_f32 v[26:27], v[26:27], v[174:175], s[80:81] op_sel:[0,0,0] op_sel_hi:[1,1,0]
  v_pk_fma_f32 v[28:29], v[28:29], v[176:177], s[80:81] op_sel:[0,0,0] op_sel_hi:[1,1,0]
  v_pk_fma_f32 v[30:31], v[30:31], v[178:179], s[80:81] op_sel:[0,0,0] op_sel_hi:[1,1,0]
  v_pk_fma_f32 v[24:25], v[24:25], v[172:173], s[78:79] op_sel:[0,0,1] op_sel_hi:[1,1,1]
  v_pk_fma_f32 v[26:27], v[26:27], v[174:175], s[78:79] op_sel:[0,0,1] op_sel_hi:[1,1,1]
  v_pk_fma_f32 v[28:29], v[28:29], v[176:177], s[78:79] op_sel:[0,0,1] op_sel_hi:[1,1,1]
  v_pk_fma_f32 v[30:31], v[30:31], v[178:179], s[78:79] op_sel:[0,0,1] op_sel_hi:[1,1,1]
  v_pk_fma_f32 v[24:25], v[16:17], v[24:25], 0.5 op_sel:[0,0,0] op_sel_hi:[1,1,0] clamp
  v_pk_fma_f32 v[26:27], v[18:19], v[26:27], 0.5 op_sel:[0,0,0] op_sel_hi:[1,1,0] clamp
  v_pk_fma_f32 v[28:29], v[20:21], v[28:29], 0.5 op_sel:[0,0,0] op_sel_hi:[1,1,0] clamp
  v_pk_fma_f32 v[30:31], v[22:23], v[30:31], 0.5 op_sel:[0,0,0] op_sel_hi:[1,1,0] clamp
  v_pk_mul_f32 v[16:17], v[16:17], v[24:25] op_sel:[0,0] op_sel_hi:[1,1]
  v_pk_mul_f32 v[18:19], v[18:19], v[26:27] op_sel:[0,0] op_sel_hi:[1,1]
  v_pk_mul_f32 v[20:21], v[20:21], v[28:29] op_sel:[0,0] op_sel_hi:[1,1]
  v_pk_mul_f32 v[22:23], v[22:23], v[30:31] op_sel:[0,0] op_sel_hi:[1,1]
  v_pk_mul_f32 v[204:205], v[16:17], v[16:17] op_sel:[0,0] op_sel_hi:[1,1]
  v_pk_mul_f32 v[206:207], v[18:19], v[18:19] op_sel:[0,0] op_sel_hi:[1,1]
  v_pk_mul_f32 v[208:209], v[20:21], v[20:21] op_sel:[0,0] op_sel_hi:[1,1]
  v_pk_mul_f32 v[210:211], v[22:23], v[22:23] op_sel:[0,0] op_sel_hi:[1,1]
  v_pk_mul_f32 v[32:33], v[32:33], v[128:129] op_sel:[0,0] op_sel_hi:[1,1]
  v_pk_fma_f32 v[32:33], v[136:137], v[144:145], v[32:33] op_sel:[0,1,0] op_sel_hi:[1,1,1]
  v_pk_mul_f32 v[34:35], v[34:35], v[130:131] op_sel:[0,0] op_sel_hi:[1,1]
  v_pk_fma_f32 v[34:35], v[138:139], v[144:145], v[34:35] op_sel:[0,1,0] op_sel_hi:[1,1,1]
  v_pk_mul_f32 v[36:37], v[36:37], v[132:133] op_sel:[0,0] op_sel_hi:[1,1]
  v_pk_fma_f32 v[36:37], v[140:141], v[144:145], v[36:37] op_sel:[0,1,0] op_sel_hi:[1,1,1]
  v_pk_mul_f32 v[38:39], v[38:39], v[134:135] op_sel:[0,0] op_sel_hi:[1,1]
  v_pk_fma_f32 v[38:39], v[142:143], v[144:145], v[38:39] op_sel:[0,1,0] op_sel_hi:[1,1,1]
  v_pk_fma_f32 v[172:173], v[32:33], s[78:79], 0.5 op_sel:[0,0,0] op_sel_hi:[1,0,0] clamp
  v_pk_fma_f32 v[174:175], v[34:35], s[78:79], 0.5 op_sel:[0,0,0] op_sel_hi:[1,0,0] clamp
  v_pk_fma_f32 v[176:177], v[36:37], s[78:79], 0.5 op_sel:[0,0,0] op_sel_hi:[1,0,0] clamp
  v_pk_fma_f32 v[178:179], v[38:39], s[78:79], 0.5 op_sel:[0,0,0] op_sel_hi:[1,0,0] clamp
  v_pk_fma_f32 v[172:173], v[172:173], v[172:173], v[172:173] neg_lo:[0,0,1] neg_hi:[0,0,1]
  v_pk_fma_f32 v[174:175], v[174:175], v[174:175], v[174:175] neg_lo:[0,0,1] neg_hi:[0,0,1]
  v_pk_fma_f32 v[176:177], v[176:177], v[176:177], v[176:177] neg_lo:[0,0,1] neg_hi:[0,0,1]
  v_pk_fma_f32 v[178:179], v[178:179], v[178:179], v[178:179] neg_lo:[0,0,1] neg_hi:[0,0,1]
  v_pk_fma_f32 v[24:25], v[2:3], v[172:173], s[84:85] op_sel:[0,0,0] op_sel_hi:[1,1,0]
  v_pk_fma_f32 v[26:27], v[2:3], v[174:175], s[84:85] op_sel:[0,0,0] op_sel_hi:[1,1,0]
  v_pk_fma_f32 v[28:29], v[2:3], v[176:177], s[84:85] op_sel:[0,0,0] op_sel_hi:[1,1,0]
  v_pk_fma_f32 v[30:31], v[2:3], v[178:179], s[84:85] op_sel:[0,0,0] op_sel_hi:[1,1,0]
  v_pk_fma_f32 v[24:25], v[24:25], v[172:173], s[82:83] op_sel:[0,0,1] op_sel_hi:[1,1,1]
  v_pk_fma_f32 v[26:27], v[26:27], v[174:175], s[82:83] op_sel:[0,0,1] op_sel_hi:[1,1,1]
  v_pk_fma_f32 v[28:29], v[28:29], v[176:177], s[82:83] op_sel:[0,0,1] op_sel_hi:[1,1,1]
  v_pk_fma_f32 v[30:31], v[30:31], v[178:179], s[82:83] op_sel:[0,0,1] op_sel_hi:[1,1,1]
  v_pk_fma_f32 v[24:25], v[24:25], v[172:173], s[82:83] op_sel:[0,0,0] op_sel_hi:[1,1,0]
  v_pk_fma_f32 v[26:27], v[26:27], v[174:175], s[82:83] op_sel:[0,0,0] op_sel_hi:[1,1,0]
  v_pk_fma_f32 v[28:29], v[28:29], v[176:177], s[82:83] op_sel:[0,0,0] op_sel_hi:[1,1,0]
  v_pk_fma_f32 v[30:31], v[30:31], v[178:179], s[82:83] op_sel:[0,0,0] op_sel_hi:[1,1,0]
  v_pk_fma_f32 v[24:25], v[24:25], v[172:173], s[80:81] op_sel:[0,0,1] op_sel_hi:[1,1,1]
  v_pk_fma_f32 v[26:27], v[26:27], v[174:175], s[80:81] op_sel:[0,0,1] op_sel_hi:[1,1,1]
  v_pk_fma_f32 v[28:29], v[28:29], v[176:177], s[80:81] op_sel:[0,0,1] op_sel_hi:[1,1,1]
  v_pk_fma_f32 v[30:31], v[30:31], v[178:179], s[80:81] op_sel:[0,0,1] op_sel_hi:[1,1,1]
  v_pk_fma_f32 v[24:25], v[24:25], v[172:173], s[80:81] op_sel:[0,0,0] op_sel_hi:[1,1,0]
  v_pk_fma_f32 v[26:27], v[26:27], v[174:175], s[80:81] op_sel:[0,0,0] op_sel_hi:[1,1,0]
  v_pk_fma_f32 v[28:29], v[28:29], v[176:177], s[80:81] op_sel:[0,0,0] op_sel_hi:[1,1,0]
  v_pk_fma_f32 v[30:31], v[30:31], v[178:179], s[80:81] op_sel:[0,0,0] op_sel_hi:[1,1,0]
  v_pk_fma_f32 v[24:25], v[24:25], v[172:173], s[78:79] op_sel:[0,0,1] op_sel_hi:[1,1,1]
  v_pk_fma_f32 v[26:27], v[26:27], v[174:175], s[78:79] op_sel:[0,0,1] op_sel_hi:[1,1,1]
  v_pk_fma_f32 v[28:29], v[28:29], v[176:177], s[78:79] op_sel:[0,0,1] op_sel_hi:[1,1,1]
  v_pk_fma_f32 v[30:31], v[30:31], v[178:179], s[78:79] op_sel:[0,0,1] op_sel_hi:[1,1,1]
  v_pk_fma_f32 v[24:25], v[32:33], v[24:25], 0.5 op_sel:[0,0,0] op_sel_hi:[1,1,0] clamp
  v_pk_fma_f32 v[26:27], v[34:35], v[26:27], 0.5 op_sel:[0,0,0] op_sel_hi:[1,1,0] clamp
  v_pk_fma_f32 v[28:29], v[36:37], v[28:29], 0.5 op_sel:[0,0,0] op_sel_hi:[1,1,0] clamp
  v_pk_fma_f32 v[30:31], v[38:39], v[30:31], 0.5 op_sel:[0,0,0] op_sel_hi:[1,1,0] clamp
  v_pk_mul_f32 v[32:33], v[32:33], v[24:25] op_sel:[0,0] op_sel_hi:[1,1]
  v_pk_mul_f32 v[34:35], v[34:35], v[26:27] op_sel:[0,0] op_sel_hi:[1,1]
  v_pk_mul_f32 v[36:37], v[36:37], v[28:29] op_sel:[0,0] op_sel_hi:[1,1]
  v_pk_mul_f32 v[38:39], v[38:39], v[30:31] op_sel:[0,0] op_sel_hi:[1,1]
  v_pk_add_f32 v[196:197], v[16:17], v[32:33] op_sel:[0,0] op_sel_hi:[1,1]
  v_pk_fma_f32 v[204:205], v[32:33], v[32:33], v[204:205] op_sel:[0,0,0] op_sel_hi:[1,1,1]
  v_pk_add_f32 v[198:199], v[18:19], v[34:35] op_sel:[0,0] op_sel_hi:[1,1]
  v_pk_fma_f32 v[206:207], v[34:35], v[34:35], v[206:207] op_sel:[0,0,0] op_sel_hi:[1,1,1]
  v_pk_add_f32 v[200:201], v[20:21], v[36:37] op_sel:[0,0] op_sel_hi:[1,1]
  v_pk_fma_f32 v[208:209], v[36:37], v[36:37], v[208:209] op_sel:[0,0,0] op_sel_hi:[1,1,1]
  v_pk_add_f32 v[202:203], v[22:23], v[38:39] op_sel:[0,0] op_sel_hi:[1,1]
  v_pk_fma_f32 v[210:211], v[38:39], v[38:39], v[210:211] op_sel:[0,0,0] op_sel_hi:[1,1,1]
  v_pk_mul_f32 v[48:49], v[48:49], v[128:129] op_sel:[0,0] op_sel_hi:[1,1]
  v_pk_fma_f32 v[48:49], v[136:137], v[146:147], v[48:49] op_sel:[0,0,0] op_sel_hi:[1,0,1]
  v_pk_mul_f32 v[50:51], v[50:51], v[130:131] op_sel:[0,0] op_sel_hi:[1,1]
  v_pk_fma_f32 v[50:51], v[138:139], v[146:147], v[50:51] op_sel:[0,0,0] op_sel_hi:[1,0,1]
  v_pk_mul_f32 v[52:53], v[52:53], v[132:133] op_sel:[0,0] op_sel_hi:[1,1]
  v_pk_fma_f32 v[52:53], v[140:141], v[146:147], v[52:53] op_sel:[0,0,0] op_sel_hi:[1,0,1]
  v_pk_mul_f32 v[54:55], v[54:55], v[134:135] op_sel:[0,0] op_sel_hi:[1,1]
  v_pk_fma_f32 v[54:55], v[142:143], v[146:147], v[54:55] op_sel:[0,0,0] op_sel_hi:[1,0,1]
  v_pk_fma_f32 v[172:173], v[48:49], s[78:79], 0.5 op_sel:[0,0,0] op_sel_hi:[1,0,0] clamp
  v_pk_fma_f32 v[174:175], v[50:51], s[78:79], 0.5 op_sel:[0,0,0] op_sel_hi:[1,0,0] clamp
  v_pk_fma_f32 v[176:177], v[52:53], s[78:79], 0.5 op_sel:[0,0,0] op_sel_hi:[1,0,0] clamp
  v_pk_fma_f32 v[178:179], v[54:55], s[78:79], 0.5 op_sel:[0,0,0] op_sel_hi:[1,0,0] clamp
  v_pk_fma_f32 v[172:173], v[172:173], v[172:173], v[172:173] neg_lo:[0,0,1] neg_hi:[0,0,1]
  v_pk_fma_f32 v[174:175], v[174:175], v[174:175], v[174:175] neg_lo:[0,0,1] neg_hi:[0,0,1]
  v_pk_fma_f32 v[176:177], v[176:177], v[176:177], v[176:177] neg_lo:[0,0,1] neg_hi:[0,0,1]
  v_pk_fma_f32 v[178:179], v[178:179], v[178:179], v[178:179] neg_lo:[0,0,1] neg_hi:[0,0,1]
  v_pk_fma_f32 v[24:25], v[2:3], v[172:173], s[84:85] op_sel:[0,0,0] op_sel_hi:[1,1,0]
  v_pk_fma_f32 v[26:27], v[2:3], v[174:175], s[84:85] op_sel:[0,0,0] op_sel_hi:[1,1,0]
  v_pk_fma_f32 v[28:29], v[2:3], v[176:177], s[84:85] op_sel:[0,0,0] op_sel_hi:[1,1,0]
  v_pk_fma_f32 v[30:31], v[2:3], v[178:179], s[84:85] op_sel:[0,0,0] op_sel_hi:[1,1,0]
  v_pk_fma_f32 v[24:25], v[24:25], v[172:173], s[82:83] op_sel:[0,0,1] op_sel_hi:[1,1,1]
  v_pk_fma_f32 v[26:27], v[26:27], v[174:175], s[82:83] op_sel:[0,0,1] op_sel_hi:[1,1,1]
  v_pk_fma_f32 v[28:29], v[28:29], v[176:177], s[82:83] op_sel:[0,0,1] op_sel_hi:[1,1,1]
  v_pk_fma_f32 v[30:31], v[30:31], v[178:179], s[82:83] op_sel:[0,0,1] op_sel_hi:[1,1,1]
  v_pk_fma_f32 v[24:25], v[24:25], v[172:173], s[82:83] op_sel:[0,0,0] op_sel_hi:[1,1,0]
  v_pk_fma_f32 v[26:27], v[26:27], v[174:175], s[82:83] op_sel:[0,0,0] op_sel_hi:[1,1,0]
  v_pk_fma_f32 v[28:29], v[28:29], v[176:177], s[82:83] op_sel:[0,0,0] op_sel_hi:[1,1,0]
  v_pk_fma_f32 v[30:31], v[30:31], v[178:179], s[82:83] op_sel:[0,0,0] op_sel_hi:[1,1,0]
  v_pk_fma_f32 v[24:25], v[24:25], v[172:173], s[80:81] op_sel:[0,0,1] op_sel_hi:[1,1,1]
  v_pk_fma_f32 v[26:27], v[26:27], v[174:175], s[80:81] op_sel:[0,0,1] op_sel_hi:[1,1,1]
  v_pk_fma_f32 v[28:29], v[28:29], v[176:177], s[80:81] op_sel:[0,0,1] op_sel_hi:[1,1,1]
  v_pk_fma_f32 v[30:31], v[30:31], v[178:179], s[80:81] op_sel:[0,0,1] op_sel_hi:[1,1,1]
  v_pk_fma_f32 v[24:25], v[24:25], v[172:173], s[80:81] op_sel:[0,0,0] op_sel_hi:[1,1,0]
  v_pk_fma_f32 v[26:27], v[26:27], v[174:175], s[80:81] op_sel:[0,0,0] op_sel_hi:[1,1,0]
  v_pk_fma_f32 v[28:29], v[28:29], v[176:177], s[80:81] op_sel:[0,0,0] op_sel_hi:[1,1,0]
  v_pk_fma_f32 v[30:31], v[30:31], v[178:179], s[80:81] op_sel:[0,0,0] op_sel_hi:[1,1,0]
  v_pk_fma_f32 v[24:25], v[24:25], v[172:173], s[78:79] op_sel:[0,0,1] op_sel_hi:[1,1,1]
  v_pk_fma_f32 v[26:27], v[26:27], v[174:175], s[78:79] op_sel:[0,0,1] op_sel_hi:[1,1,1]
  v_pk_fma_f32 v[28:29], v[28:29], v[176:177], s[78:79] op_sel:[0,0,1] op_sel_hi:[1,1,1]
  v_pk_fma_f32 v[30:31], v[30:31], v[178:179], s[78:79] op_sel:[0,0,1] op_sel_hi:[1,1,1]
  v_pk_fma_f32 v[24:25], v[48:49], v[24:25], 0.5 op_sel:[0,0,0] op_sel_hi:[1,1,0] clamp
  v_pk_fma_f32 v[26:27], v[50:51], v[26:27], 0.5 op_sel:[0,0,0] op_sel_hi:[1,1,0] clamp
  v_pk_fma_f32 v[28:29], v[52:53], v[28:29], 0.5 op_sel:[0,0,0] op_sel_hi:[1,1,0] clamp
  v_pk_fma_f32 v[30:31], v[54:55], v[30:31], 0.5 op_sel:[0,0,0] op_sel_hi:[1,1,0] clamp
  v_pk_mul_f32 v[48:49], v[48:49], v[24:25] op_sel:[0,0] op_sel_hi:[1,1]
  v_pk_mul_f32 v[50:51], v[50:51], v[26:27] op_sel:[0,0] op_sel_hi:[1,1]
  v_pk_mul_f32 v[52:53], v[52:53], v[28:29] op_sel:[0,0] op_sel_hi:[1,1]
  v_pk_mul_f32 v[54:55], v[54:55], v[30:31] op_sel:[0,0] op_sel_hi:[1,1]
  v_pk_add_f32 v[196:197], v[196:197], v[48:49] op_sel:[0,0] op_sel_hi:[1,1]
  v_pk_fma_f32 v[204:205], v[48:49], v[48:49], v[204:205] op_sel:[0,0,0] op_sel_hi:[1,1,1]
  v_pk_add_f32 v[198:199], v[198:199], v[50:51] op_sel:[0,0] op_sel_hi:[1,1]
  v_pk_fma_f32 v[206:207], v[50:51], v[50:51], v[206:207] op_sel:[0,0,0] op_sel_hi:[1,1,1]
  v_pk_add_f32 v[200:201], v[200:201], v[52:53] op_sel:[0,0] op_sel_hi:[1,1]
  v_pk_fma_f32 v[208:209], v[52:53], v[52:53], v[208:209] op_sel:[0,0,0] op_sel_hi:[1,1,1]
  v_pk_add_f32 v[202:203], v[202:203], v[54:55] op_sel:[0,0] op_sel_hi:[1,1]
  v_pk_fma_f32 v[210:211], v[54:55], v[54:55], v[210:211] op_sel:[0,0,0] op_sel_hi:[1,1,1]
  v_pk_mul_f32 v[64:65], v[64:65], v[128:129] op_sel:[0,0] op_sel_hi:[1,1]
  v_pk_fma_f32 v[64:65], v[136:137], v[146:147], v[64:65] op_sel:[0,1,0] op_sel_hi:[1,1,1]
  v_pk_mul_f32 v[66:67], v[66:67], v[130:131] op_sel:[0,0] op_sel_hi:[1,1]
  v_pk_fma_f32 v[66:67], v[138:139], v[146:147], v[66:67] op_sel:[0,1,0] op_sel_hi:[1,1,1]
  v_pk_mul_f32 v[68:69], v[68:69], v[132:133] op_sel:[0,0] op_sel_hi:[1,1]
  v_pk_fma_f32 v[68:69], v[140:141], v[146:147], v[68:69] op_sel:[0,1,0] op_sel_hi:[1,1,1]
  v_pk_mul_f32 v[70:71], v[70:71], v[134:135] op_sel:[0,0] op_sel_hi:[1,1]
  v_pk_fma_f32 v[70:71], v[142:143], v[146:147], v[70:71] op_sel:[0,1,0] op_sel_hi:[1,1,1]
  v_pk_fma_f32 v[172:173], v[64:65], s[78:79], 0.5 op_sel:[0,0,0] op_sel_hi:[1,0,0] clamp
  v_pk_fma_f32 v[174:175], v[66:67], s[78:79], 0.5 op_sel:[0,0,0] op_sel_hi:[1,0,0] clamp
  v_pk_fma_f32 v[176:177], v[68:69], s[78:79], 0.5 op_sel:[0,0,0] op_sel_hi:[1,0,0] clamp
  v_pk_fma_f32 v[178:179], v[70:71], s[78:79], 0.5 op_sel:[0,0,0] op_sel_hi:[1,0,0] clamp
  v_pk_fma_f32 v[172:173], v[172:173], v[172:173], v[172:173] neg_lo:[0,0,1] neg_hi:[0,0,1]
  v_pk_fma_f32 v[174:175], v[174:175], v[174:175], v[174:175] neg_lo:[0,0,1] neg_hi:[0,0,1]
  v_pk_fma_f32 v[176:177], v[176:177], v[176:177], v[176:177] neg_lo:[0,0,1] neg_hi:[0,0,1]
  v_pk_fma_f32 v[178:179], v[178:179], v[178:179], v[178:179] neg_lo:[0,0,1] neg_hi:[0,0,1]
  v_pk_fma_f32 v[24:25], v[2:3], v[172:173], s[84:85] op_sel:[0,0,0] op_sel_hi:[1,1,0]
  v_pk_fma_f32 v[26:27], v[2:3], v[174:175], s[84:85] op_sel:[0,0,0] op_sel_hi:[1,1,0]
  v_pk_fma_f32 v[28:29], v[2:3], v[176:177], s[84:85] op_sel:[0,0,0] op_sel_hi:[1,1,0]
  v_pk_fma_f32 v[30:31], v[2:3], v[178:179], s[84:85] op_sel:[0,0,0] op_sel_hi:[1,1,0]
  v_pk_fma_f32 v[24:25], v[24:25], v[172:173], s[82:83] op_sel:[0,0,1] op_sel_hi:[1,1,1]
  v_pk_fma_f32 v[26:27], v[26:27], v[174:175], s[82:83] op_sel:[0,0,1] op_sel_hi:[1,1,1]
  v_pk_fma_f32 v[28:29], v[28:29], v[176:177], s[82:83] op_sel:[0,0,1] op_sel_hi:[1,1,1]
  v_pk_fma_f32 v[30:31], v[30:31], v[178:179], s[82:83] op_sel:[0,0,1] op_sel_hi:[1,1,1]
  v_pk_fma_f32 v[24:25], v[24:25], v[172:173], s[82:83] op_sel:[0,0,0] op_sel_hi:[1,1,0]
  v_pk_fma_f32 v[26:27], v[26:27], v[174:175], s[82:83] op_sel:[0,0,0] op_sel_hi:[1,1,0]
  v_pk_fma_f32 v[28:29], v[28:29], v[176:177], s[82:83] op_sel:[0,0,0] op_sel_hi:[1,1,0]
  v_pk_fma_f32 v[30:31], v[30:31], v[178:179], s[82:83] op_sel:[0,0,0] op_sel_hi:[1,1,0]
  v_pk_fma_f32 v[24:25], v[24:25], v[172:173], s[80:81] op_sel:[0,0,1] op_sel_hi:[1,1,1]
  v_pk_fma_f32 v[26:27], v[26:27], v[174:175], s[80:81] op_sel:[0,0,1] op_sel_hi:[1,1,1]
  v_pk_fma_f32 v[28:29], v[28:29], v[176:177], s[80:81] op_sel:[0,0,1] op_sel_hi:[1,1,1]
  v_pk_fma_f32 v[30:31], v[30:31], v[178:179], s[80:81] op_sel:[0,0,1] op_sel_hi:[1,1,1]
  v_pk_fma_f32 v[24:25], v[24:25], v[172:173], s[80:81] op_sel:[0,0,0] op_sel_hi:[1,1,0]
  v_pk_fma_f32 v[26:27], v[26:27], v[174:175], s[80:81] op_sel:[0,0,0] op_sel_hi:[1,1,0]
  v_pk_fma_f32 v[28:29], v[28:29], v[176:177], s[80:81] op_sel:[0,0,0] op_sel_hi:[1,1,0]
  v_pk_fma_f32 v[30:31], v[30:31], v[178:179], s[80:81] op_sel:[0,0,0] op_sel_hi:[1,1,0]
  v_pk_fma_f32 v[24:25], v[24:25], v[172:173], s[78:79] op_sel:[0,0,1] op_sel_hi:[1,1,1]
  v_pk_fma_f32 v[26:27], v[26:27], v[174:175], s[78:79] op_sel:[0,0,1] op_sel_hi:[1,1,1]
  v_pk_fma_f32 v[28:29], v[28:29], v[176:177], s[78:79] op_sel:[0,0,1] op_sel_hi:[1,1,1]
  v_pk_fma_f32 v[30:31], v[30:31], v[178:179], s[78:79] op_sel:[0,0,1] op_sel_hi:[1,1,1]
  v_pk_fma_f32 v[24:25], v[64:65], v[24:25], 0.5 op_sel:[0,0,0] op_sel_hi:[1,1,0] clamp
  v_pk_fma_f32 v[26:27], v[66:67], v[26:27], 0.5 op_sel:[0,0,0] op_sel_hi:[1,1,0] clamp
  v_pk_fma_f32 v[28:29], v[68:69], v[28:29], 0.5 op_sel:[0,0,0] op_sel_hi:[1,1,0] clamp
  v_pk_fma_f32 v[30:31], v[70:71], v[30:31], 0.5 op_sel:[0,0,0] op_sel_hi:[1,1,0] clamp
  v_pk_mul_f32 v[64:65], v[64:65], v[24:25] op_sel:[0,0] op_sel_hi:[1,1]
  v_pk_mul_f32 v[66:67], v[66:67], v[26:27] op_sel:[0,0] op_sel_hi:[1,1]
  v_pk_mul_f32 v[68:69], v[68:69], v[28:29] op_sel:[0,0] op_sel_hi:[1,1]
  v_pk_mul_f32 v[70:71], v[70:71], v[30:31] op_sel:[0,0] op_sel_hi:[1,1]
  v_pk_add_f32 v[196:197], v[196:197], v[64:65] op_sel:[0,0] op_sel_hi:[1,1]
  v_pk_fma_f32 v[204:205], v[64:65], v[64:65], v[204:205] op_sel:[0,0,0] op_sel_hi:[1,1,1]
  v_pk_add_f32 v[198:199], v[198:199], v[66:67] op_sel:[0,0] op_sel_hi:[1,1]
  v_pk_fma_f32 v[206:207], v[66:67], v[66:67], v[206:207] op_sel:[0,0,0] op_sel_hi:[1,1,1]
  v_pk_add_f32 v[200:201], v[200:201], v[68:69] op_sel:[0,0] op_sel_hi:[1,1]
  v_pk_fma_f32 v[208:209], v[68:69], v[68:69], v[208:209] op_sel:[0,0,0] op_sel_hi:[1,1,1]
  v_pk_add_f32 v[202:203], v[202:203], v[70:71] op_sel:[0,0] op_sel_hi:[1,1]
  v_pk_fma_f32 v[210:211], v[70:71], v[70:71], v[210:211] op_sel:[0,0,0] op_sel_hi:[1,1,1]
  v_add_f32_dpp v128, v196, v196 row_ror:8 row_mask:0xf bank_mask:0x3
  v_add_f32_dpp v129, v197, v197 row_ror:8 row_mask:0xf bank_mask:0x3
  v_add_f32_dpp v130, v198, v198 row_ror:8 row_mask:0xf bank_mask:0x3
  v_add_f32_dpp v131, v199, v199 row_ror:8 row_mask:0xf bank_mask:0x3
  v_add_f32_dpp v132, v200, v200 row_ror:8 row_mask:0xf bank_mask:0x3
  v_add_f32_dpp v133, v201, v201 row_ror:8 row_mask:0xf bank_mask:0x3
  v_add_f32_dpp v134, v202, v202 row_ror:8 row_mask:0xf bank_mask:0x3
  v_add_f32_dpp v135, v203, v203 row_ror:8 row_mask:0xf bank_mask:0x3
  v_add_f32_dpp v128, v204, v204 row_ror:8 row_mask:0xf bank_mask:0xc
  v_add_f32_dpp v129, v205, v205 row_ror:8 row_mask:0xf bank_mask:0xc
  v_add_f32_dpp v130, v206, v206 row_ror:8 row_mask:0xf bank_mask:0xc
  v_add_f32_dpp v131, v207, v207 row_ror:8 row_mask:0xf bank_mask:0xc
  v_add_f32_dpp v132, v208, v208 row_ror:8 row_mask:0xf bank_mask:0xc
  v_add_f32_dpp v133, v209, v209 row_ror:8 row_mask:0xf bank_mask:0xc
  v_add_f32_dpp v134, v210, v210 row_ror:8 row_mask:0xf bank_mask:0xc
  v_add_f32_dpp v135, v211, v211 row_ror:8 row_mask:0xf bank_mask:0xc
  v_add_f32_dpp v136, v128, v128 row_shl:4 row_mask:0xf bank_mask:0x5
  v_add_f32_dpp v137, v129, v129 row_shl:4 row_mask:0xf bank_mask:0x5
  v_add_f32_dpp v138, v130, v130 row_shl:4 row_mask:0xf bank_mask:0x5
  v_add_f32_dpp v139, v131, v131 row_shl:4 row_mask:0xf bank_mask:0x5
  v_add_f32_dpp v136, v132, v132 row_shr:4 row_mask:0xf bank_mask:0xa
  v_add_f32_dpp v137, v133, v133 row_shr:4 row_mask:0xf bank_mask:0xa
  v_add_f32_dpp v138, v134, v134 row_shr:4 row_mask:0xf bank_mask:0xa
  v_add_f32_dpp v139, v135, v135 row_shr:4 row_mask:0xf bank_mask:0xa
  v_add_f32_dpp v136, v136, v136 quad_perm:[1,0,3,2] row_mask:0xf bank_mask:0xf
  v_add_f32_dpp v137, v137, v137 quad_perm:[1,0,3,2] row_mask:0xf bank_mask:0xf
  v_add_f32_dpp v138, v138, v138 quad_perm:[1,0,3,2] row_mask:0xf bank_mask:0xf
  v_add_f32_dpp v139, v139, v139 quad_perm:[1,0,3,2] row_mask:0xf bank_mask:0xf
  v_add_f32_dpp v136, v136, v136 quad_perm:[2,3,0,1] row_mask:0xf bank_mask:0xf
  v_add_f32_dpp v137, v137, v137 quad_perm:[2,3,0,1] row_mask:0xf bank_mask:0xf
  v_add_f32_dpp v138, v138, v138 quad_perm:[2,3,0,1] row_mask:0xf bank_mask:0xf
  v_add_f32_dpp v139, v139, v139 quad_perm:[2,3,0,1] row_mask:0xf bank_mask:0xf
  v_and_b32 v5, 3, v0
  v_cmp_eq_u32 s[72:73], 1, v5
  v_cmp_eq_u32 s[74:75], 2, v5
  v_cmp_eq_u32 s[76:77], 3, v5
  v_cndmask_b32 v136, v136, v137, s[72:73]
  v_cndmask_b32 v136, v136, v138, s[74:75]
  v_cndmask_b32 v136, v136, v139, s[76:77]
  v_min_u32 v136, -2, v136
  buffer_store_dword v136, v4, s[68:71], s26 offen offset:0 sc1
  s_setprio 0
  s_lshl_b32 s3, s13, 2
  s_add_u32 s3, s3, s59
  s_lshl_b32 s57, s3, 10
  s_mul_i32 s3, s3, 448
  s_mul_i32 s19, s12, 28
  s_add_u32 s3, s3, s19
  s_lshl_b32 s3, s3, 8
  v_lshlrev_b32 v4, 4, v0
  v_lshrrev_b32 v169, 4, v0
  v_lshlrev_b32 v169, 13, v169
  v_and_b32 v5, 15, v0
  v_lshlrev_b32 v5, 4, v5
  v_add_u32 v169, v169, v5
  s_add_u32 s27, s56, 4096
  s_mul_i32 s19, s59, 7168
  s_add_u32 s19, s19, 135168
  v_add_u32 v168, s19, v4
  v_pk_mul_f32 v[80:81], v[80:81], v[148:149] op_sel:[0,0] op_sel_hi:[1,0]
  v_pk_fma_f32 v[80:81], v[152:153], v[150:151], v[80:81] op_sel:[0,0,0] op_sel_hi:[1,0,1]
  v_pk_mul_f32 v[82:83], v[82:83], v[148:149] op_sel:[0,0] op_sel_hi:[1,0]
  v_pk_fma_f32 v[82:83], v[154:155], v[150:151], v[82:83] op_sel:[0,0,0] op_sel_hi:[1,0,1]
  v_pk_mul_f32 v[84:85], v[84:85], v[148:149] op_sel:[0,1] op_sel_hi:[1,1]
  v_pk_fma_f32 v[84:85], v[152:153], v[150:151], v[84:85] op_sel:[0,1,0] op_sel_hi:[1,1,1]
  v_pk_mul_f32 v[86:87], v[86:87], v[148:149] op_sel:[0,1] op_sel_hi:[1,1]
  v_pk_fma_f32 v[86:87], v[154:155], v[150:151], v[86:87] op_sel:[0,1,0] op_sel_hi:[1,1,1]
  v_pk_fma_f32 v[172:173], v[80:81], s[78:79], 0.5 op_sel:[0,0,0] op_sel_hi:[1,0,0] clamp
  v_pk_fma_f32 v[174:175], v[82:83], s[78:79], 0.5 op_sel:[0,0,0] op_sel_hi:[1,0,0] clamp
  v_pk_fma_f32 v[176:177], v[84:85], s[78:79], 0.5 op_sel:[0,0,0] op_sel_hi:[1,0,0] clamp
  v_pk_fma_f32 v[178:179], v[86:87], s[78:79], 0.5 op_sel:[0,0,0] op_sel_hi:[1,0,0] clamp
  v_pk_fma_f32 v[172:173], v[172:173], v[172:173], v[172:173] neg_lo:[0,0,1] neg_hi:[0,0,1]
  v_pk_fma_f32 v[174:175], v[174:175], v[174:175], v[174:175] neg_lo:[0,0,1] neg_hi:[0,0,1]
  v_pk_fma_f32 v[176:177], v[176:177], v[176:177], v[176:177] neg_lo:[0,0,1] neg_hi:[0,0,1]
  v_pk_fma_f32 v[178:179], v[178:179], v[178:179], v[178:179] neg_lo:[0,0,1] neg_hi:[0,0,1]
  v_pk_fma_f32 v[24:25], v[2:3], v[172:173], s[84:85] op_sel:[0,0,0] op_sel_hi:[1,1,0]
  v_pk_fma_f32 v[26:27], v[2:3], v[174:175], s[84:85] op_sel:[0,0,0] op_sel_hi:[1,1,0]
  v_pk_fma_f32 v[28:29], v[2:3], v[176:177], s[84:85] op_sel:[0,0,0] op_sel_hi:[1,1,0]
  v_pk_fma_f32 v[30:31], v[2:3], v[178:179], s[84:85] op_sel:[0,0,0] op_sel_hi:[1,1,0]
  v_pk_fma_f32 v[24:25], v[24:25], v[172:173], s[82:83] op_sel:[0,0,1] op_sel_hi:[1,1,1]
  v_pk_fma_f32 v[26:27], v[26:27], v[174:175], s[82:83] op_sel:[0,0,1] op_sel_hi:[1,1,1]
  v_pk_fma_f32 v[28:29], v[28:29], v[176:177], s[82:83] op_sel:[0,0,1] op_sel_hi:[1,1,1]
  v_pk_fma_f32 v[30:31], v[30:31], v[178:179], s[82:83] op_sel:[0,0,1] op_sel_hi:[1,1,1]
  v_pk_fma_f32 v[24:25], v[24:25], v[172:173], s[82:83] op_sel:[0,0,0] op_sel_hi:[1,1,0]
  v_pk_fma_f32 v[26:27], v[26:27], v[174:175], s[82:83] op_sel:[0,0,0] op_sel_hi:[1,1,0]
  v_pk_fma_f32 v[28:29], v[28:29], v[176:177], s[82:83] op_sel:[0,0,0] op_sel_hi:[1,1,0]
  v_pk_fma_f32 v[30:31], v[30:31], v[178:179], s[82:83] op_sel:[0,0,0] op_sel_hi:[1,1,0]
  v_pk_fma_f32 v[24:25], v[24:25], v[172:173], s[80:81] op_sel:[0,0,1] op_sel_hi:[1,1,1]
  v_pk_fma_f32 v[26:27], v[26:27], v[174:175], s[80:81] op_sel:[0,0,1] op_sel_hi:[1,1,1]
  v_pk_fma_f32 v[28:29], v[28:29], v[176:177], s[80:81] op_sel:[0,0,1] op_sel_hi:[1,1,1]
  v_pk_fma_f32 v[30:31], v[30:31], v[178:179], s[80:81] op_sel:[0,0,1] op_sel_hi:[1,1,1]
  v_pk_fma_f32 v[24:25], v[24:25], v[172:173], s[80:81] op_sel:[0,0,0] op_sel_hi:[1,1,0]
  v_pk_fma_f32 v[26:27], v[26:27], v[174:175], s[80:81] op_sel:[0,0,0] op_sel_hi:[1,1,0]
  v_pk_fma_f32 v[28:29], v[28:29], v[176:177], s[80:81] op_sel:[0,0,0] op_sel_hi:[1,1,0]
  v_pk_fma_f32 v[30:31], v[30:31], v[178:179], s[80:81] op_sel:[0,0,0] op_sel_hi:[1,1,0]
  v_pk_fma_f32 v[24:25], v[24:25], v[172:173], s[78:79] op_sel:[0,0,1] op_sel_hi:[1,1,1]
  v_pk_fma_f32 v[26:27], v[26:27], v[174:175], s[78:79] op_sel:[0,0,1] op_sel_hi:[1,1,1]
  v_pk_fma_f32 v[28:29], v[28:29], v[176:177], s[78:79] op_sel:[0,0,1] op_sel_hi:[1,1,1]
  v_pk_fma_f32 v[30:31], v[30:31], v[178:179], s[78:79] op_sel:[0,0,1] op_sel_hi:[1,1,1]
  v_pk_fma_f32 v[24:25], v[80:81], v[24:25], 0.5 op_sel:[0,0,0] op_sel_hi:[1,1,0] clamp
  v_pk_fma_f32 v[26:27], v[82:83], v[26:27], 0.5 op_sel:[0,0,0] op_sel_hi:[1,1,0] clamp
  v_pk_fma_f32 v[28:29], v[84:85], v[28:29], 0.5 op_sel:[0,0,0] op_sel_hi:[1,1,0] clamp
  v_pk_fma_f32 v[30:31], v[86:87], v[30:31], 0.5 op_sel:[0,0,0] op_sel_hi:[1,1,0] clamp
  v_pk_mul_f32 v[80:81], v[80:81], v[24:25] op_sel:[0,0] op_sel_hi:[1,1]
  v_pk_mul_f32 v[82:83], v[82:83], v[26:27] op_sel:[0,0] op_sel_hi:[1,1]
  v_pk_mul_f32 v[84:85], v[84:85], v[28:29] op_sel:[0,0] op_sel_hi:[1,1]
  v_pk_mul_f32 v[86:87], v[86:87], v[30:31] op_sel:[0,0] op_sel_hi:[1,1]
  v_cvt_pk_bf16_f32 v180, v80, v81
  v_cvt_pk_bf16_f32 v181, v82, v83
  v_cvt_pk_bf16_f32 v182, v84, v85
  v_cvt_pk_bf16_f32 v183, v86, v87
  ds_write_b128 v168, v[180:183] offset:0
  v_pk_mul_f32 v[96:97], v[96:97], v[148:149] op_sel:[0,0] op_sel_hi:[1,0]
  v_pk_fma_f32 v[96:97], v[156:157], v[150:151], v[96:97] op_sel:[0,0,0] op_sel_hi:[1,0,1]
  v_pk_mul_f32 v[98:99], v[98:99], v[148:149] op_sel:[0,0] op_sel_hi:[1,0]
  v_pk_fma_f32 v[98:99], v[158:159], v[150:151], v[98:99] op_sel:[0,0,0] op_sel_hi:[1,0,1]
  v_pk_mul_f32 v[100:101], v[100:101], v[148:149] op_sel:[0,1] op_sel_hi:[1,1]
  v_pk_fma_f32 v[100:101], v[156:157], v[150:151], v[100:101] op_sel:[0,1,0] op_sel_hi:[1,1,1]
  v_pk_mul_f32 v[102:103], v[102:103], v[148:149] op_sel:[0,1] op_sel_hi:[1,1]
  v_pk_fma_f32 v[102:103], v[158:159], v[150:151], v[102:103] op_sel:[0,1,0] op_sel_hi:[1,1,1]
  v_pk_fma_f32 v[172:173], v[96:97], s[78:79], 0.5 op_sel:[0,0,0] op_sel_hi:[1,0,0] clamp
  v_pk_fma_f32 v[174:175], v[98:99], s[78:79], 0.5 op_sel:[0,0,0] op_sel_hi:[1,0,0] clamp
  v_pk_fma_f32 v[176:177], v[100:101], s[78:79], 0.5 op_sel:[0,0,0] op_sel_hi:[1,0,0] clamp
  v_pk_fma_f32 v[178:179], v[102:103], s[78:79], 0.5 op_sel:[0,0,0] op_sel_hi:[1,0,0] clamp
  v_pk_fma_f32 v[172:173], v[172:173], v[172:173], v[172:173] neg_lo:[0,0,1] neg_hi:[0,0,1]
  v_pk_fma_f32 v[174:175], v[174:175], v[174:175], v[174:175] neg_lo:[0,0,1] neg_hi:[0,0,1]
  v_pk_fma_f32 v[176:177], v[176:177], v[176:177], v[176:177] neg_lo:[0,0,1] neg_hi:[0,0,1]
  v_pk_fma_f32 v[178:179], v[178:179], v[178:179], v[178:179] neg_lo:[0,0,1] neg_hi:[0,0,1]
  v_pk_fma_f32 v[24:25], v[2:3], v[172:173], s[84:85] op_sel:[0,0,0] op_sel_hi:[1,1,0]
  v_pk_fma_f32 v[26:27], v[2:3], v[174:175], s[84:85] op_sel:[0,0,0] op_sel_hi:[1,1,0]
  v_pk_fma_f32 v[28:29], v[2:3], v[176:177], s[84:85] op_sel:[0,0,0] op_sel_hi:[1,1,0]
  v_pk_fma_f32 v[30:31], v[2:3], v[178:179], s[84:85] op_sel:[0,0,0] op_sel_hi:[1,1,0]
  v_pk_fma_f32 v[24:25], v[24:25], v[172:173], s[82:83] op_sel:[0,0,1] op_sel_hi:[1,1,1]
  v_pk_fma_f32 v[26:27], v[26:27], v[174:175], s[82:83] op_sel:[0,0,1] op_sel_hi:[1,1,1]
  v_pk_fma_f32 v[28:29], v[28:29], v[176:177], s[82:83] op_sel:[0,0,1] op_sel_hi:[1,1,1]
  v_pk_fma_f32 v[30:31], v[30:31], v[178:179], s[82:83] op_sel:[0,0,1] op_sel_hi:[1,1,1]
  v_pk_fma_f32 v[24:25], v[24:25], v[172:173], s[82:83] op_sel:[0,0,0] op_sel_hi:[1,1,0]
  v_pk_fma_f32 v[26:27], v[26:27], v[174:175], s[82:83] op_sel:[0,0,0] op_sel_hi:[1,1,0]
  v_pk_fma_f32 v[28:29], v[28:29], v[176:177], s[82:83] op_sel:[0,0,0] op_sel_hi:[1,1,0]
  v_pk_fma_f32 v[30:31], v[30:31], v[178:179], s[82:83] op_sel:[0,0,0] op_sel_hi:[1,1,0]
  v_pk_fma_f32 v[24:25], v[24:25], v[172:173], s[80:81] op_sel:[0,0,1] op_sel_hi:[1,1,1]
  v_pk_fma_f32 v[26:27], v[26:27], v[174:175], s[80:81] op_sel:[0,0,1] op_sel_hi:[1,1,1]
  v_pk_fma_f32 v[28:29], v[28:29], v[176:177], s[80:81] op_sel:[0,0,1] op_sel_hi:[1,1,1]
  v_pk_fma_f32 v[30:31], v[30:31], v[178:179], s[80:81] op_sel:[0,0,1] op_sel_hi:[1,1,1]
  v_pk_fma_f32 v[24:25], v[24:25], v[172:173], s[80:81] op_sel:[0,0,0] op_sel_hi:[1,1,0]
  v_pk_fma_f32 v[26:27], v[26:27], v[174:175], s[80:81] op_sel:[0,0,0] op_sel_hi:[1,1,0]
  v_pk_fma_f32 v[28:29], v[28:29], v[176:177], s[80:81] op_sel:[0,0,0] op_sel_hi:[1,1,0]
  v_pk_fma_f32 v[30:31], v[30:31], v[178:179], s[80:81] op_sel:[0,0,0] op_sel_hi:[1,1,0]
  v_pk_fma_f32 v[24:25], v[24:25], v[172:173], s[78:79] op_sel:[0,0,1] op_sel_hi:[1,1,1]
  v_pk_fma_f32 v[26:27], v[26:27], v[174:175], s[78:79] op_sel:[0,0,1] op_sel_hi:[1,1,1]
  v_pk_fma_f32 v[28:29], v[28:29], v[176:177], s[78:79] op_sel:[0,0,1] op_sel_hi:[1,1,1]
  v_pk_fma_f32 v[30:31], v[30:31], v[178:179], s[78:79] op_sel:[0,0,1] op_sel_hi:[1,1,1]
  v_pk_fma_f32 v[24:25], v[96:97], v[24:25], 0.5 op_sel:[0,0,0] op_sel_hi:[1,1,0] clamp
  v_pk_fma_f32 v[26:27], v[98:99], v[26:27], 0.5 op_sel:[0,0,0] op_sel_hi:[1,1,0] clamp
  v_pk_fma_f32 v[28:29], v[100:101], v[28:29], 0.5 op_sel:[0,0,0] op_sel_hi:[1,1,0] clamp
  v_pk_fma_f32 v[30:31], v[102:103], v[30:31], 0.5 op_sel:[0,0,0] op_sel_hi:[1,1,0] clamp
  v_pk_mul_f32 v[96:97], v[96:97], v[24:25] op_sel:[0,0] op_sel_hi:[1,1]
  v_pk_mul_f32 v[98:99], v[98:99], v[26:27] op_sel:[0,0] op_sel_hi:[1,1]
  v_pk_mul_f32 v[100:101], v[100:101], v[28:29] op_sel:[0,0] op_sel_hi:[1,1]
  v_pk_mul_f32 v[102:103], v[102:103], v[30:31] op_sel:[0,0] op_sel_hi:[1,1]
  v_cvt_pk_bf16_f32 v184, v96, v97
  v_cvt_pk_bf16_f32 v185, v98, v99
  v_cvt_pk_bf16_f32 v186, v100, v101
  v_cvt_pk_bf16_f32 v187, v102, v103
  ds_write_b128 v168, v[184:187] offset:1024
  v_pk_mul_f32 v[112:113], v[112:113], v[148:149] op_sel:[0,0] op_sel_hi:[1,0]
  v_pk_fma_f32 v[112:113], v[160:161], v[150:151], v[112:113] op_sel:[0,0,0] op_sel_hi:[1,0,1]
  v_pk_mul_f32 v[114:115], v[114:115], v[148:149] op_sel:[0,0] op_sel_hi:[1,0]
  v_pk_fma_f32 v[114:115], v[162:163], v[150:151], v[114:115] op_sel:[0,0,0] op_sel_hi:[1,0,1]
  v_pk_mul_f32 v[116:117], v[116:117], v[148:149] op_sel:[0,1] op_sel_hi:[1,1]
  v_pk_fma_f32 v[116:117], v[160:161], v[150:151], v[116:117] op_sel:[0,1,0] op_sel_hi:[1,1,1]
  v_pk_mul_f32 v[118:119], v[118:119], v[148:149] op_sel:[0,1] op_sel_hi:[1,1]
  v_pk_fma_f32 v[118:119], v[162:163], v[150:151], v[118:119] op_sel:[0,1,0] op_sel_hi:[1,1,1]
  buffer_load_dwordx4 v[216:219], v169, s[68:71], s56 offen offset:0 sc1
  buffer_load_dwordx4 v[220:223], v169, s[68:71], s56 offen offset:1024 sc1
  buffer_load_dwordx4 v[224:227], v169, s[68:71], s56 offen offset:2048 sc1
  buffer_load_dwordx4 v[228:231], v169, s[68:71], s56 offen offset:3072 sc1
  buffer_load_dwordx4 v[232:235], v169, s[68:71], s27 offen offset:0 sc1
  buffer_load_dwordx4 v[236:239], v169, s[68:71], s27 offen offset:1024 sc1
  buffer_load_dwordx4 v[240:243], v169, s[68:71], s27 offen offset:2048 sc1
  buffer_load_dwordx4 v[244:247], v169, s[68:71], s27 offen offset:3072 sc1
  v_pk_fma_f32 v[172:173], v[112:113], s[78:79], 0.5 op_sel:[0,0,0] op_sel_hi:[1,0,0] clamp
  v_pk_fma_f32 v[174:175], v[114:115], s[78:79], 0.5 op_sel:[0,0,0] op_sel_hi:[1,0,0] clamp
  v_pk_fma_f32 v[176:177], v[116:117], s[78:79], 0.5 op_sel:[0,0,0] op_sel_hi:[1,0,0] clamp
  v_pk_fma_f32 v[178:179], v[118:119], s[78:79], 0.5 op_sel:[0,0,0] op_sel_hi:[1,0,0] clamp
  v_pk_fma_f32 v[172:173], v[172:173], v[172:173], v[172:173] neg_lo:[0,0,1] neg_hi:[0,0,1]
  v_pk_fma_f32 v[174:175], v[174:175], v[174:175], v[174:175] neg_lo:[0,0,1] neg_hi:[0,0,1]
  v_pk_fma_f32 v[176:177], v[176:177], v[176:177], v[176:177] neg_lo:[0,0,1] neg_hi:[0,0,1]
  v_pk_fma_f32 v[178:179], v[178:179], v[178:179], v[178:179] neg_lo:[0,0,1] neg_hi:[0,0,1]
  v_pk_fma_f32 v[24:25], v[2:3], v[172:173], s[84:85] op_sel:[0,0,0] op_sel_hi:[1,1,0]
  v_pk_fma_f32 v[26:27], v[2:3], v[174:175], s[84:85] op_sel:[0,0,0] op_sel_hi:[1,1,0]
  v_pk_fma_f32 v[28:29], v[2:3], v[176:177], s[84:85] op_sel:[0,0,0] op_sel_hi:[1,1,0]
  v_pk_fma_f32 v[30:31], v[2:3], v[178:179], s[84:85] op_sel:[0,0,0] op_sel_hi:[1,1,0]
  v_pk_fma_f32 v[24:25], v[24:25], v[172:173], s[82:83] op_sel:[0,0,1] op_sel_hi:[1,1,1]
  v_pk_fma_f32 v[26:27], v[26:27], v[174:175], s[82:83] op_sel:[0,0,1] op_sel_hi:[1,1,1]
  v_pk_fma_f32 v[28:29], v[28:29], v[176:177], s[82:83] op_sel:[0,0,1] op_sel_hi:[1,1,1]
  v_pk_fma_f32 v[30:31], v[30:31], v[178:179], s[82:83] op_sel:[0,0,1] op_sel_hi:[1,1,1]
  v_pk_fma_f32 v[24:25], v[24:25], v[172:173], s[82:83] op_sel:[0,0,0] op_sel_hi:[1,1,0]
  v_pk_fma_f32 v[26:27], v[26:27], v[174:175], s[82:83] op_sel:[0,0,0] op_sel_hi:[1,1,0]
  v_pk_fma_f32 v[28:29], v[28:29], v[176:177], s[82:83] op_sel:[0,0,0] op_sel_hi:[1,1,0]
  v_pk_fma_f32 v[30:31], v[30:31], v[178:179], s[82:83] op_sel:[0,0,0] op_sel_hi:[1,1,0]
  v_pk_fma_f32 v[24:25], v[24:25], v[172:173], s[80:81] op_sel:[0,0,1] op_sel_hi:[1,1,1]
  v_pk_fma_f32 v[26:27], v[26:27], v[174:175], s[80:81] op_sel:[0,0,1] op_sel_hi:[1,1,1]
  v_pk_fma_f32 v[28:29], v[28:29], v[176:177], s[80:81] op_sel:[0,0,1] op_sel_hi:[1,1,1]
  v_pk_fma_f32 v[30:31], v[30:31], v[178:179], s[80:81] op_sel:[0,0,1] op_sel_hi:[1,1,1]
  v_pk_fma_f32 v[24:25], v[24:25], v[172:173], s[80:81] op_sel:[0,0,0] op_sel_hi:[1,1,0]
  v_pk_fma_f32 v[26:27], v[26:27], v[174:175], s[80:81] op_sel:[0,0,0] op_sel_hi:[1,1,0]
  v_pk_fma_f32 v[28:29], v[28:29], v[176:177], s[80:81] op_sel:[0,0,0] op_sel_hi:[1,1,0]
  v_pk_fma_f32 v[30:31], v[30:31], v[178:179], s[80:81] op_sel:[0,0,0] op_sel_hi:[1,1,0]
  v_pk_fma_f32 v[24:25], v[24:25], v[172:173], s[78:79] op_sel:[0,0,1] op_sel_hi:[1,1,1]
  v_pk_fma_f32 v[26:27], v[26:27], v[174:175], s[78:79] op_sel:[0,0,1] op_sel_hi:[1,1,1]
  v_pk_fma_f32 v[28:29], v[28:29], v[176:177], s[78:79] op_sel:[0,0,1] op_sel_hi:[1,1,1]
  v_pk_fma_f32 v[30:31], v[30:31], v[178:179], s[78:79] op_sel:[0,0,1] op_sel_hi:[1,1,1]
  v_pk_fma_f32 v[24:25], v[112:113], v[24:25], 0.5 op_sel:[0,0,0] op_sel_hi:[1,1,0] clamp
  v_pk_fma_f32 v[26:27], v[114:115], v[26:27], 0.5 op_sel:[0,0,0] op_sel_hi:[1,1,0] clamp
  v_pk_fma_f32 v[28:29], v[116:117], v[28:29], 0.5 op_sel:[0,0,0] op_sel_hi:[1,1,0] clamp
  v_pk_fma_f32 v[30:31], v[118:119], v[30:31], 0.5 op_sel:[0,0,0] op_sel_hi:[1,1,0] clamp
  v_pk_mul_f32 v[112:113], v[112:113], v[24:25] op_sel:[0,0] op_sel_hi:[1,1]
  v_pk_mul_f32 v[114:115], v[114:115], v[26:27] op_sel:[0,0] op_sel_hi:[1,1]
  v_pk_mul_f32 v[116:117], v[116:117], v[28:29] op_sel:[0,0] op_sel_hi:[1,1]
  v_pk_mul_f32 v[118:119], v[118:119], v[30:31] op_sel:[0,0] op_sel_hi:[1,1]
  v_cvt_pk_bf16_f32 v188, v112, v113
  v_cvt_pk_bf16_f32 v189, v114, v115
  v_cvt_pk_bf16_f32 v190, v116, v117
  v_cvt_pk_bf16_f32 v191, v118, v119
  ds_write_b128 v168, v[188:191] offset:2048
  s_setprio 3
  s_mov_b32 s58, 0
  s_waitcnt vmcnt(0)
  v_max_u32 v5, v216, v217
  v_max3_u32 v5, v5, v218, v219
  v_max3_u32 v5, v5, v220, v221
  v_max3_u32 v5, v5, v222, v223
  v_max3_u32 v5, v5, v224, v225
  v_max3_u32 v5, v5, v226, v227
  v_max3_u32 v5, v5, v228, v229
  v_max3_u32 v5, v5, v230, v231
  v_max3_u32 v5, v5, v232, v233
  v_max3_u32 v5, v5, v234, v235
  v_max3_u32 v5, v5, v236, v237
  v_max3_u32 v5, v5, v238, v239
  v_max3_u32 v5, v5, v240, v241
  v_max3_u32 v5, v5, v242, v243
  v_max3_u32 v5, v5, v244, v245
  v_max3_u32 v5, v5, v246, v247
  v_cmp_eq_u32 vcc, -1, v5
  s_cbranch_vccz g3_kernel_polld13
g3_kernel_poll11:
  s_mov_b32 s19, 0
  v_max3_u32 v5, v216, v217, v218
  v_max_u32 v5, v5, v219
  v_cmp_eq_u32 vcc, -1, v5
  s_cbranch_vccz g3_kernel_ps14
  buffer_load_dwordx4 v[216:219], v169, s[68:71], s56 offen offset:0 sc1
  s_mov_b32 s19, 1
g3_kernel_ps14:
  v_max3_u32 v5, v220, v221, v222
  v_max_u32 v5, v5, v223
  v_cmp_eq_u32 vcc, -1, v5
  s_cbranch_vccz g3_kernel_ps15
  buffer_load_dwordx4 v[220:223], v169, s[68:71], s56 offen offset:1024 sc1
  s_mov_b32 s19, 1
g3_kernel_ps15:
  v_max3_u32 v5, v224, v225, v226
  v_max_u32 v5, v5, v227
  v_cmp_eq_u32 vcc, -1, v5
  s_cbranch_vccz g3_kernel_ps16
  buffer_load_dwordx4 v[224:227], v169, s[68:71], s56 offen offset:2048 sc1
  s_mov_b32 s19, 1
g3_kernel_ps16:
  v_max3_u32 v5, v228, v229, v230
  v_max_u32 v5, v5, v231
  v_cmp_eq_u32 vcc, -1, v5
  s_cbranch_vccz g3_kernel_ps17
  buffer_load_dwordx4 v[228:231], v169, s[68:71], s56 offen offset:3072 sc1
  s_mov_b32 s19, 1
g3_kernel_ps17:
  v_max3_u32 v5, v232, v233, v234
  v_max_u32 v5, v5, v235
  v_cmp_eq_u32 vcc, -1, v5
  s_cbranch_vccz g3_kernel_ps18
  buffer_load_dwordx4 v[232:235], v169, s[68:71], s27 offen offset:0 sc1
  s_mov_b32 s19, 1
g3_kernel_ps18:
  v_max3_u32 v5, v236, v237, v238
  v_max_u32 v5, v5, v239
  v_cmp_eq_u32 vcc, -1, v5
  s_cbranch_vccz g3_kernel_ps19
  buffer_load_dwordx4 v[236:239], v169, s[68:71], s27 offen offset:1024 sc1
  s_mov_b32 s19, 1
g3_kernel_ps19:
  v_max3_u32 v5, v240, v241, v242
  v_max_u32 v5, v5, v243
  v_cmp_eq_u32 vcc, -1, v5
  s_cbranch_vccz g3_kernel_ps20
  buffer_load_dwordx4 v[240:243], v169, s[68:71], s27 offen offset:2048 sc1
  s_mov_b32 s19, 1
g3_kernel_ps20:
  v_max3_u32 v5, v244, v245, v246
  v_max_u32 v5, v5, v247
  v_cmp_eq_u32 vcc, -1, v5
  s_cbranch_vccz g3_kernel_ps21
  buffer_load_dwordx4 v[244:247], v169, s[68:71], s27 offen offset:3072 sc1
  s_mov_b32 s19, 1
g3_kernel_ps21:
  s_add_u32 s58, s58, 1
  s_cmp_eq_u32 s19, 0
  s_cbranch_scc1 g3_kernel_polld13
  s_waitcnt vmcnt(0)
  s_cmp_lt_u32 s58, 0x10000
  s_cbranch_scc1 g3_kernel_poll11
g3_kernel_polld13:
  v_pk_add_f32 v[216:217], v[216:217], v[232:233] op_sel:[0,0] op_sel_hi:[1,1]
  v_pk_add_f32 v[218:219], v[218:219], v[234:235] op_sel:[0,0] op_sel_hi:[1,1]
  v_pk_add_f32 v[220:221], v[220:221], v[236:237] op_sel:[0,0] op_sel_hi:[1,1]
  v_pk_add_f32 v[222:223], v[222:223], v[238:239] op_sel:[0,0] op_sel_hi:[1,1]
  v_pk_add_f32 v[224:225], v[224:225], v[240:241] op_sel:[0,0] op_sel_hi:[1,1]
  v_pk_add_f32 v[226:227], v[226:227], v[242:243] op_sel:[0,0] op_sel_hi:[1,1]
  v_pk_add_f32 v[228:229], v[228:229], v[244:245] op_sel:[0,0] op_sel_hi:[1,1]
  v_pk_add_f32 v[230:231], v[230:231], v[246:247] op_sel:[0,0] op_sel_hi:[1,1]
  v_pk_add_f32 v[216:217], v[216:217], v[224:225] op_sel:[0,0] op_sel_hi:[1,1]
  v_pk_add_f32 v[218:219], v[218:219], v[226:227] op_sel:[0,0] op_sel_hi:[1,1]
  v_pk_add_f32 v[220:221], v[220:221], v[228:229] op_sel:[0,0] op_sel_hi:[1,1]
  v_pk_add_f32 v[222:223], v[222:223], v[230:231] op_sel:[0,0] op_sel_hi:[1,1]
  v_pk_add_f32 v[216:217], v[216:217], v[220:221] op_sel:[0,0] op_sel_hi:[1,1]
  v_pk_add_f32 v[218:219], v[218:219], v[222:223] op_sel:[0,0] op_sel_hi:[1,1]
  s_nop 1
  v_permlane32_swap_b32 v216, v218
  v_permlane32_swap_b32 v217, v219
  v_pk_add_f32 v[216:217], v[216:217], v[218:219] op_sel:[0,0] op_sel_hi:[1,1]
  v_mov_b32 v218, v216
  v_mov_b32 v219, v217
  s_nop 0
  v_permlane16_swap_b32 v216, v218
  v_permlane16_swap_b32 v217, v219
  v_pk_add_f32 v[216:217], v[216:217], v[218:219] op_sel:[0,0] op_sel_hi:[1,1]
  v_mul_f32 v216, 974276901, v216
  v_mul_f32 v217, 974276901, v217
  v_fma_f32 v217, -v216, v216, v217
  v_max_f32 v217, 0, v217
  v_add_f32 v217, 925353388, v217
  v_rsq_f32 v217, v217
  s_nop 0
  v_mul_f32 v216, v216, v217
  v_sub_f32 v216, 0, v216
  v_and_b32 v5, 15, v0
  v_lshlrev_b32 v5, 3, v5
  v_lshrrev_b32 v2, 5, v0
  v_lshlrev_b32 v2, 2, v2
  v_add_u32 v5, v5, v2
  s_lshl_b32 s3, s14, 8
  s_add_u32 s3, s3, 133120
  v_add_u32 v5, s3, v5
  ds_write_b32 v5, v217
  ds_write_b32 v5, v216 offset:128
  v_lshrrev_b32 v168, 4, v0
  v_lshlrev_b32 v168, 5, v168
  v_add_u32 v168, s3, v168
  s_mul_i32 s56, s12, 7
  s_waitcnt lgkmcnt(0)
  ds_read_b128 v[128:131], v168 offset:0
  ds_read_b128 v[136:139], v168 offset:128
  ds_read_b128 v[132:135], v168 offset:16
  ds_read_b128 v[140:143], v168 offset:144
  s_waitcnt lgkmcnt(0)
  s_add_u32 s3, s56, 0
  s_lshl_b32 s3, s3, 16
  s_add_u32 s26, s3, s57
  v_pk_fma_f32 v[16:17], v[16:17], v[128:129], v[136:137] op_sel:[0,0,0] op_sel_hi:[1,1,1]
  v_cvt_pk_bf16_f32 v192, v16, v17
  v_pk_fma_f32 v[18:19], v[18:19], v[130:131], v[138:139] op_sel:[0,0,0] op_sel_hi:[1,1,1]
  v_cvt_pk_bf16_f32 v193, v18, v19
  v_pk_fma_f32 v[20:21], v[20:21], v[132:133], v[140:141] op_sel:[0,0,0] op_sel_hi:[1,1,1]
  v_cvt_pk_bf16_f32 v194, v20, v21
  v_pk_fma_f32 v[22:23], v[22:23], v[134:135], v[142:143] op_sel:[0,0,0] op_sel_hi:[1,1,1]
  v_cvt_pk_bf16_f32 v195, v22, v23
  buffer_store_dwordx4 v[192:195], v4, s[64:67], s26 offen sc0 sc1
  s_add_u32 s3, s56, 1
  s_lshl_b32 s3, s3, 16
  s_add_u32 s26, s3, s57
  v_pk_fma_f32 v[32:33], v[32:33], v[128:129], v[136:137] op_sel:[0,0,0] op_sel_hi:[1,1,1]
  v_cvt_pk_bf16_f32 v180, v32, v33
  v_pk_fma_f32 v[34:35], v[34:35], v[130:131], v[138:139] op_sel:[0,0,0] op_sel_hi:[1,1,1]
  v_cvt_pk_bf16_f32 v181, v34, v35
  v_pk_fma_f32 v[36:37], v[36:37], v[132:133], v[140:141] op_sel:[0,0,0] op_sel_hi:[1,1,1]
  v_cvt_pk_bf16_f32 v182, v36, v37
  v_pk_fma_f32 v[38:39], v[38:39], v[134:135], v[142:143] op_sel:[0,0,0] op_sel_hi:[1,1,1]
  v_cvt_pk_bf16_f32 v183, v38, v39
  buffer_store_dwordx4 v[180:183], v4, s[64:67], s26 offen sc0 sc1
  s_add_u32 s3, s56, 2
  s_lshl_b32 s3, s3, 16
  s_add_u32 s26, s3, s57
  v_pk_fma_f32 v[48:49], v[48:49], v[128:129], v[136:137] op_sel:[0,0,0] op_sel_hi:[1,1,1]
  v_cvt_pk_bf16_f32 v184, v48, v49
  v_pk_fma_f32 v[50:51], v[50:51], v[130:131], v[138:139] op_sel:[0,0,0] op_sel_hi:[1,1,1]
  v_cvt_pk_bf16_f32 v185, v50, v51
  v_pk_fma_f32 v[52:53], v[52:53], v[132:133], v[140:141] op_sel:[0,0,0] op_sel_hi:[1,1,1]
  v_cvt_pk_bf16_f32 v186, v52, v53
  v_pk_fma_f32 v[54:55], v[54:55], v[134:135], v[142:143] op_sel:[0,0,0] op_sel_hi:[1,1,1]
  v_cvt_pk_bf16_f32 v187, v54, v55
  buffer_store_dwordx4 v[184:187], v4, s[64:67], s26 offen sc0 sc1
  s_add_u32 s3, s56, 3
  s_lshl_b32 s3, s3, 16
  s_add_u32 s26, s3, s57
  v_pk_fma_f32 v[64:65], v[64:65], v[128:129], v[136:137] op_sel:[0,0,0] op_sel_hi:[1,1,1]
  v_cvt_pk_bf16_f32 v188, v64, v65
  v_pk_fma_f32 v[66:67], v[66:67], v[130:131], v[138:139] op_sel:[0,0,0] op_sel_hi:[1,1,1]
  v_cvt_pk_bf16_f32 v189, v66, v67
  v_pk_fma_f32 v[68:69], v[68:69], v[132:133], v[140:141] op_sel:[0,0,0] op_sel_hi:[1,1,1]
  v_cvt_pk_bf16_f32 v190, v68, v69
  v_pk_fma_f32 v[70:71], v[70:71], v[134:135], v[142:143] op_sel:[0,0,0] op_sel_hi:[1,1,1]
  v_cvt_pk_bf16_f32 v191, v70, v71
  buffer_store_dwordx4 v[188:191], v4, s[64:67], s26 offen sc0 sc1
  s_setprio 0
  s_branch g3_kernel_fin
g3_kernel_path1:
  s_waitcnt lgkmcnt(0)
  s_barrier
  s_barrier
  ds_read_b64_tr_b16 v[128:129], v7 offset:128
  ds_read_b64_tr_b16 v[130:131], v7 offset:1920
  ds_read_b128 v[156:159], v13 offset:0
  ds_read_b64_tr_b16 v[132:133], v10 offset:128
  ds_read_b64_tr_b16 v[134:135], v10 offset:1920
  ds_read_b128 v[160:163], v13 offset:2048
  ds_read_b64_tr_b16 v[136:137], v7 offset:192
  ds_read_b64_tr_b16 v[138:139], v7 offset:1984
  ds_read_b128 v[164:167], v13 offset:4096
  ds_read_b64_tr_b16 v[140:141], v7 offset:320
  ds_read_b64_tr_b16 v[142:143], v7 offset:2112
  ds_read_b128 v[168:171], v13 offset:6144
  ds_read_b64_tr_b16 v[144:145], v10 offset:320
  ds_read_b64_tr_b16 v[146:147], v10 offset:2112
  ds_read_b64_tr_b16 v[148:149], v7 offset:384
  ds_read_b64_tr_b16 v[150:151], v7 offset:2176
  ds_read_b64_tr_b16 v[152:153], v10 offset:384
  ds_read_b64_tr_b16 v[154:155], v10 offset:2176
  s_waitcnt lgkmcnt(15)
  v_mfma_f32_16x16x32_bf16 v[16:19], v[156:159], v[128:131], 0
  ds_read_b64_tr_b16 v[172:173], v8 offset:14464
  s_waitcnt lgkmcnt(13)
  v_mfma_f32_16x16x32_bf16 v[20:23], v[160:163], v[128:131], 0
  ds_read_b64_tr_b16 v[174:175], v8 offset:16256
  v_mfma_f32_16x16x32_bf16 v[32:35], v[156:159], v[132:135], 0
  ds_read_b128 v[200:203], v14 offset:1024
  v_mfma_f32_16x16x32_bf16 v[36:39], v[160:163], v[132:135], 0
  ds_read_b64_tr_b16 v[176:177], v11 offset:14464
  s_waitcnt lgkmcnt(13)
  v_mfma_f32_16x16x32_bf16 v[24:27], v[164:167], v[128:131], 0
  ds_read_b64_tr_b16 v[178:179], v11 offset:16256
  v_mfma_f32_16x16x32_bf16 v[40:43], v[164:167], v[132:135], 0
  ds_read_b128 v[204:207], v14 offset:3072
  v_mfma_f32_16x16x32_bf16 v[48:51], v[156:159], v[136:139], 0
  ds_read_b64_tr_b16 v[180:181], v8 offset:14528
  v_mfma_f32_16x16x32_bf16 v[52:55], v[160:163], v[136:139], 0
  ds_read_b64_tr_b16 v[182:183], v8 offset:16320
  v_mfma_f32_16x16x32_bf16 v[56:59], v[164:167], v[136:139], 0
  ds_read_b128 v[208:211], v14 offset:5120
  s_waitcnt lgkmcnt(15)
  v_mfma_f32_16x16x32_bf16 v[28:31], v[168:171], v[128:131], 0
  ds_read_b64_tr_b16 v[184:185], v8 offset:14656
  v_mfma_f32_16x16x32_bf16 v[44:47], v[168:171], v[132:135], 0
  ds_read_b64_tr_b16 v[186:187], v8 offset:16448
  v_mfma_f32_16x16x32_bf16 v[60:63], v[168:171], v[136:139], 0
  ds_read_b128 v[212:215], v14 offset:7168
  v_mfma_f32_16x16x32_bf16 v[64:67], v[140:143], v[156:159], 0
  ds_read_b64_tr_b16 v[188:189], v11 offset:14656
  v_mfma_f32_16x16x32_bf16 v[68:71], v[140:143], v[160:163], 0
  ds_read_b64_tr_b16 v[190:191], v11 offset:16448
  v_mfma_f32_16x16x32_bf16 v[72:75], v[140:143], v[164:167], 0
  ds_read_b64_tr_b16 v[192:193], v8 offset:14720
  v_mfma_f32_16x16x32_bf16 v[76:79], v[140:143], v[168:171], 0
  ds_read_b64_tr_b16 v[194:195], v8 offset:16512
  s_waitcnt lgkmcnt(15)
  v_mfma_f32_16x16x32_bf16 v[80:83], v[144:147], v[156:159], 0
  ds_read_b64_tr_b16 v[196:197], v11 offset:14720
  v_mfma_f32_16x16x32_bf16 v[84:87], v[144:147], v[160:163], 0
  ds_read_b64_tr_b16 v[198:199], v11 offset:16512
  v_mfma_f32_16x16x32_bf16 v[88:91], v[144:147], v[164:167], 0
  s_add_u32 s15, s15, 45056
  s_cmp_ge_u32 s15, 135168
  s_cselect_b32 s3, 135168, 0
  s_sub_u32 s15, s15, s3
  v_mfma_f32_16x16x32_bf16 v[92:95], v[144:147], v[168:171], 0
  v_add_u32 v7, s15, v6
  s_waitcnt lgkmcnt(15)
  v_mfma_f32_16x16x32_bf16 v[96:99], v[148:151], v[156:159], 0
  v_add_u32 v10, s15, v9
  v_mfma_f32_16x16x32_bf16 v[100:103], v[148:151], v[160:163], 0
  v_add_u32 v13, s15, v12
  v_mfma_f32_16x16x32_bf16 v[104:107], v[148:151], v[164:167], 0
  v_mfma_f32_16x16x32_bf16 v[108:111], v[148:151], v[168:171], 0
  s_waitcnt lgkmcnt(15)
  v_mfma_f32_16x16x32_bf16 v[112:115], v[152:155], v[156:159], 0
  v_mfma_f32_16x16x32_bf16 v[116:119], v[152:155], v[160:163], 0
  v_mfma_f32_16x16x32_bf16 v[120:123], v[152:155], v[164:167], 0
  v_mfma_f32_16x16x32_bf16 v[124:127], v[152:155], v[168:171], 0
  s_waitcnt lgkmcnt(15)
  v_mfma_f32_16x16x32_bf16 v[16:19], v[200:203], v[172:175], v[16:19]
  v_add_u32 v8, s15, v6
  s_waitcnt lgkmcnt(12)
  v_mfma_f32_16x16x32_bf16 v[20:23], v[204:207], v[172:175], v[20:23]
  v_add_u32 v11, s15, v9
  s_waitcnt lgkmcnt(0)
  s_barrier
  v_mfma_f32_16x16x32_bf16 v[32:35], v[200:203], v[176:179], v[32:35]
  ds_read_b64_tr_b16 v[128:129], v7 offset:128
  v_mfma_f32_16x16x32_bf16 v[36:39], v[204:207], v[176:179], v[36:39]
  ds_read_b64_tr_b16 v[130:131], v7 offset:1920
  v_mfma_f32_16x16x32_bf16 v[24:27], v[208:211], v[172:175], v[24:27]
  ds_read_b128 v[156:159], v13 offset:0
  v_mfma_f32_16x16x32_bf16 v[40:43], v[208:211], v[176:179], v[40:43]
  ds_read_b64_tr_b16 v[132:133], v10 offset:128
  v_mfma_f32_16x16x32_bf16 v[48:51], v[200:203], v[180:183], v[48:51]
  ds_read_b64_tr_b16 v[134:135], v10 offset:1920
  v_mfma_f32_16x16x32_bf16 v[52:55], v[204:207], v[180:183], v[52:55]
  ds_read_b128 v[160:163], v13 offset:2048
  v_mfma_f32_16x16x32_bf16 v[56:59], v[208:211], v[180:183], v[56:59]
  ds_read_b64_tr_b16 v[136:137], v7 offset:192
  v_mfma_f32_16x16x32_bf16 v[28:31], v[212:215], v[172:175], v[28:31]
  ds_read_b64_tr_b16 v[138:139], v7 offset:1984
  v_mfma_f32_16x16x32_bf16 v[44:47], v[212:215], v[176:179], v[44:47]
  ds_read_b128 v[164:167], v13 offset:4096
  v_mfma_f32_16x16x32_bf16 v[60:63], v[212:215], v[180:183], v[60:63]
  ds_read_b64_tr_b16 v[140:141], v7 offset:320
  v_mfma_f32_16x16x32_bf16 v[64:67], v[184:187], v[200:203], v[64:67]
  ds_read_b64_tr_b16 v[142:143], v7 offset:2112
  v_mfma_f32_16x16x32_bf16 v[68:71], v[184:187], v[204:207], v[68:71]
  ds_read_b128 v[168:171], v13 offset:6144
  v_mfma_f32_16x16x32_bf16 v[72:75], v[184:187], v[208:211], v[72:75]
  ds_read_b64_tr_b16 v[144:145], v10 offset:320
  v_mfma_f32_16x16x32_bf16 v[76:79], v[184:187], v[212:215], v[76:79]
  ds_read_b64_tr_b16 v[146:147], v10 offset:2112
  v_mfma_f32_16x16x32_bf16 v[80:83], v[188:191], v[200:203], v[80:83]
  ds_read_b64_tr_b16 v[148:149], v7 offset:384
  v_mfma_f32_16x16x32_bf16 v[84:87], v[188:191], v[204:207], v[84:87]
  ds_read_b64_tr_b16 v[150:151], v7 offset:2176
  v_mfma_f32_16x16x32_bf16 v[88:91], v[188:191], v[208:211], v[88:91]
  ds_read_b64_tr_b16 v[152:153], v10 offset:384
  v_mfma_f32_16x16x32_bf16 v[92:95], v[188:191], v[212:215], v[92:95]
  ds_read_b64_tr_b16 v[154:155], v10 offset:2176
  v_mfma_f32_16x16x32_bf16 v[96:99], v[192:195], v[200:203], v[96:99]
  v_add_u32 v14, s15, v12
  v_mfma_f32_16x16x32_bf16 v[100:103], v[192:195], v[204:207], v[100:103]
  v_mfma_f32_16x16x32_bf16 v[104:107], v[192:195], v[208:211], v[104:107]
  v_mfma_f32_16x16x32_bf16 v[108:111], v[192:195], v[212:215], v[108:111]
  v_mfma_f32_16x16x32_bf16 v[112:115], v[196:199], v[200:203], v[112:115]
  v_mfma_f32_16x16x32_bf16 v[116:119], v[196:199], v[204:207], v[116:119]
  v_mfma_f32_16x16x32_bf16 v[120:123], v[196:199], v[208:211], v[120:123]
  v_mfma_f32_16x16x32_bf16 v[124:127], v[196:199], v[212:215], v[124:127]
  s_mov_b32 s16, 14
  .p2align 3
g3_kernel_cloop22:
  s_waitcnt lgkmcnt(15)
  v_mfma_f32_16x16x32_bf16 v[16:19], v[156:159], v[128:131], v[16:19]
  ds_read_b64_tr_b16 v[172:173], v8 offset:14464
  s_waitcnt lgkmcnt(13)
  v_mfma_f32_16x16x32_bf16 v[20:23], v[160:163], v[128:131], v[20:23]
  ds_read_b64_tr_b16 v[174:175], v8 offset:16256
  v_mfma_f32_16x16x32_bf16 v[32:35], v[156:159], v[132:135], v[32:35]
  ds_read_b128 v[200:203], v14 offset:1024
  v_mfma_f32_16x16x32_bf16 v[36:39], v[160:163], v[132:135], v[36:39]
  ds_read_b64_tr_b16 v[176:177], v11 offset:14464
  s_waitcnt lgkmcnt(13)
  v_mfma_f32_16x16x32_bf16 v[24:27], v[164:167], v[128:131], v[24:27]
  ds_read_b64_tr_b16 v[178:179], v11 offset:16256
  v_mfma_f32_16x16x32_bf16 v[40:43], v[164:167], v[132:135], v[40:43]
  ds_read_b128 v[204:207], v14 offset:3072
  v_mfma_f32_16x16x32_bf16 v[48:51], v[156:159], v[136:139], v[48:51]
  ds_read_b64_tr_b16 v[180:181], v8 offset:14528
  v_mfma_f32_16x16x32_bf16 v[52:55], v[160:163], v[136:139], v[52:55]
  ds_read_b64_tr_b16 v[182:183], v8 offset:16320
  v_mfma_f32_16x16x32_bf16 v[56:59], v[164:167], v[136:139], v[56:59]
  ds_read_b128 v[208:211], v14 offset:5120
  s_waitcnt lgkmcnt(15)
  v_mfma_f32_16x16x32_bf16 v[28:31], v[168:171], v[128:131], v[28:31]
  ds_read_b64_tr_b16 v[184:185], v8 offset:14656
  v_mfma_f32_16x16x32_bf16 v[44:47], v[168:171], v[132:135], v[44:47]
  ds_read_b64_tr_b16 v[186:187], v8 offset:16448
  v_mfma_f32_16x16x32_bf16 v[60:63], v[168:171], v[136:139], v[60:63]
  ds_read_b128 v[212:215], v14 offset:7168
  v_mfma_f32_16x16x32_bf16 v[64:67], v[140:143], v[156:159], v[64:67]
  ds_read_b64_tr_b16 v[188:189], v11 offset:14656
  v_mfma_f32_16x16x32_bf16 v[68:71], v[140:143], v[160:163], v[68:71]
  ds_read_b64_tr_b16 v[190:191], v11 offset:16448
  v_mfma_f32_16x16x32_bf16 v[72:75], v[140:143], v[164:167], v[72:75]
  ds_read_b64_tr_b16 v[192:193], v8 offset:14720
  v_mfma_f32_16x16x32_bf16 v[76:79], v[140:143], v[168:171], v[76:79]
  ds_read_b64_tr_b16 v[194:195], v8 offset:16512
  s_waitcnt lgkmcnt(15)
  v_mfma_f32_16x16x32_bf16 v[80:83], v[144:147], v[156:159], v[80:83]
  ds_read_b64_tr_b16 v[196:197], v11 offset:14720
  v_mfma_f32_16x16x32_bf16 v[84:87], v[144:147], v[160:163], v[84:87]
  ds_read_b64_tr_b16 v[198:199], v11 offset:16512
  v_mfma_f32_16x16x32_bf16 v[88:91], v[144:147], v[164:167], v[88:91]
  s_add_u32 s15, s15, 45056
  s_cmp_ge_u32 s15, 135168
  s_cselect_b32 s3, 135168, 0
  s_sub_u32 s15, s15, s3
  v_mfma_f32_16x16x32_bf16 v[92:95], v[144:147], v[168:171], v[92:95]
  v_add_u32 v7, s15, v6
  s_waitcnt lgkmcnt(15)
  v_mfma_f32_16x16x32_bf16 v[96:99], v[148:151], v[156:159], v[96:99]
  v_add_u32 v10, s15, v9
  v_mfma_f32_16x16x32_bf16 v[100:103], v[148:151], v[160:163], v[100:103]
  v_add_u32 v13, s15, v12
  v_mfma_f32_16x16x32_bf16 v[104:107], v[148:151], v[164:167], v[104:107]
  v_mfma_f32_16x16x32_bf16 v[108:111], v[148:151], v[168:171], v[108:111]
  s_waitcnt lgkmcnt(15)
  v_mfma_f32_16x16x32_bf16 v[112:115], v[152:155], v[156:159], v[112:115]
  v_mfma_f32_16x16x32_bf16 v[116:119], v[152:155], v[160:163], v[116:119]
  v_mfma_f32_16x16x32_bf16 v[120:123], v[152:155], v[164:167], v[120:123]
  v_mfma_f32_16x16x32_bf16 v[124:127], v[152:155], v[168:171], v[124:127]
  s_waitcnt lgkmcnt(15)
  v_mfma_f32_16x16x32_bf16 v[16:19], v[200:203], v[172:175], v[16:19]
  v_add_u32 v8, s15, v6
  s_waitcnt lgkmcnt(12)
  v_mfma_f32_16x16x32_bf16 v[20:23], v[204:207], v[172:175], v[20:23]
  v_add_u32 v11, s15, v9
  s_waitcnt lgkmcnt(0)
  s_barrier
  v_mfma_f32_16x16x32_bf16 v[32:35], v[200:203], v[176:179], v[32:35]
  ds_read_b64_tr_b16 v[128:129], v7 offset:128
  v_mfma_f32_16x16x32_bf16 v[36:39], v[204:207], v[176:179], v[36:39]
  ds_read_b64_tr_b16 v[130:131], v7 offset:1920
  v_mfma_f32_16x16x32_bf16 v[24:27], v[208:211], v[172:175], v[24:27]
  ds_read_b128 v[156:159], v13 offset:0
  v_mfma_f32_16x16x32_bf16 v[40:43], v[208:211], v[176:179], v[40:43]
  ds_read_b64_tr_b16 v[132:133], v10 offset:128
  v_mfma_f32_16x16x32_bf16 v[48:51], v[200:203], v[180:183], v[48:51]
  ds_read_b64_tr_b16 v[134:135], v10 offset:1920
  v_mfma_f32_16x16x32_bf16 v[52:55], v[204:207], v[180:183], v[52:55]
  ds_read_b128 v[160:163], v13 offset:2048
  v_mfma_f32_16x16x32_bf16 v[56:59], v[208:211], v[180:183], v[56:59]
  ds_read_b64_tr_b16 v[136:137], v7 offset:192
  v_mfma_f32_16x16x32_bf16 v[28:31], v[212:215], v[172:175], v[28:31]
  ds_read_b64_tr_b16 v[138:139], v7 offset:1984
  v_mfma_f32_16x16x32_bf16 v[44:47], v[212:215], v[176:179], v[44:47]
  ds_read_b128 v[164:167], v13 offset:4096
  v_mfma_f32_16x16x32_bf16 v[60:63], v[212:215], v[180:183], v[60:63]
  ds_read_b64_tr_b16 v[140:141], v7 offset:320
  v_mfma_f32_16x16x32_bf16 v[64:67], v[184:187], v[200:203], v[64:67]
  ds_read_b64_tr_b16 v[142:143], v7 offset:2112
  v_mfma_f32_16x16x32_bf16 v[68:71], v[184:187], v[204:207], v[68:71]
  ds_read_b128 v[168:171], v13 offset:6144
  v_mfma_f32_16x16x32_bf16 v[72:75], v[184:187], v[208:211], v[72:75]
  ds_read_b64_tr_b16 v[144:145], v10 offset:320
  v_mfma_f32_16x16x32_bf16 v[76:79], v[184:187], v[212:215], v[76:79]
  ds_read_b64_tr_b16 v[146:147], v10 offset:2112
  v_mfma_f32_16x16x32_bf16 v[80:83], v[188:191], v[200:203], v[80:83]
  ds_read_b64_tr_b16 v[148:149], v7 offset:384
  v_mfma_f32_16x16x32_bf16 v[84:87], v[188:191], v[204:207], v[84:87]
  ds_read_b64_tr_b16 v[150:151], v7 offset:2176
  v_mfma_f32_16x16x32_bf16 v[88:91], v[188:191], v[208:211], v[88:91]
  ds_read_b64_tr_b16 v[152:153], v10 offset:384
  v_mfma_f32_16x16x32_bf16 v[92:95], v[188:191], v[212:215], v[92:95]
  ds_read_b64_tr_b16 v[154:155], v10 offset:2176
  v_mfma_f32_16x16x32_bf16 v[96:99], v[192:195], v[200:203], v[96:99]
  v_add_u32 v14, s15, v12
  v_mfma_f32_16x16x32_bf16 v[100:103], v[192:195], v[204:207], v[100:103]
  v_mfma_f32_16x16x32_bf16 v[104:107], v[192:195], v[208:211], v[104:107]
  v_mfma_f32_16x16x32_bf16 v[108:111], v[192:195], v[212:215], v[108:111]
  v_mfma_f32_16x16x32_bf16 v[112:115], v[196:199], v[200:203], v[112:115]
  v_mfma_f32_16x16x32_bf16 v[116:119], v[196:199], v[204:207], v[116:119]
  v_mfma_f32_16x16x32_bf16 v[120:123], v[196:199], v[208:211], v[120:123]
  v_mfma_f32_16x16x32_bf16 v[124:127], v[196:199], v[212:215], v[124:127]
  s_sub_u32 s16, s16, 1
  s_cmp_lg_u32 s16, 0
  s_cbranch_scc1 g3_kernel_cloop22
  s_waitcnt lgkmcnt(15)
  v_mfma_f32_16x16x32_bf16 v[16:19], v[156:159], v[128:131], v[16:19]
  ds_read_b64_tr_b16 v[172:173], v8 offset:14464
  s_waitcnt lgkmcnt(13)
  v_mfma_f32_16x16x32_bf16 v[20:23], v[160:163], v[128:131], v[20:23]
  ds_read_b64_tr_b16 v[174:175], v8 offset:16256
  v_mfma_f32_16x16x32_bf16 v[32:35], v[156:159], v[132:135], v[32:35]
  ds_read_b128 v[200:203], v14 offset:1024
  v_mfma_f32_16x16x32_bf16 v[36:39], v[160:163], v[132:135], v[36:39]
  ds_read_b64_tr_b16 v[176:177], v11 offset:14464
  s_waitcnt lgkmcnt(13)
  v_mfma_f32_16x16x32_bf16 v[24:27], v[164:167], v[128:131], v[24:27]
  ds_read_b64_tr_b16 v[178:179], v11 offset:16256
  v_mfma_f32_16x16x32_bf16 v[40:43], v[164:167], v[132:135], v[40:43]
  ds_read_b128 v[204:207], v14 offset:3072
  v_mfma_f32_16x16x32_bf16 v[48:51], v[156:159], v[136:139], v[48:51]
  ds_read_b64_tr_b16 v[180:181], v8 offset:14528
  v_mfma_f32_16x16x32_bf16 v[52:55], v[160:163], v[136:139], v[52:55]
  ds_read_b64_tr_b16 v[182:183], v8 offset:16320
  v_mfma_f32_16x16x32_bf16 v[56:59], v[164:167], v[136:139], v[56:59]
  ds_read_b128 v[208:211], v14 offset:5120
  s_waitcnt lgkmcnt(15)
  v_mfma_f32_16x16x32_bf16 v[28:31], v[168:171], v[128:131], v[28:31]
  ds_read_b64_tr_b16 v[184:185], v8 offset:14656
  v_mfma_f32_16x16x32_bf16 v[44:47], v[168:171], v[132:135], v[44:47]
  ds_read_b64_tr_b16 v[186:187], v8 offset:16448
  v_mfma_f32_16x16x32_bf16 v[60:63], v[168:171], v[136:139], v[60:63]
  ds_read_b128 v[212:215], v14 offset:7168
  v_mfma_f32_16x16x32_bf16 v[64:67], v[140:143], v[156:159], v[64:67]
  ds_read_b64_tr_b16 v[188:189], v11 offset:14656
  v_mfma_f32_16x16x32_bf16 v[68:71], v[140:143], v[160:163], v[68:71]
  ds_read_b64_tr_b16 v[190:191], v11 offset:16448
  v_mfma_f32_16x16x32_bf16 v[72:75], v[140:143], v[164:167], v[72:75]
  ds_read_b64_tr_b16 v[192:193], v8 offset:14720
  v_mfma_f32_16x16x32_bf16 v[76:79], v[140:143], v[168:171], v[76:79]
  ds_read_b64_tr_b16 v[194:195], v8 offset:16512
  s_waitcnt lgkmcnt(15)
  v_mfma_f32_16x16x32_bf16 v[80:83], v[144:147], v[156:159], v[80:83]
  ds_read_b64_tr_b16 v[196:197], v11 offset:14720
  v_mfma_f32_16x16x32_bf16 v[84:87], v[144:147], v[160:163], v[84:87]
  ds_read_b64_tr_b16 v[198:199], v11 offset:16512
  v_mfma_f32_16x16x32_bf16 v[88:91], v[144:147], v[164:167], v[88:91]
  v_mfma_f32_16x16x32_bf16 v[92:95], v[144:147], v[168:171], v[92:95]
  s_waitcnt lgkmcnt(15)
  v_mfma_f32_16x16x32_bf16 v[96:99], v[148:151], v[156:159], v[96:99]
  v_mfma_f32_16x16x32_bf16 v[100:103], v[148:151], v[160:163], v[100:103]
  v_mfma_f32_16x16x32_bf16 v[104:107], v[148:151], v[164:167], v[104:107]
  v_mfma_f32_16x16x32_bf16 v[108:111], v[148:151], v[168:171], v[108:111]
  s_waitcnt lgkmcnt(15)
  v_mfma_f32_16x16x32_bf16 v[112:115], v[152:155], v[156:159], v[112:115]
  v_mfma_f32_16x16x32_bf16 v[116:119], v[152:155], v[160:163], v[116:119]
  v_mfma_f32_16x16x32_bf16 v[120:123], v[152:155], v[164:167], v[120:123]
  v_mfma_f32_16x16x32_bf16 v[124:127], v[152:155], v[168:171], v[124:127]
  s_waitcnt lgkmcnt(15)
  v_mfma_f32_16x16x32_bf16 v[16:19], v[200:203], v[172:175], v[16:19]
  s_waitcnt lgkmcnt(12)
  v_mfma_f32_16x16x32_bf16 v[20:23], v[204:207], v[172:175], v[20:23]
  v_mfma_f32_16x16x32_bf16 v[32:35], v[200:203], v[176:179], v[32:35]
  v_mfma_f32_16x16x32_bf16 v[36:39], v[204:207], v[176:179], v[36:39]
  s_waitcnt lgkmcnt(9)
  v_mfma_f32_16x16x32_bf16 v[24:27], v[208:211], v[172:175], v[24:27]
  v_mfma_f32_16x16x32_bf16 v[40:43], v[208:211], v[176:179], v[40:43]
  v_mfma_f32_16x16x32_bf16 v[48:51], v[200:203], v[180:183], v[48:51]
  v_mfma_f32_16x16x32_bf16 v[52:55], v[204:207], v[180:183], v[52:55]
  v_mfma_f32_16x16x32_bf16 v[56:59], v[208:211], v[180:183], v[56:59]
  s_waitcnt lgkmcnt(6)
  v_mfma_f32_16x16x32_bf16 v[28:31], v[212:215], v[172:175], v[28:31]
  v_mfma_f32_16x16x32_bf16 v[44:47], v[212:215], v[176:179], v[44:47]
  v_mfma_f32_16x16x32_bf16 v[60:63], v[212:215], v[180:183], v[60:63]
  v_mfma_f32_16x16x32_bf16 v[64:67], v[184:187], v[200:203], v[64:67]
  v_mfma_f32_16x16x32_bf16 v[68:71], v[184:187], v[204:207], v[68:71]
  v_mfma_f32_16x16x32_bf16 v[72:75], v[184:187], v[208:211], v[72:75]
  v_mfma_f32_16x16x32_bf16 v[76:79], v[184:187], v[212:215], v[76:79]
  s_waitcnt lgkmcnt(4)
  v_mfma_f32_16x16x32_bf16 v[80:83], v[188:191], v[200:203], v[80:83]
  v_mfma_f32_16x16x32_bf16 v[84:87], v[188:191], v[204:207], v[84:87]
  v_mfma_f32_16x16x32_bf16 v[88:91], v[188:191], v[208:211], v[88:91]
  v_mfma_f32_16x16x32_bf16 v[92:95], v[188:191], v[212:215], v[92:95]
  s_waitcnt lgkmcnt(2)
  v_mfma_f32_16x16x32_bf16 v[96:99], v[192:195], v[200:203], v[96:99]
  v_mfma_f32_16x16x32_bf16 v[100:103], v[192:195], v[204:207], v[100:103]
  v_mfma_f32_16x16x32_bf16 v[104:107], v[192:195], v[208:211], v[104:107]
  v_mfma_f32_16x16x32_bf16 v[108:111], v[192:195], v[212:215], v[108:111]
  s_waitcnt lgkmcnt(0)
  v_mfma_f32_16x16x32_bf16 v[112:115], v[196:199], v[200:203], v[112:115]
  v_mfma_f32_16x16x32_bf16 v[116:119], v[196:199], v[204:207], v[116:119]
  v_mfma_f32_16x16x32_bf16 v[120:123], v[196:199], v[208:211], v[120:123]
  v_mfma_f32_16x16x32_bf16 v[124:127], v[196:199], v[212:215], v[124:127]
  s_mul_i32 s3, s14, 14336
  s_add_u32 s3, s3, 45056
  v_lshlrev_b32 v4, 4, v0
  v_add_u32 v4, s3, v4
  ds_write_b128 v4, v[24:27] offset:0
  ds_write_b128 v4, v[28:31] offset:1024
  ds_write_b128 v4, v[40:43] offset:2048
  ds_write_b128 v4, v[44:47] offset:3072
  ds_write_b128 v4, v[56:59] offset:4096
  ds_write_b128 v4, v[60:63] offset:5120
  ds_write_b128 v4, v[72:75] offset:6144
  ds_write_b128 v4, v[76:79] offset:7168
  ds_write_b128 v4, v[88:91] offset:8192
  ds_write_b128 v4, v[92:95] offset:9216
  ds_write_b128 v4, v[104:107] offset:10240
  ds_write_b128 v4, v[108:111] offset:11264
  ds_write_b128 v4, v[120:123] offset:12288
  ds_write_b128 v4, v[124:127] offset:13312
  s_waitcnt lgkmcnt(0)
  s_barrier
g3_kernel_epi1:
  v_lshrrev_b32 v168, 4, v0
  v_lshlrev_b32 v168, 5, v168
  s_lshl_b32 s3, s59, 7
  s_add_u32 s3, s3, 131072
  v_add_u32 v168, s3, v168
  ds_read_b128 v[128:131], v168 offset:0
  ds_read_b128 v[136:139], v168 offset:512
  ds_read_b128 v[132:135], v168 offset:16
  ds_read_b128 v[140:143], v168 offset:528
  v_and_b32 v5, 15, v0
  v_lshlrev_b32 v5, 2, v5
  v_add_u32 v5, 132096, v5
  ds_read_b32 v144, v5 offset:256
  ds_read_b32 v145, v5 offset:320
  ds_read_b32 v146, v5 offset:384
  v_lshrrev_b32 v5, 4, v0
  v_lshlrev_b32 v5, 4, v5
  v_add_u32 v5, 132096, v5
  ds_read_b128 v[152:155], v5 offset:640
  ds_read_b128 v[156:159], v5 offset:704
  ds_read_b128 v[160:163], v5 offset:768
  ds_read_b128 v[164:167], v5 offset:832
  v_and_b32 v5, 15, v0
  v_and_b32 v2, 15, v0
  v_and_b32 v2, 12, v2
  v_add_u32 v5, v5, v2
  v_lshlrev_b32 v5, 2, v5
  v_add_u32 v5, s3, v5
  ds_read_b32 v148, v5 offset:0
  ds_read_b32 v150, v5 offset:512
  ds_read_b32 v149, v5 offset:16
  ds_read_b32 v151, v5 offset:528
  v_and_b32 v4, 15, v0
  v_lshrrev_b32 v4, 2, v4
  v_and_b32 v4, 1, v4
  v_lshlrev_b32 v4, 5, v4
  v_lshrrev_b32 v2, 4, v0
  v_lshlrev_b32 v2, 6, v2
  v_add_u32 v4, v4, v2
  v_and_b32 v2, 15, v0
  v_and_b32 v2, 3, v2
  v_lshlrev_b32 v2, 3, v2
  v_add_u32 v4, v4, v2
  v_and_b32 v2, 15, v0
  v_lshrrev_b32 v2, 3, v2
  v_lshlrev_b32 v2, 2, v2
  v_add_u32 v4, v4, v2
  s_lshl_b32 s56, s13, 15
  s_lshl_b32 s19, s59, 8
  s_add_u32 s56, s56, s19
  s_lshl_b32 s19, s12, 11
  s_add_u32 s26, s56, s19
  v_mov_b32 v2, 1152912344
  v_mov_b32 v3, 1152912344
  s_waitcnt lgkmcnt(0)
  s_setprio 3
  v_pk_mul_f32 v[16:17], v[16:17], v[128:129] op_sel:[0,0] op_sel_hi:[1,1]
  v_pk_fma_f32 v[16:17], v[136:137], v[144:145], v[16:17] op_sel:[0,0,0] op_sel_hi:[1,0,1]
  v_pk_mul_f32 v[18:19], v[18:19], v[130:131] op_sel:[0,0] op_sel_hi:[1,1]
  v_pk_fma_f32 v[18:19], v[138:139], v[144:145], v[18:19] op_sel:[0,0,0] op_sel_hi:[1,0,1]
  v_pk_mul_f32 v[20:21], v[20:21], v[132:133] op_sel:[0,0] op_sel_hi:[1,1]
  v_pk_fma_f32 v[20:21], v[140:141], v[144:145], v[20:21] op_sel:[0,0,0] op_sel_hi:[1,0,1]
  v_pk_mul_f32 v[22:23], v[22:23], v[134:135] op_sel:[0,0] op_sel_hi:[1,1]
  v_pk_fma_f32 v[22:23], v[142:143], v[144:145], v[22:23] op_sel:[0,0,0] op_sel_hi:[1,0,1]
  v_pk_fma_f32 v[172:173], v[16:17], s[78:79], 0.5 op_sel:[0,0,0] op_sel_hi:[1,0,0] clamp
  v_pk_fma_f32 v[174:175], v[18:19], s[78:79], 0.5 op_sel:[0,0,0] op_sel_hi:[1,0,0] clamp
  v_pk_fma_f32 v[176:177], v[20:21], s[78:79], 0.5 op_sel:[0,0,0] op_sel_hi:[1,0,0] clamp
  v_pk_fma_f32 v[178:179], v[22:23], s[78:79], 0.5 op_sel:[0,0,0] op_sel_hi:[1,0,0] clamp
  v_pk_fma_f32 v[172:173], v[172:173], v[172:173], v[172:173] neg_lo:[0,0,1] neg_hi:[0,0,1]
  v_pk_fma_f32 v[174:175], v[174:175], v[174:175], v[174:175] neg_lo:[0,0,1] neg_hi:[0,0,1]
  v_pk_fma_f32 v[176:177], v[176:177], v[176:177], v[176:177] neg_lo:[0,0,1] neg_hi:[0,0,1]
  v_pk_fma_f32 v[178:179], v[178:179], v[178:179], v[178:179] neg_lo:[0,0,1] neg_hi:[0,0,1]
  v_pk_fma_f32 v[24:25], v[2:3], v[172:173], s[84:85] op_sel:[0,0,0] op_sel_hi:[1,1,0]
  v_pk_fma_f32 v[26:27], v[2:3], v[174:175], s[84:85] op_sel:[0,0,0] op_sel_hi:[1,1,0]
  v_pk_fma_f32 v[28:29], v[2:3], v[176:177], s[84:85] op_sel:[0,0,0] op_sel_hi:[1,1,0]
  v_pk_fma_f32 v[30:31], v[2:3], v[178:179], s[84:85] op_sel:[0,0,0] op_sel_hi:[1,1,0]
  v_pk_fma_f32 v[24:25], v[24:25], v[172:173], s[82:83] op_sel:[0,0,1] op_sel_hi:[1,1,1]
  v_pk_fma_f32 v[26:27], v[26:27], v[174:175], s[82:83] op_sel:[0,0,1] op_sel_hi:[1,1,1]
  v_pk_fma_f32 v[28:29], v[28:29], v[176:177], s[82:83] op_sel:[0,0,1] op_sel_hi:[1,1,1]
  v_pk_fma_f32 v[30:31], v[30:31], v[178:179], s[82:83] op_sel:[0,0,1] op_sel_hi:[1,1,1]
  v_pk_fma_f32 v[24:25], v[24:25], v[172:173], s[82:83] op_sel:[0,0,0] op_sel_hi:[1,1,0]
  v_pk_fma_f32 v[26:27], v[26:27], v[174:175], s[82:83] op_sel:[0,0,0] op_sel_hi:[1,1,0]
  v_pk_fma_f32 v[28:29], v[28:29], v[176:177], s[82:83] op_sel:[0,0,0] op_sel_hi:[1,1,0]
  v_pk_fma_f32 v[30:31], v[30:31], v[178:179], s[82:83] op_sel:[0,0,0] op_sel_hi:[1,1,0]
  v_pk_fma_f32 v[24:25], v[24:25], v[172:173], s[80:81] op_sel:[0,0,1] op_sel_hi:[1,1,1]
  v_pk_fma_f32 v[26:27], v[26:27], v[174:175], s[80:81] op_sel:[0,0,1] op_sel_hi:[1,1,1]
  v_pk_fma_f32 v[28:29], v[28:29], v[176:177], s[80:81] op_sel:[0,0,1] op_sel_hi:[1,1,1]
  v_pk_fma_f32 v[30:31], v[30:31], v[178:179], s[80:81] op_sel:[0,0,1] op_sel_hi:[1,1,1]
  v_pk_fma_f32 v[24:25], v[24:25], v[172:173], s[80:81] op_sel:[0,0,0] op_sel_hi:[1,1,0]
  v_pk_fma_f32 v[26:27], v[26:27], v[174:175], s[80:81] op_sel:[0,0,0] op_sel_hi:[1,1,0]
  v_pk_fma_f32 v[28:29], v[28:29], v[176:177], s[80:81] op_sel:[0,0,0] op_sel_hi:[1,1,0]
  v_pk_fma_f32 v[30:31], v[30:31], v[178:179], s[80:81] op_sel:[0,0,0] op_sel_hi:[1,1,0]
  v_pk_fma_f32 v[24:25], v[24:25], v[172:173], s[78:79] op_sel:[0,0,1] op_sel_hi:[1,1,1]
  v_pk_fma_f32 v[26:27], v[26:27], v[174:175], s[78:79] op_sel:[0,0,1] op_sel_hi:[1,1,1]
  v_pk_fma_f32 v[28:29], v[28:29], v[176:177], s[78:79] op_sel:[0,0,1] op_sel_hi:[1,1,1]
  v_pk_fma_f32 v[30:31], v[30:31], v[178:179], s[78:79] op_sel:[0,0,1] op_sel_hi:[1,1,1]
  v_pk_fma_f32 v[24:25], v[16:17], v[24:25], 0.5 op_sel:[0,0,0] op_sel_hi:[1,1,0] clamp
  v_pk_fma_f32 v[26:27], v[18:19], v[26:27], 0.5 op_sel:[0,0,0] op_sel_hi:[1,1,0] clamp
  v_pk_fma_f32 v[28:29], v[20:21], v[28:29], 0.5 op_sel:[0,0,0] op_sel_hi:[1,1,0] clamp
  v_pk_fma_f32 v[30:31], v[22:23], v[30:31], 0.5 op_sel:[0,0,0] op_sel_hi:[1,1,0] clamp
  v_pk_mul_f32 v[16:17], v[16:17], v[24:25] op_sel:[0,0] op_sel_hi:[1,1]
  v_pk_mul_f32 v[18:19], v[18:19], v[26:27] op_sel:[0,0] op_sel_hi:[1,1]
  v_pk_mul_f32 v[20:21], v[20:21], v[28:29] op_sel:[0,0] op_sel_hi:[1,1]
  v_pk_mul_f32 v[22:23], v[22:23], v[30:31] op_sel:[0,0] op_sel_hi:[1,1]
  v_pk_mul_f32 v[204:205], v[16:17], v[16:17] op_sel:[0,0] op_sel_hi:[1,1]
  v_pk_mul_f32 v[206:207], v[18:19], v[18:19] op_sel:[0,0] op_sel_hi:[1,1]
  v_pk_mul_f32 v[208:209], v[20:21], v[20:21] op_sel:[0,0] op_sel_hi:[1,1]
  v_pk_mul_f32 v[210:211], v[22:23], v[22:23] op_sel:[0,0] op_sel_hi:[1,1]
  v_pk_mul_f32 v[32:33], v[32:33], v[128:129] op_sel:[0,0] op_sel_hi:[1,1]
  v_pk_fma_f32 v[32:33], v[136:137], v[144:145], v[32:33] op_sel:[0,1,0] op_sel_hi:[1,1,1]
  v_pk_mul_f32 v[34:35], v[34:35], v[130:131] op_sel:[0,0] op_sel_hi:[1,1]
  v_pk_fma_f32 v[34:35], v[138:139], v[144:145], v[34:35] op_sel:[0,1,0] op_sel_hi:[1,1,1]
  v_pk_mul_f32 v[36:37], v[36:37], v[132:133] op_sel:[0,0] op_sel_hi:[1,1]
  v_pk_fma_f32 v[36:37], v[140:141], v[144:145], v[36:37] op_sel:[0,1,0] op_sel_hi:[1,1,1]
  v_pk_mul_f32 v[38:39], v[38:39], v[134:135] op_sel:[0,0] op_sel_hi:[1,1]
  v_pk_fma_f32 v[38:39], v[142:143], v[144:145], v[38:39] op_sel:[0,1,0] op_sel_hi:[1,1,1]
  v_pk_fma_f32 v[172:173], v[32:33], s[78:79], 0.5 op_sel:[0,0,0] op_sel_hi:[1,0,0] clamp
  v_pk_fma_f32 v[174:175], v[34:35], s[78:79], 0.5 op_sel:[0,0,0] op_sel_hi:[1,0,0] clamp
  v_pk_fma_f32 v[176:177], v[36:37], s[78:79], 0.5 op_sel:[0,0,0] op_sel_hi:[1,0,0] clamp
  v_pk_fma_f32 v[178:179], v[38:39], s[78:79], 0.5 op_sel:[0,0,0] op_sel_hi:[1,0,0] clamp
  v_pk_fma_f32 v[172:173], v[172:173], v[172:173], v[172:173] neg_lo:[0,0,1] neg_hi:[0,0,1]
  v_pk_fma_f32 v[174:175], v[174:175], v[174:175], v[174:175] neg_lo:[0,0,1] neg_hi:[0,0,1]
  v_pk_fma_f32 v[176:177], v[176:177], v[176:177], v[176:177] neg_lo:[0,0,1] neg_hi:[0,0,1]
  v_pk_fma_f32 v[178:179], v[178:179], v[178:179], v[178:179] neg_lo:[0,0,1] neg_hi:[0,0,1]
  v_pk_fma_f32 v[24:25], v[2:3], v[172:173], s[84:85] op_sel:[0,0,0] op_sel_hi:[1,1,0]
  v_pk_fma_f32 v[26:27], v[2:3], v[174:175], s[84:85] op_sel:[0,0,0] op_sel_hi:[1,1,0]
  v_pk_fma_f32 v[28:29], v[2:3], v[176:177], s[84:85] op_sel:[0,0,0] op_sel_hi:[1,1,0]
  v_pk_fma_f32 v[30:31], v[2:3], v[178:179], s[84:85] op_sel:[0,0,0] op_sel_hi:[1,1,0]
  v_pk_fma_f32 v[24:25], v[24:25], v[172:173], s[82:83] op_sel:[0,0,1] op_sel_hi:[1,1,1]
  v_pk_fma_f32 v[26:27], v[26:27], v[174:175], s[82:83] op_sel:[0,0,1] op_sel_hi:[1,1,1]
  v_pk_fma_f32 v[28:29], v[28:29], v[176:177], s[82:83] op_sel:[0,0,1] op_sel_hi:[1,1,1]
  v_pk_fma_f32 v[30:31], v[30:31], v[178:179], s[82:83] op_sel:[0,0,1] op_sel_hi:[1,1,1]
  v_pk_fma_f32 v[24:25], v[24:25], v[172:173], s[82:83] op_sel:[0,0,0] op_sel_hi:[1,1,0]
  v_pk_fma_f32 v[26:27], v[26:27], v[174:175], s[82:83] op_sel:[0,0,0] op_sel_hi:[1,1,0]
  v_pk_fma_f32 v[28:29], v[28:29], v[176:177], s[82:83] op_sel:[0,0,0] op_sel_hi:[1,1,0]
  v_pk_fma_f32 v[30:31], v[30:31], v[178:179], s[82:83] op_sel:[0,0,0] op_sel_hi:[1,1,0]
  v_pk_fma_f32 v[24:25], v[24:25], v[172:173], s[80:81] op_sel:[0,0,1] op_sel_hi:[1,1,1]
  v_pk_fma_f32 v[26:27], v[26:27], v[174:175], s[80:81] op_sel:[0,0,1] op_sel_hi:[1,1,1]
  v_pk_fma_f32 v[28:29], v[28:29], v[176:177], s[80:81] op_sel:[0,0,1] op_sel_hi:[1,1,1]
  v_pk_fma_f32 v[30:31], v[30:31], v[178:179], s[80:81] op_sel:[0,0,1] op_sel_hi:[1,1,1]
  v_pk_fma_f32 v[24:25], v[24:25], v[172:173], s[80:81] op_sel:[0,0,0] op_sel_hi:[1,1,0]
  v_pk_fma_f32 v[26:27], v[26:27], v[174:175], s[80:81] op_sel:[0,0,0] op_sel_hi:[1,1,0]
  v_pk_fma_f32 v[28:29], v[28:29], v[176:177], s[80:81] op_sel:[0,0,0] op_sel_hi:[1,1,0]
  v_pk_fma_f32 v[30:31], v[30:31], v[178:179], s[80:81] op_sel:[0,0,0] op_sel_hi:[1,1,0]
  v_pk_fma_f32 v[24:25], v[24:25], v[172:173], s[78:79] op_sel:[0,0,1] op_sel_hi:[1,1,1]
  v_pk_fma_f32 v[26:27], v[26:27], v[174:175], s[78:79] op_sel:[0,0,1] op_sel_hi:[1,1,1]
  v_pk_fma_f32 v[28:29], v[28:29], v[176:177], s[78:79] op_sel:[0,0,1] op_sel_hi:[1,1,1]
  v_pk_fma_f32 v[30:31], v[30:31], v[178:179], s[78:79] op_sel:[0,0,1] op_sel_hi:[1,1,1]
  v_pk_fma_f32 v[24:25], v[32:33], v[24:25], 0.5 op_sel:[0,0,0] op_sel_hi:[1,1,0] clamp
  v_pk_fma_f32 v[26:27], v[34:35], v[26:27], 0.5 op_sel:[0,0,0] op_sel_hi:[1,1,0] clamp
  v_pk_fma_f32 v[28:29], v[36:37], v[28:29], 0.5 op_sel:[0,0,0] op_sel_hi:[1,1,0] clamp
  v_pk_fma_f32 v[30:31], v[38:39], v[30:31], 0.5 op_sel:[0,0,0] op_sel_hi:[1,1,0] clamp
  v_pk_mul_f32 v[32:33], v[32:33], v[24:25] op_sel:[0,0] op_sel_hi:[1,1]
  v_pk_mul_f32 v[34:35], v[34:35], v[26:27] op_sel:[0,0] op_sel_hi:[1,1]
  v_pk_mul_f32 v[36:37], v[36:37], v[28:29] op_sel:[0,0] op_sel_hi:[1,1]
  v_pk_mul_f32 v[38:39], v[38:39], v[30:31] op_sel:[0,0] op_sel_hi:[1,1]
  v_pk_add_f32 v[196:197], v[16:17], v[32:33] op_sel:[0,0] op_sel_hi:[1,1]
  v_pk_fma_f32 v[204:205], v[32:33], v[32:33], v[204:205] op_sel:[0,0,0] op_sel_hi:[1,1,1]
  v_pk_add_f32 v[198:199], v[18:19], v[34:35] op_sel:[0,0] op_sel_hi:[1,1]
  v_pk_fma_f32 v[206:207], v[34:35], v[34:35], v[206:207] op_sel:[0,0,0] op_sel_hi:[1,1,1]
  v_pk_add_f32 v[200:201], v[20:21], v[36:37] op_sel:[0,0] op_sel_hi:[1,1]
  v_pk_fma_f32 v[208:209], v[36:37], v[36:37], v[208:209] op_sel:[0,0,0] op_sel_hi:[1,1,1]
  v_pk_add_f32 v[202:203], v[22:23], v[38:39] op_sel:[0,0] op_sel_hi:[1,1]
  v_pk_fma_f32 v[210:211], v[38:39], v[38:39], v[210:211] op_sel:[0,0,0] op_sel_hi:[1,1,1]
  v_pk_mul_f32 v[48:49], v[48:49], v[128:129] op_sel:[0,0] op_sel_hi:[1,1]
  v_pk_fma_f32 v[48:49], v[136:137], v[146:147], v[48:49] op_sel:[0,0,0] op_sel_hi:[1,0,1]
  v_pk_mul_f32 v[50:51], v[50:51], v[130:131] op_sel:[0,0] op_sel_hi:[1,1]
  v_pk_fma_f32 v[50:51], v[138:139], v[146:147], v[50:51] op_sel:[0,0,0] op_sel_hi:[1,0,1]
  v_pk_mul_f32 v[52:53], v[52:53], v[132:133] op_sel:[0,0] op_sel_hi:[1,1]
  v_pk_fma_f32 v[52:53], v[140:141], v[146:147], v[52:53] op_sel:[0,0,0] op_sel_hi:[1,0,1]
  v_pk_mul_f32 v[54:55], v[54:55], v[134:135] op_sel:[0,0] op_sel_hi:[1,1]
  v_pk_fma_f32 v[54:55], v[142:143], v[146:147], v[54:55] op_sel:[0,0,0] op_sel_hi:[1,0,1]
  v_pk_fma_f32 v[172:173], v[48:49], s[78:79], 0.5 op_sel:[0,0,0] op_sel_hi:[1,0,0] clamp
  v_pk_fma_f32 v[174:175], v[50:51], s[78:79], 0.5 op_sel:[0,0,0] op_sel_hi:[1,0,0] clamp
  v_pk_fma_f32 v[176:177], v[52:53], s[78:79], 0.5 op_sel:[0,0,0] op_sel_hi:[1,0,0] clamp
  v_pk_fma_f32 v[178:179], v[54:55], s[78:79], 0.5 op_sel:[0,0,0] op_sel_hi:[1,0,0] clamp
  v_pk_fma_f32 v[172:173], v[172:173], v[172:173], v[172:173] neg_lo:[0,0,1] neg_hi:[0,0,1]
  v_pk_fma_f32 v[174:175], v[174:175], v[174:175], v[174:175] neg_lo:[0,0,1] neg_hi:[0,0,1]
  v_pk_fma_f32 v[176:177], v[176:177], v[176:177], v[176:177] neg_lo:[0,0,1] neg_hi:[0,0,1]
  v_pk_fma_f32 v[178:179], v[178:179], v[178:179], v[178:179] neg_lo:[0,0,1] neg_hi:[0,0,1]
  v_pk_fma_f32 v[24:25], v[2:3], v[172:173], s[84:85] op_sel:[0,0,0] op_sel_hi:[1,1,0]
  v_pk_fma_f32 v[26:27], v[2:3], v[174:175], s[84:85] op_sel:[0,0,0] op_sel_hi:[1,1,0]
  v_pk_fma_f32 v[28:29], v[2:3], v[176:177], s[84:85] op_sel:[0,0,0] op_sel_hi:[1,1,0]
  v_pk_fma_f32 v[30:31], v[2:3], v[178:179], s[84:85] op_sel:[0,0,0] op_sel_hi:[1,1,0]
  v_pk_fma_f32 v[24:25], v[24:25], v[172:173], s[82:83] op_sel:[0,0,1] op_sel_hi:[1,1,1]
  v_pk_fma_f32 v[26:27], v[26:27], v[174:175], s[82:83] op_sel:[0,0,1] op_sel_hi:[1,1,1]
  v_pk_fma_f32 v[28:29], v[28:29], v[176:177], s[82:83] op_sel:[0,0,1] op_sel_hi:[1,1,1]
  v_pk_fma_f32 v[30:31], v[30:31], v[178:179], s[82:83] op_sel:[0,0,1] op_sel_hi:[1,1,1]
  v_pk_fma_f32 v[24:25], v[24:25], v[172:173], s[82:83] op_sel:[0,0,0] op_sel_hi:[1,1,0]
  v_pk_fma_f32 v[26:27], v[26:27], v[174:175], s[82:83] op_sel:[0,0,0] op_sel_hi:[1,1,0]
  v_pk_fma_f32 v[28:29], v[28:29], v[176:177], s[82:83] op_sel:[0,0,0] op_sel_hi:[1,1,0]
  v_pk_fma_f32 v[30:31], v[30:31], v[178:179], s[82:83] op_sel:[0,0,0] op_sel_hi:[1,1,0]
  v_pk_fma_f32 v[24:25], v[24:25], v[172:173], s[80:81] op_sel:[0,0,1] op_sel_hi:[1,1,1]
  v_pk_fma_f32 v[26:27], v[26:27], v[174:175], s[80:81] op_sel:[0,0,1] op_sel_hi:[1,1,1]
  v_pk_fma_f32 v[28:29], v[28:29], v[176:177], s[80:81] op_sel:[0,0,1] op_sel_hi:[1,1,1]
  v_pk_fma_f32 v[30:31], v[30:31], v[178:179], s[80:81] op_sel:[0,0,1] op_sel_hi:[1,1,1]
  v_pk_fma_f32 v[24:25], v[24:25], v[172:173], s[80:81] op_sel:[0,0,0] op_sel_hi:[1,1,0]
  v_pk_fma_f32 v[26:27], v[26:27], v[174:175], s[80:81] op_sel:[0,0,0] op_sel_hi:[1,1,0]
  v_pk_fma_f32 v[28:29], v[28:29], v[176:177], s[80:81] op_sel:[0,0,0] op_sel_hi:[1,1,0]
  v_pk_fma_f32 v[30:31], v[30:31], v[178:179], s[80:81] op_sel:[0,0,0] op_sel_hi:[1,1,0]
  v_pk_fma_f32 v[24:25], v[24:25], v[172:173], s[78:79] op_sel:[0,0,1] op_sel_hi:[1,1,1]
  v_pk_fma_f32 v[26:27], v[26:27], v[174:175], s[78:79] op_sel:[0,0,1] op_sel_hi:[1,1,1]
  v_pk_fma_f32 v[28:29], v[28:29], v[176:177], s[78:79] op_sel:[0,0,1] op_sel_hi:[1,1,1]
  v_pk_fma_f32 v[30:31], v[30:31], v[178:179], s[78:79] op_sel:[0,0,1] op_sel_hi:[1,1,1]
  v_pk_fma_f32 v[24:25], v[48:49], v[24:25], 0.5 op_sel:[0,0,0] op_sel_hi:[1,1,0] clamp
  v_pk_fma_f32 v[26:27], v[50:51], v[26:27], 0.5 op_sel:[0,0,0] op_sel_hi:[1,1,0] clamp
  v_pk_fma_f32 v[28:29], v[52:53], v[28:29], 0.5 op_sel:[0,0,0] op_sel_hi:[1,1,0] clamp
  v_pk_fma_f32 v[30:31], v[54:55], v[30:31], 0.5 op_sel:[0,0,0] op_sel_hi:[1,1,0] clamp
  v_pk_mul_f32 v[48:49], v[48:49], v[24:25] op_sel:[0,0] op_sel_hi:[1,1]
  v_pk_mul_f32 v[50:51], v[50:51], v[26:27] op_sel:[0,0] op_sel_hi:[1,1]
  v_pk_mul_f32 v[52:53], v[52:53], v[28:29] op_sel:[0,0] op_sel_hi:[1,1]
  v_pk_mul_f32 v[54:55], v[54:55], v[30:31] op_sel:[0,0] op_sel_hi:[1,1]
  v_pk_add_f32 v[196:197], v[196:197], v[48:49] op_sel:[0,0] op_sel_hi:[1,1]
  v_pk_fma_f32 v[204:205], v[48:49], v[48:49], v[204:205] op_sel:[0,0,0] op_sel_hi:[1,1,1]
  v_pk_add_f32 v[198:199], v[198:199], v[50:51] op_sel:[0,0] op_sel_hi:[1,1]
  v_pk_fma_f32 v[206:207], v[50:51], v[50:51], v[206:207] op_sel:[0,0,0] op_sel_hi:[1,1,1]
  v_pk_add_f32 v[200:201], v[200:201], v[52:53] op_sel:[0,0] op_sel_hi:[1,1]
  v_pk_fma_f32 v[208:209], v[52:53], v[52:53], v[208:209] op_sel:[0,0,0] op_sel_hi:[1,1,1]
  v_pk_add_f32 v[202:203], v[202:203], v[54:55] op_sel:[0,0] op_sel_hi:[1,1]
  v_pk_fma_f32 v[210:211], v[54:55], v[54:55], v[210:211] op_sel:[0,0,0] op_sel_hi:[1,1,1]
  v_add_f32_dpp v128, v196, v196 row_ror:8 row_mask:0xf bank_mask:0x3
  v_add_f32_dpp v129, v197, v197 row_ror:8 row_mask:0xf bank_mask:0x3
  v_add_f32_dpp v130, v198, v198 row_ror:8 row_mask:0xf bank_mask:0x3
  v_add_f32_dpp v131, v199, v199 row_ror:8 row_mask:0xf bank_mask:0x3
  v_add_f32_dpp v132, v200, v200 row_ror:8 row_mask:0xf bank_mask:0x3
  v_add_f32_dpp v133, v201, v201 row_ror:8 row_mask:0xf bank_mask:0x3
  v_add_f32_dpp v134, v202, v202 row_ror:8 row_mask:0xf bank_mask:0x3
  v_add_f32_dpp v135, v203, v203 row_ror:8 row_mask:0xf bank_mask:0x3
  v_add_f32_dpp v128, v204, v204 row_ror:8 row_mask:0xf bank_mask:0xc
  v_add_f32_dpp v129, v205, v205 row_ror:8 row_mask:0xf bank_mask:0xc
  v_add_f32_dpp v130, v206, v206 row_ror:8 row_mask:0xf bank_mask:0xc
  v_add_f32_dpp v131, v207, v207 row_ror:8 row_mask:0xf bank_mask:0xc
  v_add_f32_dpp v132, v208, v208 row_ror:8 row_mask:0xf bank_mask:0xc
  v_add_f32_dpp v133, v209, v209 row_ror:8 row_mask:0xf bank_mask:0xc
  v_add_f32_dpp v134, v210, v210 row_ror:8 row_mask:0xf bank_mask:0xc
  v_add_f32_dpp v135, v211, v211 row_ror:8 row_mask:0xf bank_mask:0xc
  v_add_f32_dpp v136, v128, v128 row_shl:4 row_mask:0xf bank_mask:0x5
  v_add_f32_dpp v137, v129, v129 row_shl:4 row_mask:0xf bank_mask:0x5
  v_add_f32_dpp v138, v130, v130 row_shl:4 row_mask:0xf bank_mask:0x5
  v_add_f32_dpp v139, v131, v131 row_shl:4 row_mask:0xf bank_mask:0x5
  v_add_f32_dpp v136, v132, v132 row_shr:4 row_mask:0xf bank_mask:0xa
  v_add_f32_dpp v137, v133, v133 row_shr:4 row_mask:0xf bank_mask:0xa
  v_add_f32_dpp v138, v134, v134 row_shr:4 row_mask:0xf bank_mask:0xa
  v_add_f32_dpp v139, v135, v135 row_shr:4 row_mask:0xf bank_mask:0xa
  v_add_f32_dpp v136, v136, v136 quad_perm:[1,0,3,2] row_mask:0xf bank_mask:0xf
  v_add_f32_dpp v137, v137, v137 quad_perm:[1,0,3,2] row_mask:0xf bank_mask:0xf
  v_add_f32_dpp v138, v138, v138 quad_perm:[1,0,3,2] row_mask:0xf bank_mask:0xf
  v_add_f32_dpp v139, v139, v139 quad_perm:[1,0,3,2] row_mask:0xf bank_mask:0xf
  v_add_f32_dpp v136, v136, v136 quad_perm:[2,3,0,1] row_mask:0xf bank_mask:0xf
  v_add_f32_dpp v137, v137, v137 quad_perm:[2,3,0,1] row_mask:0xf bank_mask:0xf
  v_add_f32_dpp v138, v138, v138 quad_perm:[2,3,0,1] row_mask:0xf bank_mask:0xf
  v_add_f32_dpp v139, v139, v139 quad_perm:[2,3,0,1] row_mask:0xf bank_mask:0xf
  v_and_b32 v5, 3, v0
  v_cmp_eq_u32 s[72:73], 1, v5
  v_cmp_eq_u32 s[74:75], 2, v5
  v_cmp_eq_u32 s[76:77], 3, v5
  v_cndmask_b32 v136, v136, v137, s[72:73]
  v_cndmask_b32 v136, v136, v138, s[74:75]
  v_cndmask_b32 v136, v136, v139, s[76:77]
  v_min_u32 v136, -2, v136
  buffer_store_dword v136, v4, s[68:71], s26 offen offset:1024 sc1
  s_setprio 0
  s_lshl_b32 s3, s13, 2
  s_add_u32 s3, s3, s59
  s_lshl_b32 s57, s3, 10
  s_mul_i32 s3, s3, 448
  s_mul_i32 s19, s12, 28
  s_add_u32 s3, s3, s19
  s_lshl_b32 s3, s3, 8
  v_lshlrev_b32 v4, 4, v0
  v_lshrrev_b32 v169, 4, v0
  v_lshlrev_b32 v169, 13, v169
  v_and_b32 v5, 15, v0
  v_lshlrev_b32 v5, 4, v5
  v_add_u32 v169, v169, v5
  s_add_u32 s27, s56, 4096
  s_mul_i32 s19, s59, 7168
  s_add_u32 s19, s19, 135168
  v_add_u32 v168, s19, v4
  v_pk_mul_f32 v[64:65], v[64:65], v[148:149] op_sel:[0,0] op_sel_hi:[1,0]
  v_pk_fma_f32 v[64:65], v[152:153], v[150:151], v[64:65] op_sel:[0,0,0] op_sel_hi:[1,0,1]
  v_pk_mul_f32 v[66:67], v[66:67], v[148:149] op_sel:[0,0] op_sel_hi:[1,0]
  v_pk_fma_f32 v[66:67], v[154:155], v[150:151], v[66:67] op_sel:[0,0,0] op_sel_hi:[1,0,1]
  v_pk_mul_f32 v[68:69], v[68:69], v[148:149] op_sel:[0,1] op_sel_hi:[1,1]
  v_pk_fma_f32 v[68:69], v[152:153], v[150:151], v[68:69] op_sel:[0,1,0] op_sel_hi:[1,1,1]
  v_pk_mul_f32 v[70:71], v[70:71], v[148:149] op_sel:[0,1] op_sel_hi:[1,1]
  v_pk_fma_f32 v[70:71], v[154:155], v[150:151], v[70:71] op_sel:[0,1,0] op_sel_hi:[1,1,1]
  v_pk_fma_f32 v[172:173], v[64:65], s[78:79], 0.5 op_sel:[0,0,0] op_sel_hi:[1,0,0] clamp
  v_pk_fma_f32 v[174:175], v[66:67], s[78:79], 0.5 op_sel:[0,0,0] op_sel_hi:[1,0,0] clamp
  v_pk_fma_f32 v[176:177], v[68:69], s[78:79], 0.5 op_sel:[0,0,0] op_sel_hi:[1,0,0] clamp
  v_pk_fma_f32 v[178:179], v[70:71], s[78:79], 0.5 op_sel:[0,0,0] op_sel_hi:[1,0,0] clamp
  v_pk_fma_f32 v[172:173], v[172:173], v[172:173], v[172:173] neg_lo:[0,0,1] neg_hi:[0,0,1]
  v_pk_fma_f32 v[174:175], v[174:175], v[174:175], v[174:175] neg_lo:[0,0,1] neg_hi:[0,0,1]
  v_pk_fma_f32 v[176:177], v[176:177], v[176:177], v[176:177] neg_lo:[0,0,1] neg_hi:[0,0,1]
  v_pk_fma_f32 v[178:179], v[178:179], v[178:179], v[178:179] neg_lo:[0,0,1] neg_hi:[0,0,1]
  v_pk_fma_f32 v[24:25], v[2:3], v[172:173], s[84:85] op_sel:[0,0,0] op_sel_hi:[1,1,0]
  v_pk_fma_f32 v[26:27], v[2:3], v[174:175], s[84:85] op_sel:[0,0,0] op_sel_hi:[1,1,0]
  v_pk_fma_f32 v[28:29], v[2:3], v[176:177], s[84:85] op_sel:[0,0,0] op_sel_hi:[1,1,0]
  v_pk_fma_f32 v[30:31], v[2:3], v[178:179], s[84:85] op_sel:[0,0,0] op_sel_hi:[1,1,0]
  v_pk_fma_f32 v[24:25], v[24:25], v[172:173], s[82:83] op_sel:[0,0,1] op_sel_hi:[1,1,1]
  v_pk_fma_f32 v[26:27], v[26:27], v[174:175], s[82:83] op_sel:[0,0,1] op_sel_hi:[1,1,1]
  v_pk_fma_f32 v[28:29], v[28:29], v[176:177], s[82:83] op_sel:[0,0,1] op_sel_hi:[1,1,1]
  v_pk_fma_f32 v[30:31], v[30:31], v[178:179], s[82:83] op_sel:[0,0,1] op_sel_hi:[1,1,1]
  v_pk_fma_f32 v[24:25], v[24:25], v[172:173], s[82:83] op_sel:[0,0,0] op_sel_hi:[1,1,0]
  v_pk_fma_f32 v[26:27], v[26:27], v[174:175], s[82:83] op_sel:[0,0,0] op_sel_hi:[1,1,0]
  v_pk_fma_f32 v[28:29], v[28:29], v[176:177], s[82:83] op_sel:[0,0,0] op_sel_hi:[1,1,0]
  v_pk_fma_f32 v[30:31], v[30:31], v[178:179], s[82:83] op_sel:[0,0,0] op_sel_hi:[1,1,0]
  v_pk_fma_f32 v[24:25], v[24:25], v[172:173], s[80:81] op_sel:[0,0,1] op_sel_hi:[1,1,1]
  v_pk_fma_f32 v[26:27], v[26:27], v[174:175], s[80:81] op_sel:[0,0,1] op_sel_hi:[1,1,1]
  v_pk_fma_f32 v[28:29], v[28:29], v[176:177], s[80:81] op_sel:[0,0,1] op_sel_hi:[1,1,1]
  v_pk_fma_f32 v[30:31], v[30:31], v[178:179], s[80:81] op_sel:[0,0,1] op_sel_hi:[1,1,1]
  v_pk_fma_f32 v[24:25], v[24:25], v[172:173], s[80:81] op_sel:[0,0,0] op_sel_hi:[1,1,0]
  v_pk_fma_f32 v[26:27], v[26:27], v[174:175], s[80:81] op_sel:[0,0,0] op_sel_hi:[1,1,0]
  v_pk_fma_f32 v[28:29], v[28:29], v[176:177], s[80:81] op_sel:[0,0,0] op_sel_hi:[1,1,0]
  v_pk_fma_f32 v[30:31], v[30:31], v[178:179], s[80:81] op_sel:[0,0,0] op_sel_hi:[1,1,0]
  v_pk_fma_f32 v[24:25], v[24:25], v[172:173], s[78:79] op_sel:[0,0,1] op_sel_hi:[1,1,1]
  v_pk_fma_f32 v[26:27], v[26:27], v[174:175], s[78:79] op_sel:[0,0,1] op_sel_hi:[1,1,1]
  v_pk_fma_f32 v[28:29], v[28:29], v[176:177], s[78:79] op_sel:[0,0,1] op_sel_hi:[1,1,1]
  v_pk_fma_f32 v[30:31], v[30:31], v[178:179], s[78:79] op_sel:[0,0,1] op_sel_hi:[1,1,1]
  v_pk_fma_f32 v[24:25], v[64:65], v[24:25], 0.5 op_sel:[0,0,0] op_sel_hi:[1,1,0] clamp
  v_pk_fma_f32 v[26:27], v[66:67], v[26:27], 0.5 op_sel:[0,0,0] op_sel_hi:[1,1,0] clamp
  v_pk_fma_f32 v[28:29], v[68:69], v[28:29], 0.5 op_sel:[0,0,0] op_sel_hi:[1,1,0] clamp
  v_pk_fma_f32 v[30:31], v[70:71], v[30:31], 0.5 op_sel:[0,0,0] op_sel_hi:[1,1,0] clamp
  v_pk_mul_f32 v[64:65], v[64:65], v[24:25] op_sel:[0,0] op_sel_hi:[1,1]
  v_pk_mul_f32 v[66:67], v[66:67], v[26:27] op_sel:[0,0] op_sel_hi:[1,1]
  v_pk_mul_f32 v[68:69], v[68:69], v[28:29] op_sel:[0,0] op_sel_hi:[1,1]
  v_pk_mul_f32 v[70:71], v[70:71], v[30:31] op_sel:[0,0] op_sel_hi:[1,1]
  v_cvt_pk_bf16_f32 v180, v64, v65
  v_cvt_pk_bf16_f32 v181, v66, v67
  v_cvt_pk_bf16_f32 v182, v68, v69
  v_cvt_pk_bf16_f32 v183, v70, v71
  ds_write_b128 v168, v[180:183] offset:3072
  v_pk_mul_f32 v[80:81], v[80:81], v[148:149] op_sel:[0,0] op_sel_hi:[1,0]
  v_pk_fma_f32 v[80:81], v[156:157], v[150:151], v[80:81] op_sel:[0,0,0] op_sel_hi:[1,0,1]
  v_pk_mul_f32 v[82:83], v[82:83], v[148:149] op_sel:[0,0] op_sel_hi:[1,0]
  v_pk_fma_f32 v[82:83], v[158:159], v[150:151], v[82:83] op_sel:[0,0,0] op_sel_hi:[1,0,1]
  v_pk_mul_f32 v[84:85], v[84:85], v[148:149] op_sel:[0,1] op_sel_hi:[1,1]
  v_pk_fma_f32 v[84:85], v[156:157], v[150:151], v[84:85] op_sel:[0,1,0] op_sel_hi:[1,1,1]
  v_pk_mul_f32 v[86:87], v[86:87], v[148:149] op_sel:[0,1] op_sel_hi:[1,1]
  v_pk_fma_f32 v[86:87], v[158:159], v[150:151], v[86:87] op_sel:[0,1,0] op_sel_hi:[1,1,1]
  v_pk_fma_f32 v[172:173], v[80:81], s[78:79], 0.5 op_sel:[0,0,0] op_sel_hi:[1,0,0] clamp
  v_pk_fma_f32 v[174:175], v[82:83], s[78:79], 0.5 op_sel:[0,0,0] op_sel_hi:[1,0,0] clamp
  v_pk_fma_f32 v[176:177], v[84:85], s[78:79], 0.5 op_sel:[0,0,0] op_sel_hi:[1,0,0] clamp
  v_pk_fma_f32 v[178:179], v[86:87], s[78:79], 0.5 op_sel:[0,0,0] op_sel_hi:[1,0,0] clamp
  v_pk_fma_f32 v[172:173], v[172:173], v[172:173], v[172:173] neg_lo:[0,0,1] neg_hi:[0,0,1]
  v_pk_fma_f32 v[174:175], v[174:175], v[174:175], v[174:175] neg_lo:[0,0,1] neg_hi:[0,0,1]
  v_pk_fma_f32 v[176:177], v[176:177], v[176:177], v[176:177] neg_lo:[0,0,1] neg_hi:[0,0,1]
  v_pk_fma_f32 v[178:179], v[178:179], v[178:179], v[178:179] neg_lo:[0,0,1] neg_hi:[0,0,1]
  v_pk_fma_f32 v[24:25], v[2:3], v[172:173], s[84:85] op_sel:[0,0,0] op_sel_hi:[1,1,0]
  v_pk_fma_f32 v[26:27], v[2:3], v[174:175], s[84:85] op_sel:[0,0,0] op_sel_hi:[1,1,0]
  v_pk_fma_f32 v[28:29], v[2:3], v[176:177], s[84:85] op_sel:[0,0,0] op_sel_hi:[1,1,0]
  v_pk_fma_f32 v[30:31], v[2:3], v[178:179], s[84:85] op_sel:[0,0,0] op_sel_hi:[1,1,0]
  v_pk_fma_f32 v[24:25], v[24:25], v[172:173], s[82:83] op_sel:[0,0,1] op_sel_hi:[1,1,1]
  v_pk_fma_f32 v[26:27], v[26:27], v[174:175], s[82:83] op_sel:[0,0,1] op_sel_hi:[1,1,1]
  v_pk_fma_f32 v[28:29], v[28:29], v[176:177], s[82:83] op_sel:[0,0,1] op_sel_hi:[1,1,1]
  v_pk_fma_f32 v[30:31], v[30:31], v[178:179], s[82:83] op_sel:[0,0,1] op_sel_hi:[1,1,1]
  v_pk_fma_f32 v[24:25], v[24:25], v[172:173], s[82:83] op_sel:[0,0,0] op_sel_hi:[1,1,0]
  v_pk_fma_f32 v[26:27], v[26:27], v[174:175], s[82:83] op_sel:[0,0,0] op_sel_hi:[1,1,0]
  v_pk_fma_f32 v[28:29], v[28:29], v[176:177], s[82:83] op_sel:[0,0,0] op_sel_hi:[1,1,0]
  v_pk_fma_f32 v[30:31], v[30:31], v[178:179], s[82:83] op_sel:[0,0,0] op_sel_hi:[1,1,0]
  v_pk_fma_f32 v[24:25], v[24:25], v[172:173], s[80:81] op_sel:[0,0,1] op_sel_hi:[1,1,1]
  v_pk_fma_f32 v[26:27], v[26:27], v[174:175], s[80:81] op_sel:[0,0,1] op_sel_hi:[1,1,1]
  v_pk_fma_f32 v[28:29], v[28:29], v[176:177], s[80:81] op_sel:[0,0,1] op_sel_hi:[1,1,1]
  v_pk_fma_f32 v[30:31], v[30:31], v[178:179], s[80:81] op_sel:[0,0,1] op_sel_hi:[1,1,1]
  v_pk_fma_f32 v[24:25], v[24:25], v[172:173], s[80:81] op_sel:[0,0,0] op_sel_hi:[1,1,0]
  v_pk_fma_f32 v[26:27], v[26:27], v[174:175], s[80:81] op_sel:[0,0,0] op_sel_hi:[1,1,0]
  v_pk_fma_f32 v[28:29], v[28:29], v[176:177], s[80:81] op_sel:[0,0,0] op_sel_hi:[1,1,0]
  v_pk_fma_f32 v[30:31], v[30:31], v[178:179], s[80:81] op_sel:[0,0,0] op_sel_hi:[1,1,0]
  v_pk_fma_f32 v[24:25], v[24:25], v[172:173], s[78:79] op_sel:[0,0,1] op_sel_hi:[1,1,1]
  v_pk_fma_f32 v[26:27], v[26:27], v[174:175], s[78:79] op_sel:[0,0,1] op_sel_hi:[1,1,1]
  v_pk_fma_f32 v[28:29], v[28:29], v[176:177], s[78:79] op_sel:[0,0,1] op_sel_hi:[1,1,1]
  v_pk_fma_f32 v[30:31], v[30:31], v[178:179], s[78:79] op_sel:[0,0,1] op_sel_hi:[1,1,1]
  v_pk_fma_f32 v[24:25], v[80:81], v[24:25], 0.5 op_sel:[0,0,0] op_sel_hi:[1,1,0] clamp
  v_pk_fma_f32 v[26:27], v[82:83], v[26:27], 0.5 op_sel:[0,0,0] op_sel_hi:[1,1,0] clamp
  v_pk_fma_f32 v[28:29], v[84:85], v[28:29], 0.5 op_sel:[0,0,0] op_sel_hi:[1,1,0] clamp
  v_pk_fma_f32 v[30:31], v[86:87], v[30:31], 0.5 op_sel:[0,0,0] op_sel_hi:[1,1,0] clamp
  v_pk_mul_f32 v[80:81], v[80:81], v[24:25] op_sel:[0,0] op_sel_hi:[1,1]
  v_pk_mul_f32 v[82:83], v[82:83], v[26:27] op_sel:[0,0] op_sel_hi:[1,1]
  v_pk_mul_f32 v[84:85], v[84:85], v[28:29] op_sel:[0,0] op_sel_hi:[1,1]
  v_pk_mul_f32 v[86:87], v[86:87], v[30:31] op_sel:[0,0] op_sel_hi:[1,1]
  v_cvt_pk_bf16_f32 v184, v80, v81
  v_cvt_pk_bf16_f32 v185, v82, v83
  v_cvt_pk_bf16_f32 v186, v84, v85
  v_cvt_pk_bf16_f32 v187, v86, v87
  ds_write_b128 v168, v[184:187] offset:4096
  v_pk_mul_f32 v[96:97], v[96:97], v[148:149] op_sel:[0,0] op_sel_hi:[1,0]
  v_pk_fma_f32 v[96:97], v[160:161], v[150:151], v[96:97] op_sel:[0,0,0] op_sel_hi:[1,0,1]
  v_pk_mul_f32 v[98:99], v[98:99], v[148:149] op_sel:[0,0] op_sel_hi:[1,0]
  v_pk_fma_f32 v[98:99], v[162:163], v[150:151], v[98:99] op_sel:[0,0,0] op_sel_hi:[1,0,1]
  v_pk_mul_f32 v[100:101], v[100:101], v[148:149] op_sel:[0,1] op_sel_hi:[1,1]
  v_pk_fma_f32 v[100:101], v[160:161], v[150:151], v[100:101] op_sel:[0,1,0] op_sel_hi:[1,1,1]
  v_pk_mul_f32 v[102:103], v[102:103], v[148:149] op_sel:[0,1] op_sel_hi:[1,1]
  v_pk_fma_f32 v[102:103], v[162:163], v[150:151], v[102:103] op_sel:[0,1,0] op_sel_hi:[1,1,1]
  v_pk_fma_f32 v[172:173], v[96:97], s[78:79], 0.5 op_sel:[0,0,0] op_sel_hi:[1,0,0] clamp
  v_pk_fma_f32 v[174:175], v[98:99], s[78:79], 0.5 op_sel:[0,0,0] op_sel_hi:[1,0,0] clamp
  v_pk_fma_f32 v[176:177], v[100:101], s[78:79], 0.5 op_sel:[0,0,0] op_sel_hi:[1,0,0] clamp
  v_pk_fma_f32 v[178:179], v[102:103], s[78:79], 0.5 op_sel:[0,0,0] op_sel_hi:[1,0,0] clamp
  v_pk_fma_f32 v[172:173], v[172:173], v[172:173], v[172:173] neg_lo:[0,0,1] neg_hi:[0,0,1]
  v_pk_fma_f32 v[174:175], v[174:175], v[174:175], v[174:175] neg_lo:[0,0,1] neg_hi:[0,0,1]
  v_pk_fma_f32 v[176:177], v[176:177], v[176:177], v[176:177] neg_lo:[0,0,1] neg_hi:[0,0,1]
  v_pk_fma_f32 v[178:179], v[178:179], v[178:179], v[178:179] neg_lo:[0,0,1] neg_hi:[0,0,1]
  v_pk_fma_f32 v[24:25], v[2:3], v[172:173], s[84:85] op_sel:[0,0,0] op_sel_hi:[1,1,0]
  v_pk_fma_f32 v[26:27], v[2:3], v[174:175], s[84:85] op_sel:[0,0,0] op_sel_hi:[1,1,0]
  v_pk_fma_f32 v[28:29], v[2:3], v[176:177], s[84:85] op_sel:[0,0,0] op_sel_hi:[1,1,0]
  v_pk_fma_f32 v[30:31], v[2:3], v[178:179], s[84:85] op_sel:[0,0,0] op_sel_hi:[1,1,0]
  v_pk_fma_f32 v[24:25], v[24:25], v[172:173], s[82:83] op_sel:[0,0,1] op_sel_hi:[1,1,1]
  v_pk_fma_f32 v[26:27], v[26:27], v[174:175], s[82:83] op_sel:[0,0,1] op_sel_hi:[1,1,1]
  v_pk_fma_f32 v[28:29], v[28:29], v[176:177], s[82:83] op_sel:[0,0,1] op_sel_hi:[1,1,1]
  v_pk_fma_f32 v[30:31], v[30:31], v[178:179], s[82:83] op_sel:[0,0,1] op_sel_hi:[1,1,1]
  v_pk_fma_f32 v[24:25], v[24:25], v[172:173], s[82:83] op_sel:[0,0,0] op_sel_hi:[1,1,0]
  v_pk_fma_f32 v[26:27], v[26:27], v[174:175], s[82:83] op_sel:[0,0,0] op_sel_hi:[1,1,0]
  v_pk_fma_f32 v[28:29], v[28:29], v[176:177], s[82:83] op_sel:[0,0,0] op_sel_hi:[1,1,0]
  v_pk_fma_f32 v[30:31], v[30:31], v[178:179], s[82:83] op_sel:[0,0,0] op_sel_hi:[1,1,0]
  v_pk_fma_f32 v[24:25], v[24:25], v[172:173], s[80:81] op_sel:[0,0,1] op_sel_hi:[1,1,1]
  v_pk_fma_f32 v[26:27], v[26:27], v[174:175], s[80:81] op_sel:[0,0,1] op_sel_hi:[1,1,1]
  v_pk_fma_f32 v[28:29], v[28:29], v[176:177], s[80:81] op_sel:[0,0,1] op_sel_hi:[1,1,1]
  v_pk_fma_f32 v[30:31], v[30:31], v[178:179], s[80:81] op_sel:[0,0,1] op_sel_hi:[1,1,1]
  v_pk_fma_f32 v[24:25], v[24:25], v[172:173], s[80:81] op_sel:[0,0,0] op_sel_hi:[1,1,0]
  v_pk_fma_f32 v[26:27], v[26:27], v[174:175], s[80:81] op_sel:[0,0,0] op_sel_hi:[1,1,0]
  v_pk_fma_f32 v[28:29], v[28:29], v[176:177], s[80:81] op_sel:[0,0,0] op_sel_hi:[1,1,0]
  v_pk_fma_f32 v[30:31], v[30:31], v[178:179], s[80:81] op_sel:[0,0,0] op_sel_hi:[1,1,0]
  v_pk_fma_f32 v[24:25], v[24:25], v[172:173], s[78:79] op_sel:[0,0,1] op_sel_hi:[1,1,1]
  v_pk_fma_f32 v[26:27], v[26:27], v[174:175], s[78:79] op_sel:[0,0,1] op_sel_hi:[1,1,1]
  v_pk_fma_f32 v[28:29], v[28:29], v[176:177], s[78:79] op_sel:[0,0,1] op_sel_hi:[1,1,1]
  v_pk_fma_f32 v[30:31], v[30:31], v[178:179], s[78:79] op_sel:[0,0,1] op_sel_hi:[1,1,1]
  v_pk_fma_f32 v[24:25], v[96:97], v[24:25], 0.5 op_sel:[0,0,0] op_sel_hi:[1,1,0] clamp
  v_pk_fma_f32 v[26:27], v[98:99], v[26:27], 0.5 op_sel:[0,0,0] op_sel_hi:[1,1,0] clamp
  v_pk_fma_f32 v[28:29], v[100:101], v[28:29], 0.5 op_sel:[0,0,0] op_sel_hi:[1,1,0] clamp
  v_pk_fma_f32 v[30:31], v[102:103], v[30:31], 0.5 op_sel:[0,0,0] op_sel_hi:[1,1,0] clamp
  v_pk_mul_f32 v[96:97], v[96:97], v[24:25] op_sel:[0,0] op_sel_hi:[1,1]
  v_pk_mul_f32 v[98:99], v[98:99], v[26:27] op_sel:[0,0] op_sel_hi:[1,1]
  v_pk_mul_f32 v[100:101], v[100:101], v[28:29] op_sel:[0,0] op_sel_hi:[1,1]
  v_pk_mul_f32 v[102:103], v[102:103], v[30:31] op_sel:[0,0] op_sel_hi:[1,1]
  v_cvt_pk_bf16_f32 v188, v96, v97
  v_cvt_pk_bf16_f32 v189, v98, v99
  v_cvt_pk_bf16_f32 v190, v100, v101
  v_cvt_pk_bf16_f32 v191, v102, v103
  ds_write_b128 v168, v[188:191] offset:5120
  v_pk_mul_f32 v[112:113], v[112:113], v[148:149] op_sel:[0,0] op_sel_hi:[1,0]
  v_pk_fma_f32 v[112:113], v[164:165], v[150:151], v[112:113] op_sel:[0,0,0] op_sel_hi:[1,0,1]
  v_pk_mul_f32 v[114:115], v[114:115], v[148:149] op_sel:[0,0] op_sel_hi:[1,0]
  v_pk_fma_f32 v[114:115], v[166:167], v[150:151], v[114:115] op_sel:[0,0,0] op_sel_hi:[1,0,1]
  v_pk_mul_f32 v[116:117], v[116:117], v[148:149] op_sel:[0,1] op_sel_hi:[1,1]
  v_pk_fma_f32 v[116:117], v[164:165], v[150:151], v[116:117] op_sel:[0,1,0] op_sel_hi:[1,1,1]
  v_pk_mul_f32 v[118:119], v[118:119], v[148:149] op_sel:[0,1] op_sel_hi:[1,1]
  v_pk_fma_f32 v[118:119], v[166:167], v[150:151], v[118:119] op_sel:[0,1,0] op_sel_hi:[1,1,1]
  buffer_load_dwordx4 v[216:219], v169, s[68:71], s56 offen offset:0 sc1
  buffer_load_dwordx4 v[220:223], v169, s[68:71], s56 offen offset:1024 sc1
  buffer_load_dwordx4 v[224:227], v169, s[68:71], s56 offen offset:2048 sc1
  buffer_load_dwordx4 v[228:231], v169, s[68:71], s56 offen offset:3072 sc1
  buffer_load_dwordx4 v[232:235], v169, s[68:71], s27 offen offset:0 sc1
  buffer_load_dwordx4 v[236:239], v169, s[68:71], s27 offen offset:1024 sc1
  buffer_load_dwordx4 v[240:243], v169, s[68:71], s27 offen offset:2048 sc1
  buffer_load_dwordx4 v[244:247], v169, s[68:71], s27 offen offset:3072 sc1
  v_pk_fma_f32 v[172:173], v[112:113], s[78:79], 0.5 op_sel:[0,0,0] op_sel_hi:[1,0,0] clamp
  v_pk_fma_f32 v[174:175], v[114:115], s[78:79], 0.5 op_sel:[0,0,0] op_sel_hi:[1,0,0] clamp
  v_pk_fma_f32 v[176:177], v[116:117], s[78:79], 0.5 op_sel:[0,0,0] op_sel_hi:[1,0,0] clamp
  v_pk_fma_f32 v[178:179], v[118:119], s[78:79], 0.5 op_sel:[0,0,0] op_sel_hi:[1,0,0] clamp
  v_pk_fma_f32 v[172:173], v[172:173], v[172:173], v[172:173] neg_lo:[0,0,1] neg_hi:[0,0,1]
  v_pk_fma_f32 v[174:175], v[174:175], v[174:175], v[174:175] neg_lo:[0,0,1] neg_hi:[0,0,1]
  v_pk_fma_f32 v[176:177], v[176:177], v[176:177], v[176:177] neg_lo:[0,0,1] neg_hi:[0,0,1]
  v_pk_fma_f32 v[178:179], v[178:179], v[178:179], v[178:179] neg_lo:[0,0,1] neg_hi:[0,0,1]
  v_pk_fma_f32 v[24:25], v[2:3], v[172:173], s[84:85] op_sel:[0,0,0] op_sel_hi:[1,1,0]
  v_pk_fma_f32 v[26:27], v[2:3], v[174:175], s[84:85] op_sel:[0,0,0] op_sel_hi:[1,1,0]
  v_pk_fma_f32 v[28:29], v[2:3], v[176:177], s[84:85] op_sel:[0,0,0] op_sel_hi:[1,1,0]
  v_pk_fma_f32 v[30:31], v[2:3], v[178:179], s[84:85] op_sel:[0,0,0] op_sel_hi:[1,1,0]
  v_pk_fma_f32 v[24:25], v[24:25], v[172:173], s[82:83] op_sel:[0,0,1] op_sel_hi:[1,1,1]
  v_pk_fma_f32 v[26:27], v[26:27], v[174:175], s[82:83] op_sel:[0,0,1] op_sel_hi:[1,1,1]
  v_pk_fma_f32 v[28:29], v[28:29], v[176:177], s[82:83] op_sel:[0,0,1] op_sel_hi:[1,1,1]
  v_pk_fma_f32 v[30:31], v[30:31], v[178:179], s[82:83] op_sel:[0,0,1] op_sel_hi:[1,1,1]
  v_pk_fma_f32 v[24:25], v[24:25], v[172:173], s[82:83] op_sel:[0,0,0] op_sel_hi:[1,1,0]
  v_pk_fma_f32 v[26:27], v[26:27], v[174:175], s[82:83] op_sel:[0,0,0] op_sel_hi:[1,1,0]
  v_pk_fma_f32 v[28:29], v[28:29], v[176:177], s[82:83] op_sel:[0,0,0] op_sel_hi:[1,1,0]
  v_pk_fma_f32 v[30:31], v[30:31], v[178:179], s[82:83] op_sel:[0,0,0] op_sel_hi:[1,1,0]
  v_pk_fma_f32 v[24:25], v[24:25], v[172:173], s[80:81] op_sel:[0,0,1] op_sel_hi:[1,1,1]
  v_pk_fma_f32 v[26:27], v[26:27], v[174:175], s[80:81] op_sel:[0,0,1] op_sel_hi:[1,1,1]
  v_pk_fma_f32 v[28:29], v[28:29], v[176:177], s[80:81] op_sel:[0,0,1] op_sel_hi:[1,1,1]
  v_pk_fma_f32 v[30:31], v[30:31], v[178:179], s[80:81] op_sel:[0,0,1] op_sel_hi:[1,1,1]
  v_pk_fma_f32 v[24:25], v[24:25], v[172:173], s[80:81] op_sel:[0,0,0] op_sel_hi:[1,1,0]
  v_pk_fma_f32 v[26:27], v[26:27], v[174:175], s[80:81] op_sel:[0,0,0] op_sel_hi:[1,1,0]
  v_pk_fma_f32 v[28:29], v[28:29], v[176:177], s[80:81] op_sel:[0,0,0] op_sel_hi:[1,1,0]
  v_pk_fma_f32 v[30:31], v[30:31], v[178:179], s[80:81] op_sel:[0,0,0] op_sel_hi:[1,1,0]
  v_pk_fma_f32 v[24:25], v[24:25], v[172:173], s[78:79] op_sel:[0,0,1] op_sel_hi:[1,1,1]
  v_pk_fma_f32 v[26:27], v[26:27], v[174:175], s[78:79] op_sel:[0,0,1] op_sel_hi:[1,1,1]
  v_pk_fma_f32 v[28:29], v[28:29], v[176:177], s[78:79] op_sel:[0,0,1] op_sel_hi:[1,1,1]
  v_pk_fma_f32 v[30:31], v[30:31], v[178:179], s[78:79] op_sel:[0,0,1] op_sel_hi:[1,1,1]
  v_pk_fma_f32 v[24:25], v[112:113], v[24:25], 0.5 op_sel:[0,0,0] op_sel_hi:[1,1,0] clamp
  v_pk_fma_f32 v[26:27], v[114:115], v[26:27], 0.5 op_sel:[0,0,0] op_sel_hi:[1,1,0] clamp
  v_pk_fma_f32 v[28:29], v[116:117], v[28:29], 0.5 op_sel:[0,0,0] op_sel_hi:[1,1,0] clamp
  v_pk_fma_f32 v[30:31], v[118:119], v[30:31], 0.5 op_sel:[0,0,0] op_sel_hi:[1,1,0] clamp
  v_pk_mul_f32 v[112:113], v[112:113], v[24:25] op_sel:[0,0] op_sel_hi:[1,1]
  v_pk_mul_f32 v[114:115], v[114:115], v[26:27] op_sel:[0,0] op_sel_hi:[1,1]
  v_pk_mul_f32 v[116:117], v[116:117], v[28:29] op_sel:[0,0] op_sel_hi:[1,1]
  v_pk_mul_f32 v[118:119], v[118:119], v[30:31] op_sel:[0,0] op_sel_hi:[1,1]
  v_cvt_pk_bf16_f32 v192, v112, v113
  v_cvt_pk_bf16_f32 v193, v114, v115
  v_cvt_pk_bf16_f32 v194, v116, v117
  v_cvt_pk_bf16_f32 v195, v118, v119
  ds_write_b128 v168, v[192:195] offset:6144
  s_setprio 3
  s_mov_b32 s58, 0
  s_waitcnt vmcnt(0)
  v_max_u32 v5, v216, v217
  v_max3_u32 v5, v5, v218, v219
  v_max3_u32 v5, v5, v220, v221
  v_max3_u32 v5, v5, v222, v223
  v_max3_u32 v5, v5, v224, v225
  v_max3_u32 v5, v5, v226, v227
  v_max3_u32 v5, v5, v228, v229
  v_max3_u32 v5, v5, v230, v231
  v_max3_u32 v5, v5, v232, v233
  v_max3_u32 v5, v5, v234, v235
  v_max3_u32 v5, v5, v236, v237
  v_max3_u32 v5, v5, v238, v239
  v_max3_u32 v5, v5, v240, v241
  v_max3_u32 v5, v5, v242, v243
  v_max3_u32 v5, v5, v244, v245
  v_max3_u32 v5, v5, v246, v247
  v_cmp_eq_u32 vcc, -1, v5
  s_cbranch_vccz g3_kernel_polld25
g3_kernel_poll23:
  s_mov_b32 s19, 0
  v_max3_u32 v5, v216, v217, v218
  v_max_u32 v5, v5, v219
  v_cmp_eq_u32 vcc, -1, v5
  s_cbranch_vccz g3_kernel_ps26
  buffer_load_dwordx4 v[216:219], v169, s[68:71], s56 offen offset:0 sc1
  s_mov_b32 s19, 1
g3_kernel_ps26:
  v_max3_u32 v5, v220, v221, v222
  v_max_u32 v5, v5, v223
  v_cmp_eq_u32 vcc, -1, v5
  s_cbranch_vccz g3_kernel_ps27
  buffer_load_dwordx4 v[220:223], v169, s[68:71], s56 offen offset:1024 sc1
  s_mov_b32 s19, 1
g3_kernel_ps27:
  v_max3_u32 v5, v224, v225, v226
  v_max_u32 v5, v5, v227
  v_cmp_eq_u32 vcc, -1, v5
  s_cbranch_vccz g3_kernel_ps28
  buffer_load_dwordx4 v[224:227], v169, s[68:71], s56 offen offset:2048 sc1
  s_mov_b32 s19, 1
g3_kernel_ps28:
  v_max3_u32 v5, v228, v229, v230
  v_max_u32 v5, v5, v231
  v_cmp_eq_u32 vcc, -1, v5
  s_cbranch_vccz g3_kernel_ps29
  buffer_load_dwordx4 v[228:231], v169, s[68:71], s56 offen offset:3072 sc1
  s_mov_b32 s19, 1
g3_kernel_ps29:
  v_max3_u32 v5, v232, v233, v234
  v_max_u32 v5, v5, v235
  v_cmp_eq_u32 vcc, -1, v5
  s_cbranch_vccz g3_kernel_ps30
  buffer_load_dwordx4 v[232:235], v169, s[68:71], s27 offen offset:0 sc1
  s_mov_b32 s19, 1
g3_kernel_ps30:
  v_max3_u32 v5, v236, v237, v238
  v_max_u32 v5, v5, v239
  v_cmp_eq_u32 vcc, -1, v5
  s_cbranch_vccz g3_kernel_ps31
  buffer_load_dwordx4 v[236:239], v169, s[68:71], s27 offen offset:1024 sc1
  s_mov_b32 s19, 1
g3_kernel_ps31:
  v_max3_u32 v5, v240, v241, v242
  v_max_u32 v5, v5, v243
  v_cmp_eq_u32 vcc, -1, v5
  s_cbranch_vccz g3_kernel_ps32
  buffer_load_dwordx4 v[240:243], v169, s[68:71], s27 offen offset:2048 sc1
  s_mov_b32 s19, 1
g3_kernel_ps32:
  v_max3_u32 v5, v244, v245, v246
  v_max_u32 v5, v5, v247
  v_cmp_eq_u32 vcc, -1, v5
  s_cbranch_vccz g3_kernel_ps33
  buffer_load_dwordx4 v[244:247], v169, s[68:71], s27 offen offset:3072 sc1
  s_mov_b32 s19, 1
g3_kernel_ps33:
  s_add_u32 s58, s58, 1
  s_cmp_eq_u32 s19, 0
  s_cbranch_scc1 g3_kernel_polld25
  s_waitcnt vmcnt(0)
  s_cmp_lt_u32 s58, 0x10000
  s_cbranch_scc1 g3_kernel_poll23
g3_kernel_polld25:
  v_pk_add_f32 v[216:217], v[216:217], v[232:233] op_sel:[0,0] op_sel_hi:[1,1]
  v_pk_add_f32 v[218:219], v[218:219], v[234:235] op_sel:[0,0] op_sel_hi:[1,1]
  v_pk_add_f32 v[220:221], v[220:221], v[236:237] op_sel:[0,0] op_sel_hi:[1,1]
  v_pk_add_f32 v[222:223], v[222:223], v[238:239] op_sel:[0,0] op_sel_hi:[1,1]
  v_pk_add_f32 v[224:225], v[224:225], v[240:241] op_sel:[0,0] op_sel_hi:[1,1]
  v_pk_add_f32 v[226:227], v[226:227], v[242:243] op_sel:[0,0] op_sel_hi:[1,1]
  v_pk_add_f32 v[228:229], v[228:229], v[244:245] op_sel:[0,0] op_sel_hi:[1,1]
  v_pk_add_f32 v[230:231], v[230:231], v[246:247] op_sel:[0,0] op_sel_hi:[1,1]
  v_pk_add_f32 v[216:217], v[216:217], v[224:225] op_sel:[0,0] op_sel_hi:[1,1]
  v_pk_add_f32 v[218:219], v[218:219], v[226:227] op_sel:[0,0] op_sel_hi:[1,1]
  v_pk_add_f32 v[220:221], v[220:221], v[228:229] op_sel:[0,0] op_sel_hi:[1,1]
  v_pk_add_f32 v[222:223], v[222:223], v[230:231] op_sel:[0,0] op_sel_hi:[1,1]
  v_pk_add_f32 v[216:217], v[216:217], v[220:221] op_sel:[0,0] op_sel_hi:[1,1]
  v_pk_add_f32 v[218:219], v[218:219], v[222:223] op_sel:[0,0] op_sel_hi:[1,1]
  s_nop 1
  v_permlane32_swap_b32 v216, v218
  v_permlane32_swap_b32 v217, v219
  v_pk_add_f32 v[216:217], v[216:217], v[218:219] op_sel:[0,0] op_sel_hi:[1,1]
  v_mov_b32 v218, v216
  v_mov_b32 v219, v217
  s_nop 0
  v_permlane16_swap_b32 v216, v218
  v_permlane16_swap_b32 v217, v219
  v_pk_add_f32 v[216:217], v[216:217], v[218:219] op_sel:[0,0] op_sel_hi:[1,1]
  v_mul_f32 v216, 974276901, v216
  v_mul_f32 v217, 974276901, v217
  v_fma_f32 v217, -v216, v216, v217
  v_max_f32 v217, 0, v217
  v_add_f32 v217, 925353388, v217
  v_rsq_f32 v217, v217
  s_nop 0
  v_mul_f32 v216, v216, v217
  v_sub_f32 v216, 0, v216
  v_and_b32 v5, 15, v0
  v_lshlrev_b32 v5, 3, v5
  v_lshrrev_b32 v2, 5, v0
  v_lshlrev_b32 v2, 2, v2
  v_add_u32 v5, v5, v2
  s_lshl_b32 s3, s14, 8
  s_add_u32 s3, s3, 133120
  v_add_u32 v5, s3, v5
  ds_write_b32 v5, v217
  ds_write_b32 v5, v216 offset:128
  v_lshrrev_b32 v168, 4, v0
  v_lshlrev_b32 v168, 5, v168
  v_add_u32 v168, s3, v168
  s_mul_i32 s56, s12, 7
  s_waitcnt lgkmcnt(0)
  ds_read_b128 v[128:131], v168 offset:0
  ds_read_b128 v[136:139], v168 offset:128
  ds_read_b128 v[132:135], v168 offset:16
  ds_read_b128 v[140:143], v168 offset:144
  s_waitcnt lgkmcnt(0)
  s_add_u32 s3, s56, 4
  s_lshl_b32 s3, s3, 16
  s_add_u32 s26, s3, s57
  v_pk_fma_f32 v[16:17], v[16:17], v[128:129], v[136:137] op_sel:[0,0,0] op_sel_hi:[1,1,1]
  v_cvt_pk_bf16_f32 v180, v16, v17
  v_pk_fma_f32 v[18:19], v[18:19], v[130:131], v[138:139] op_sel:[0,0,0] op_sel_hi:[1,1,1]
  v_cvt_pk_bf16_f32 v181, v18, v19
  v_pk_fma_f32 v[20:21], v[20:21], v[132:133], v[140:141] op_sel:[0,0,0] op_sel_hi:[1,1,1]
  v_cvt_pk_bf16_f32 v182, v20, v21
  v_pk_fma_f32 v[22:23], v[22:23], v[134:135], v[142:143] op_sel:[0,0,0] op_sel_hi:[1,1,1]
  v_cvt_pk_bf16_f32 v183, v22, v23
  buffer_store_dwordx4 v[180:183], v4, s[64:67], s26 offen sc0 sc1
  s_add_u32 s3, s56, 5
  s_lshl_b32 s3, s3, 16
  s_add_u32 s26, s3, s57
  v_pk_fma_f32 v[32:33], v[32:33], v[128:129], v[136:137] op_sel:[0,0,0] op_sel_hi:[1,1,1]
  v_cvt_pk_bf16_f32 v184, v32, v33
  v_pk_fma_f32 v[34:35], v[34:35], v[130:131], v[138:139] op_sel:[0,0,0] op_sel_hi:[1,1,1]
  v_cvt_pk_bf16_f32 v185, v34, v35
  v_pk_fma_f32 v[36:37], v[36:37], v[132:133], v[140:141] op_sel:[0,0,0] op_sel_hi:[1,1,1]
  v_cvt_pk_bf16_f32 v186, v36, v37
  v_pk_fma_f32 v[38:39], v[38:39], v[134:135], v[142:143] op_sel:[0,0,0] op_sel_hi:[1,1,1]
  v_cvt_pk_bf16_f32 v187, v38, v39
  buffer_store_dwordx4 v[184:187], v4, s[64:67], s26 offen sc0 sc1
  s_add_u32 s3, s56, 6
  s_lshl_b32 s3, s3, 16
  s_add_u32 s26, s3, s57
  v_pk_fma_f32 v[48:49], v[48:49], v[128:129], v[136:137] op_sel:[0,0,0] op_sel_hi:[1,1,1]
  v_cvt_pk_bf16_f32 v188, v48, v49
  v_pk_fma_f32 v[50:51], v[50:51], v[130:131], v[138:139] op_sel:[0,0,0] op_sel_hi:[1,1,1]
  v_cvt_pk_bf16_f32 v189, v50, v51
  v_pk_fma_f32 v[52:53], v[52:53], v[132:133], v[140:141] op_sel:[0,0,0] op_sel_hi:[1,1,1]
  v_cvt_pk_bf16_f32 v190, v52, v53
  v_pk_fma_f32 v[54:55], v[54:55], v[134:135], v[142:143] op_sel:[0,0,0] op_sel_hi:[1,1,1]
  v_cvt_pk_bf16_f32 v191, v54, v55
  buffer_store_dwordx4 v[188:191], v4, s[64:67], s26 offen sc0 sc1
  s_setprio 0
  s_branch g3_kernel_fin
g3_kernel_ldjoin:
  ds_read_b128 v[16:19], v4 offset:0
  ds_read_b128 v[20:23], v4 offset:1024
  ds_read_b128 v[32:35], v4 offset:2048
  ds_read_b128 v[36:39], v4 offset:3072
  ds_read_b128 v[48:51], v4 offset:4096
  ds_read_b128 v[52:55], v4 offset:5120
  ds_read_b128 v[64:67], v4 offset:6144
  ds_read_b128 v[68:71], v4 offset:7168
  ds_read_b128 v[80:83], v4 offset:8192
  ds_read_b128 v[84:87], v4 offset:9216
  ds_read_b128 v[96:99], v4 offset:10240
  ds_read_b128 v[100:103], v4 offset:11264
  ds_read_b128 v[112:115], v4 offset:12288
  ds_read_b128 v[116:119], v4 offset:13312
  s_waitcnt lgkmcnt(0)
  s_add_u32 s28, s28, 16777216
  s_addc_u32 s29, s29, 0
  s_cmp_eq_u32 s90, 0
  s_cselect_b32 s30, 67108864, 0
  s_add_u32 s28, s28, s30
  s_addc_u32 s29, s29, 0
  s_mov_b32 s30, 7340032
  s_mov_b32 s31, 0x20000
  s_add_u32 s64, s64, 25165824
  s_addc_u32 s65, s65, 0
  s_cmp_eq_u32 s90, 0
  s_cselect_b32 s66, 67108864, 0
  s_add_u32 s64, s64, s66
  s_addc_u32 s65, s65, 0
  s_mov_b32 s66, 7340032
  s_mov_b32 s67, 0x20000
  s_add_u32 s68, s68, 42991616
  s_addc_u32 s69, s69, 0
  s_mov_b32 s70, 524288
  s_mov_b32 s71, 0x20000
  s_mov_b32 s62, 3184710632
  s_mov_b32 s63, 3184710632
  s_mov_b32 s78, 1040628898
  s_mov_b32 s79, 1040629375
  s_mov_b32 s80, 3196220901
  s_mov_b32 s81, 1067829519
  s_mov_b32 s82, 1092275358
  s_mov_b32 s83, 1124867972
  s_mov_b32 s84, 1143086295
  s_lshl_b32 s59, s25, 1
  s_add_u32 s59, s59, 1
  s_add_u32 s14, s14, 4
  s_cmp_eq_u32 s24, 1
  s_cbranch_scc1 g3_kernel_epi1
  s_branch g3_kernel_epi0
g3_kernel_fin:
  s_load_dwordx2 s[96:97], s[0:1], 96
  s_cmp_lg_u32 s90, 0
  s_cselect_b32 s19, 2, 6
  s_lshl_b32 s19, s19, 15
  s_lshl_b32 s3, s12, 4
  s_add_u32 s3, s3, s13
  s_lshl_b32 s3, s3, 7
  s_add_u32 s3, s3, s19
  v_mov_b32 v2, 0
  v_mov_b32 v3, 1
  s_waitcnt lgkmcnt(0)
  s_add_u32 s96, s96, 63963136
  s_addc_u32 s97, s97, 0
  s_mov_b32 s98, 262144
  s_mov_b32 s99, 0x20000
  s_waitcnt vmcnt(0)
  s_barrier
  s_cmp_lg_u32 s14, 0
  s_cbranch_scc1 g3_kernel_nb34
  buffer_store_dword v3, v2, s[96:99], s3 offen sc1
g3_kernel_nb34:
  s_branch g4_kernel_fe
g3_kernel_end:
  s_endpgm
.p2align 6
g4_kernel_fe:
  s_load_dwordx2 s[4:5], s[0:1], 96
  s_load_dwordx2 s[8:9], s[0:1], 56
  s_cmp_lg_u32 s90, 0
  s_cselect_b32 s87, 7, 3
  s_cmp_lg_u32 s90, 0
  s_cselect_b32 s88, 1, 1
  s_cmp_lg_u32 s90, 0
  s_cselect_b32 s89, 1, 1
  s_and_b32 s3, s2, 7
  s_lshr_b32 s16, s2, 3
  s_and_b32 s12, s3, 3
  s_mul_i32 s12, s12, 4
  s_lshr_b32 s13, s3, 2
  s_mul_i32 s13, s13, 8
  s_and_b32 s3, s16, 3
  s_add_u32 s12, s12, s3
  s_lshr_b32 s16, s16, 2
  s_add_u32 s13, s13, s16
  s_mov_b32 s15, 0
  s_cmp_lt_u32 s14, 4
  s_cbranch_scc1 g4_kernel_comp
  s_sub_u32 s24, s14, 4
  s_setprio 2
  s_mul_i32 s82, s12, 458752
  s_lshr_b32 s3, s24, 1
  s_mul_i32 s3, s3, 65536
  s_add_u32 s82, s82, s3
  s_and_b32 s3, s24, 1
  s_lshl_b32 s3, s3, 10
  s_add_u32 s82, s82, s3
  s_mul_i32 s84, s24, 1024
  v_lshlrev_b32 v6, 4, v0
  v_add_u32 v6, s82, v6
  s_mul_i32 s83, s13, 524288
  s_mul_i32 s3, s24, 32768
  s_add_u32 s83, s83, s3
  s_mul_i32 s85, s24, 1024
  s_add_u32 s85, s85, 14336
  v_lshrrev_b32 v7, 3, v0
  v_lshlrev_b32 v7, 12, v7
  v_lshrrev_b32 v3, 4, v0
  v_and_b32 v3, 1, v3
  v_xor_b32 v2, v0, v3
  v_and_b32 v2, 7, v2
  v_lshlrev_b32 v2, 4, v2
  v_add_u32 v7, v7, v2
  s_lshl_b32 s3, s24, 5
  v_xor_b32 v7, s3, v7
  v_add_u32 v7, s83, v7
  s_mov_b32 s17, 0
  s_mov_b32 s18, 0
  s_mov_b32 s80, 0
  s_mul_i32 s81, s12, s88
  s_mul_i32 s3, s13, s89
  s_add_u32 s81, s81, s3
  s_mov_b32 s16, 0
  s_waitcnt lgkmcnt(0)
  s_add_u32 s4, s4, 25165824
  s_addc_u32 s5, s5, 0
  s_cmp_eq_u32 s90, 0
  s_cselect_b32 s6, 67108864, 0
  s_add_u32 s4, s4, s6
  s_addc_u32 s5, s5, 0
  s_mov_b32 s6, 7340032
  s_mov_b32 s7, 0x20000
  s_mov_b32 s10, 8388608
  s_mov_b32 s11, 0x20000
  s_add_u32 s3, s80, s81
  s_and_b32 s3, s3, s87
  s_andn2_b32 s19, s80, s87
  s_or_b32 s3, s3, s19
  s_mul_i32 s17, s3, 2048
  s_mul_i32 s18, s3, 128
  s_add_u32 s26, s15, s85
  s_mov_b32 m0, s26
  s_nop 0
  buffer_load_dwordx4 v7, s[8:11], s18 offen lds
  s_add_u32 m0, s26, 4096
  s_add_u32 s27, s18, 131072
  buffer_load_dwordx4 v7, s[8:11], s27 offen lds
  s_add_u32 m0, s26, 8192
  s_add_u32 s27, s18, 262144
  buffer_load_dwordx4 v7, s[8:11], s27 offen lds
  s_add_u32 m0, s26, 12288
  s_add_u32 s27, s18, 393216
  buffer_load_dwordx4 v7, s[8:11], s27 offen lds
  s_add_u32 s15, s15, 30720
  s_cmp_eq_u32 s15, 122880
  s_cselect_b32 s15, 0, s15
  s_add_u32 s80, s80, 1
  s_add_u32 s3, s80, s81
  s_and_b32 s3, s3, s87
  s_andn2_b32 s19, s80, s87
  s_or_b32 s3, s3, s19
  s_mul_i32 s17, s3, 2048
  s_mul_i32 s18, s3, 128
  s_add_u32 s26, s15, s85
  s_mov_b32 m0, s26
  s_nop 0
  buffer_load_dwordx4 v7, s[8:11], s18 offen lds
  s_add_u32 m0, s26, 4096
  s_add_u32 s27, s18, 131072
  buffer_load_dwordx4 v7, s[8:11], s27 offen lds
  s_add_u32 m0, s26, 8192
  s_add_u32 s27, s18, 262144
  buffer_load_dwordx4 v7, s[8:11], s27 offen lds
  s_add_u32 m0, s26, 12288
  s_add_u32 s27, s18, 393216
  buffer_load_dwordx4 v7, s[8:11], s27 offen lds
  s_add_u32 s15, s15, 30720
  s_cmp_eq_u32 s15, 122880
  s_cselect_b32 s15, 0, s15
  s_add_u32 s80, s80, 1
  s_add_u32 s3, s80, s81
  s_and_b32 s3, s3, s87
  s_andn2_b32 s19, s80, s87
  s_or_b32 s3, s3, s19
  s_mul_i32 s17, s3, 2048
  s_mul_i32 s18, s3, 128
  s_add_u32 s26, s15, s85
  s_mov_b32 m0, s26
  s_nop 0
  buffer_load_dwordx4 v7, s[8:11], s18 offen lds
  s_add_u32 m0, s26, 4096
  s_add_u32 s27, s18, 131072
  buffer_load_dwordx4 v7, s[8:11], s27 offen lds
  s_add_u32 m0, s26, 8192
  s_add_u32 s27, s18, 262144
  buffer_load_dwordx4 v7, s[8:11], s27 offen lds
  s_add_u32 m0, s26, 12288
  s_add_u32 s27, s18, 393216
  buffer_load_dwordx4 v7, s[8:11], s27 offen lds
  s_add_u32 s15, s15, 30720
  s_cmp_eq_u32 s15, 122880
  s_cselect_b32 s15, 0, s15
  s_add_u32 s80, s80, 1
  s_add_u32 s3, s80, s81
  s_and_b32 s3, s3, s87
  s_andn2_b32 s19, s80, s87
  s_or_b32 s3, s3, s19
  s_mul_i32 s17, s3, 2048
  s_mul_i32 s18, s3, 128
  s_mov_b32 s15, 0
  s_mov_b32 s17, 0
  s_mov_b32 s18, 0
  s_mov_b32 s80, 0
  s_add_u32 s3, s80, s81
  s_and_b32 s3, s3, s87
  s_andn2_b32 s19, s80, s87
  s_or_b32 s3, s3, s19
  s_mul_i32 s17, s3, 2048
  s_mul_i32 s18, s3, 128
  s_load_dwordx2 s[28:29], s[0:1], 96
  v_and_b32 v2, 15, v0
  v_lshlrev_b32 v2, 7, v2
  s_cmp_lg_u32 s90, 0
  s_cselect_b32 s32, 2, 6
  s_lshl_b32 s32, s32, 15
  s_andn2_b32 s3, s12, 0
  s_lshl_b32 s3, s3, 8
  s_lshr_b32 s3, s3, 4
  s_lshl_b32 s3, s3, 7
  s_add_u32 s32, s32, s3
  s_mov_b32 s33, 0
  s_waitcnt lgkmcnt(0)
  s_add_u32 s28, s28, 63963136
  s_addc_u32 s29, s29, 0
  s_mov_b32 s30, 262144
  s_mov_b32 s31, 0x20000
  s_cmp_lg_u32 s24, 0
  s_cbranch_scc1 g4_kernel_dd4
g4_kernel_dp3:
  buffer_load_dword v8, v2, s[28:31], s32 offen sc1
  s_add_u32 s33, s33, 1
  s_waitcnt vmcnt(0)
  v_cmp_eq_u32 vcc, -1, v8
  s_cmp_ge_u32 s33, 0x8000
  s_cbranch_vccz g4_kernel_dd4
  s_cbranch_scc0 g4_kernel_dp3
g4_kernel_dd4:
  s_barrier
  s_add_u32 s26, s15, s84
  s_mov_b32 m0, s26
  s_nop 0
  buffer_load_dwordx4 v6, s[4:7], s17 offen lds
  s_add_u32 m0, s26, 4096
  s_add_u32 s27, s17, 131072
  buffer_load_dwordx4 v6, s[4:7], s27 offen lds
  s_add_u32 m0, s26, 8192
  s_add_u32 s27, s17, 262144
  buffer_load_dwordx4 v6, s[4:7], s27 offen lds
  s_cmp_ge_u32 s24, 2
  s_cbranch_scc1 g4_kernel_ldskip5
  s_add_u32 m0, s26, 12288
  s_add_u32 s27, s17, 393216
  buffer_load_dwordx4 v6, s[4:7], s27 offen lds
g4_kernel_ldskip5:
  s_add_u32 s15, s15, 30720
  s_cmp_eq_u32 s15, 122880
  s_cselect_b32 s15, 0, s15
  s_add_u32 s80, s80, 1
  s_add_u32 s3, s80, s81
  s_and_b32 s3, s3, s87
  s_andn2_b32 s19, s80, s87
  s_or_b32 s3, s3, s19
  s_mul_i32 s17, s3, 2048
  s_mul_i32 s18, s3, 128
  s_add_u32 s26, s15, s84
  s_mov_b32 m0, s26
  s_nop 0
  buffer_load_dwordx4 v6, s[4:7], s17 offen lds
  s_add_u32 m0, s26, 4096
  s_add_u32 s27, s17, 131072
  buffer_load_dwordx4 v6, s[4:7], s27 offen lds
  s_add_u32 m0, s26, 8192
  s_add_u32 s27, s17, 262144
  buffer_load_dwordx4 v6, s[4:7], s27 offen lds
  s_cmp_ge_u32 s24, 2
  s_cbranch_scc1 g4_kernel_ldskip6
  s_add_u32 m0, s26, 12288
  s_add_u32 s27, s17, 393216
  buffer_load_dwordx4 v6, s[4:7], s27 offen lds
g4_kernel_ldskip6:
  s_add_u32 s15, s15, 30720
  s_cmp_eq_u32 s15, 122880
  s_cselect_b32 s15, 0, s15
  s_add_u32 s80, s80, 1
  s_add_u32 s3, s80, s81
  s_and_b32 s3, s3, s87
  s_andn2_b32 s19, s80, s87
  s_or_b32 s3, s3, s19
  s_mul_i32 s17, s3, 2048
  s_mul_i32 s18, s3, 128
  s_add_u32 s26, s15, s84
  s_mov_b32 m0, s26
  s_nop 0
  buffer_load_dwordx4 v6, s[4:7], s17 offen lds
  s_add_u32 m0, s26, 4096
  s_add_u32 s27, s17, 131072
  buffer_load_dwordx4 v6, s[4:7], s27 offen lds
  s_add_u32 m0, s26, 8192
  s_add_u32 s27, s17, 262144
  buffer_load_dwordx4 v6, s[4:7], s27 offen lds
  s_cmp_ge_u32 s24, 2
  s_cbranch_scc1 g4_kernel_ldskip7
  s_add_u32 m0, s26, 12288
  s_add_u32 s27, s17, 393216
  buffer_load_dwordx4 v6, s[4:7], s27 offen lds
g4_kernel_ldskip7:
  s_add_u32 s15, s15, 30720
  s_cmp_eq_u32 s15, 122880
  s_cselect_b32 s15, 0, s15
  s_add_u32 s80, s80, 1
  s_add_u32 s3, s80, s81
  s_and_b32 s3, s3, s87
  s_andn2_b32 s19, s80, s87
  s_or_b32 s3, s3, s19
  s_mul_i32 s17, s3, 2048
  s_mul_i32 s18, s3, 128
  s_waitcnt vmcnt(6)
  s_barrier
  s_add_u32 s26, s15, s84
  s_mov_b32 m0, s26
  s_nop 0
  buffer_load_dwordx4 v6, s[4:7], s17 offen lds
  s_add_u32 m0, s26, 4096
  s_add_u32 s27, s17, 131072
  buffer_load_dwordx4 v6, s[4:7], s27 offen lds
  s_add_u32 m0, s26, 8192
  s_add_u32 s27, s17, 262144
  buffer_load_dwordx4 v6, s[4:7], s27 offen lds
  s_cmp_ge_u32 s24, 2
  s_cbranch_scc1 g4_kernel_ldskip8
  s_add_u32 m0, s26, 12288
  s_add_u32 s27, s17, 393216
  buffer_load_dwordx4 v6, s[4:7], s27 offen lds
g4_kernel_ldskip8:
  s_add_u32 s26, s15, s85
  s_mov_b32 m0, s26
  s_nop 0
  buffer_load_dwordx4 v7, s[8:11], s18 offen lds
  s_add_u32 m0, s26, 4096
  s_add_u32 s27, s18, 131072
  buffer_load_dwordx4 v7, s[8:11], s27 offen lds
  s_add_u32 m0, s26, 8192
  s_add_u32 s27, s18, 262144
  buffer_load_dwordx4 v7, s[8:11], s27 offen lds
  s_add_u32 m0, s26, 12288
  s_add_u32 s27, s18, 393216
  buffer_load_dwordx4 v7, s[8:11], s27 offen lds
  s_add_u32 s15, s15, 30720
  s_cmp_eq_u32 s15, 122880
  s_cselect_b32 s15, 0, s15
  s_add_u32 s80, s80, 1
  s_add_u32 s3, s80, s81
  s_and_b32 s3, s3, s87
  s_andn2_b32 s19, s80, s87
  s_or_b32 s3, s3, s19
  s_mul_i32 s17, s3, 2048
  s_mul_i32 s18, s3, 128
  s_waitcnt vmcnt(10)
  s_barrier
  s_add_u32 s26, s15, s84
  s_mov_b32 m0, s26
  s_nop 0
  buffer_load_dwordx4 v6, s[4:7], s17 offen lds
  s_add_u32 m0, s26, 4096
  s_add_u32 s27, s17, 131072
  buffer_load_dwordx4 v6, s[4:7], s27 offen lds
  s_add_u32 m0, s26, 8192
  s_add_u32 s27, s17, 262144
  buffer_load_dwordx4 v6, s[4:7], s27 offen lds
  s_cmp_ge_u32 s24, 2
  s_cbranch_scc1 g4_kernel_ldskip9
  s_add_u32 m0, s26, 12288
  s_add_u32 s27, s17, 393216
  buffer_load_dwordx4 v6, s[4:7], s27 offen lds
g4_kernel_ldskip9:
  s_add_u32 s26, s15, s85
  s_mov_b32 m0, s26
  s_nop 0
  buffer_load_dwordx4 v7, s[8:11], s18 offen lds
  s_add_u32 m0, s26, 4096
  s_add_u32 s27, s18, 131072
  buffer_load_dwordx4 v7, s[8:11], s27 offen lds
  s_add_u32 m0, s26, 8192
  s_add_u32 s27, s18, 262144
  buffer_load_dwordx4 v7, s[8:11], s27 offen lds
  s_add_u32 m0, s26, 12288
  s_add_u32 s27, s18, 393216
  buffer_load_dwordx4 v7, s[8:11], s27 offen lds
  s_add_u32 s15, s15, 30720
  s_cmp_eq_u32 s15, 122880
  s_cselect_b32 s15, 0, s15
  s_add_u32 s80, s80, 1
  s_add_u32 s3, s80, s81
  s_and_b32 s3, s3, s87
  s_andn2_b32 s19, s80, s87
  s_or_b32 s3, s3, s19
  s_mul_i32 s17, s3, 2048
  s_mul_i32 s18, s3, 128
  s_mov_b32 s16, 5
g4_kernel_ldloop1:
  s_waitcnt vmcnt(14)
  s_barrier
g4_kernel_ldissue2:
  s_add_u32 s26, s15, s84
  s_mov_b32 m0, s26
  s_nop 0
  buffer_load_dwordx4 v6, s[4:7], s17 offen lds
  s_add_u32 m0, s26, 4096
  s_add_u32 s27, s17, 131072
  buffer_load_dwordx4 v6, s[4:7], s27 offen lds
  s_add_u32 m0, s26, 8192
  s_add_u32 s27, s17, 262144
  buffer_load_dwordx4 v6, s[4:7], s27 offen lds
  s_cmp_ge_u32 s24, 2
  s_cbranch_scc1 g4_kernel_ldskip10
  s_add_u32 m0, s26, 12288
  s_add_u32 s27, s17, 393216
  buffer_load_dwordx4 v6, s[4:7], s27 offen lds
g4_kernel_ldskip10:
  s_add_u32 s26, s15, s85
  s_mov_b32 m0, s26
  s_nop 0
  buffer_load_dwordx4 v7, s[8:11], s18 offen lds
  s_add_u32 m0, s26, 4096
  s_add_u32 s27, s18, 131072
  buffer_load_dwordx4 v7, s[8:11], s27 offen lds
  s_add_u32 m0, s26, 8192
  s_add_u32 s27, s18, 262144
  buffer_load_dwordx4 v7, s[8:11], s27 offen lds
  s_add_u32 m0, s26, 12288
  s_add_u32 s27, s18, 393216
  buffer_load_dwordx4 v7, s[8:11], s27 offen lds
  s_add_u32 s15, s15, 30720
  s_cmp_eq_u32 s15, 122880
  s_cselect_b32 s15, 0, s15
  s_add_u32 s80, s80, 1
  s_add_u32 s3, s80, s81
  s_and_b32 s3, s3, s87
  s_andn2_b32 s19, s80, s87
  s_or_b32 s3, s3, s19
  s_mul_i32 s17, s3, 2048
  s_mul_i32 s18, s3, 128
  s_add_u32 s16, s16, 1
  s_cmp_lt_u32 s16, 32
  s_cbranch_scc1 g4_kernel_ldloop1
  s_waitcnt vmcnt(14)
  s_barrier
  s_waitcnt vmcnt(7)
  s_barrier
  s_waitcnt vmcnt(0)
  s_barrier
  s_barrier
  s_lshl_b32 s86, s13, 4
  s_add_u32 s86, s86, s12
  s_lshl_b32 s86, s86, 7
  s_cmp_lg_u32 s90, 0
  s_cbranch_scc1 g5_kernel_fe
  s_branch g5f_kernel_fe
g4_kernel_comp:
  s_load_dwordx2 s[28:29], s[0:1], 96
  s_load_dwordx2 s[32:33], s[0:1], 96
  s_load_dwordx2 s[36:37], s[0:1], 64
  s_and_b32 s24, s14, 0
  s_lshr_b32 s25, s14, 0
  v_lshlrev_b32 v6, 4, v0
  s_mul_i32 s3, s24, 14336
  v_add_u32 v6, s3, v6
  v_mov_b32 v7, v6
  v_mov_b32 v8, v6
  v_and_b32 v9, 15, v0
  v_and_b32 v2, 15, v0
  v_and_b32 v2, 12, v2
  v_add_u32 v9, v9, v2
  v_lshlrev_b32 v9, 7, v9
  v_lshrrev_b32 v2, 4, v0
  v_and_b32 v3, 15, v0
  v_and_b32 v4, 15, v0
  v_and_b32 v4, 12, v4
  v_add_u32 v3, v3, v4
  v_lshrrev_b32 v3, 1, v3
  v_and_b32 v3, 1, v3
  v_and_b32 v4, 15, v0
  v_and_b32 v5, 15, v0
  v_and_b32 v5, 12, v5
  v_add_u32 v4, v4, v5
  v_lshrrev_b32 v4, 2, v4
  v_and_b32 v4, 6, v4
  v_add_u32 v3, v3, v4
  v_xor_b32 v2, v2, v3
  v_and_b32 v2, 7, v2
  v_lshlrev_b32 v2, 4, v2
  v_add_u32 v9, v9, v2
  s_mul_i32 s3, s25, 4096
  s_add_u32 s3, s3, 14336
  v_add_u32 v9, s3, v9
  v_mov_b32 v10, v9
  v_and_b32 v11, 15, v0
  v_and_b32 v2, 15, v0
  v_and_b32 v2, 12, v2
  v_add_u32 v11, v11, v2
  v_lshlrev_b32 v11, 7, v11
  v_lshrrev_b32 v2, 4, v0
  v_xor_b32 v2, 4, v2
  v_and_b32 v3, 15, v0
  v_and_b32 v4, 15, v0
  v_and_b32 v4, 12, v4
  v_add_u32 v3, v3, v4
  v_lshrrev_b32 v3, 1, v3
  v_and_b32 v3, 1, v3
  v_and_b32 v4, 15, v0
  v_and_b32 v5, 15, v0
  v_and_b32 v5, 12, v5
  v_add_u32 v4, v4, v5
  v_lshrrev_b32 v4, 2, v4
  v_and_b32 v4, 6, v4
  v_add_u32 v3, v3, v4
  v_xor_b32 v2, v2, v3
  v_and_b32 v2, 7, v2
  v_lshlrev_b32 v2, 4, v2
  v_add_u32 v11, v11, v2
  s_mul_i32 s3, s25, 4096
  s_add_u32 s3, s3, 14336
  v_add_u32 v11, s3, v11
  v_mov_b32 v12, v11
  s_waitcnt lgkmcnt(0)
  s_add_u32 s28, s28, 33554432
  s_addc_u32 s29, s29, 0
  s_cmp_eq_u32 s90, 0
  s_cselect_b32 s30, 67108864, 0
  s_add_u32 s28, s28, s30
  s_addc_u32 s29, s29, 0
  s_mov_b32 s30, 7340032
  s_mov_b32 s31, 0x20000
  s_add_u32 s32, s32, 16777216
  s_addc_u32 s33, s33, 0
  s_cmp_eq_u32 s90, 0
  s_cselect_b32 s34, 67108864, 0
  s_add_u32 s32, s32, s34
  s_addc_u32 s33, s33, 0
  s_mov_b32 s34, 7340032
  s_mov_b32 s35, 0x20000
  s_mov_b32 s38, 4096
  s_mov_b32 s39, 0x20000
  s_mul_i32 s57, s13, 4
  s_add_u32 s57, s57, s25
  s_mul_i32 s56, s12, 7
  s_mul_i32 s19, s24, 7
  s_add_u32 s56, s56, s19
  s_waitcnt lgkmcnt(0)
  s_barrier
  s_barrier
  ds_read_b128 v[72:75], v7 offset:0
  ds_read_b128 v[100:103], v10 offset:0
  ds_read_b128 v[76:79], v7 offset:2048
  ds_read_b128 v[104:107], v10 offset:512
  ds_read_b128 v[80:83], v7 offset:4096
  ds_read_b128 v[84:87], v7 offset:6144
  ds_read_b128 v[88:91], v7 offset:8192
  ds_read_b128 v[92:95], v7 offset:10240
  ds_read_b128 v[96:99], v7 offset:12288
  s_waitcnt lgkmcnt(7)
  v_mfma_f32_16x16x32_bf16 v[16:19], v[72:75], v[100:103], 0
  ds_read_b128 v[108:111], v8 offset:1024
  s_waitcnt lgkmcnt(6)
  v_mfma_f32_16x16x32_bf16 v[20:23], v[72:75], v[104:107], 0
  ds_read_b128 v[136:139], v12 offset:0
  v_mfma_f32_16x16x32_bf16 v[24:27], v[76:79], v[100:103], 0
  ds_read_b128 v[112:115], v8 offset:3072
  v_mfma_f32_16x16x32_bf16 v[28:31], v[76:79], v[104:107], 0
  ds_read_b128 v[140:143], v12 offset:512
  s_waitcnt lgkmcnt(8)
  v_mfma_f32_16x16x32_bf16 v[32:35], v[80:83], v[100:103], 0
  ds_read_b128 v[116:119], v8 offset:5120
  v_mfma_f32_16x16x32_bf16 v[36:39], v[80:83], v[104:107], 0
  ds_read_b128 v[120:123], v8 offset:7168
  s_waitcnt lgkmcnt(9)
  v_mfma_f32_16x16x32_bf16 v[40:43], v[84:87], v[100:103], 0
  ds_read_b128 v[124:127], v8 offset:9216
  v_mfma_f32_16x16x32_bf16 v[44:47], v[84:87], v[104:107], 0
  ds_read_b128 v[128:131], v8 offset:11264
  s_waitcnt lgkmcnt(10)
  v_mfma_f32_16x16x32_bf16 v[48:51], v[88:91], v[100:103], 0
  ds_read_b128 v[132:135], v8 offset:13312
  v_mfma_f32_16x16x32_bf16 v[52:55], v[88:91], v[104:107], 0
  s_add_u32 s15, s15, 30720
  s_cmp_ge_u32 s15, 122880
  s_cselect_b32 s3, 122880, 0
  s_sub_u32 s15, s15, s3
  s_waitcnt lgkmcnt(10)
  v_mfma_f32_16x16x32_bf16 v[56:59], v[92:95], v[100:103], 0
  v_add_u32 v7, s15, v6
  v_mfma_f32_16x16x32_bf16 v[60:63], v[92:95], v[104:107], 0
  v_add_u32 v10, s15, v9
  s_waitcnt lgkmcnt(9)
  v_mfma_f32_16x16x32_bf16 v[64:67], v[96:99], v[100:103], 0
  v_mfma_f32_16x16x32_bf16 v[68:71], v[96:99], v[104:107], 0
  s_waitcnt lgkmcnt(7)
  v_mfma_f32_16x16x32_bf16 v[16:19], v[108:111], v[136:139], v[16:19]
  v_add_u32 v8, s15, v6
  s_waitcnt lgkmcnt(5)
  v_mfma_f32_16x16x32_bf16 v[20:23], v[108:111], v[140:143], v[20:23]
  v_add_u32 v12, s15, v11
  s_waitcnt lgkmcnt(0)
  s_barrier
  v_mfma_f32_16x16x32_bf16 v[24:27], v[112:115], v[136:139], v[24:27]
  ds_read_b128 v[72:75], v7 offset:0
  v_mfma_f32_16x16x32_bf16 v[28:31], v[112:115], v[140:143], v[28:31]
  ds_read_b128 v[100:103], v10 offset:0
  v_mfma_f32_16x16x32_bf16 v[32:35], v[116:119], v[136:139], v[32:35]
  ds_read_b128 v[76:79], v7 offset:2048
  v_mfma_f32_16x16x32_bf16 v[36:39], v[116:119], v[140:143], v[36:39]
  ds_read_b128 v[104:107], v10 offset:512
  v_mfma_f32_16x16x32_bf16 v[40:43], v[120:123], v[136:139], v[40:43]
  ds_read_b128 v[80:83], v7 offset:4096
  v_mfma_f32_16x16x32_bf16 v[44:47], v[120:123], v[140:143], v[44:47]
  ds_read_b128 v[84:87], v7 offset:6144
  v_mfma_f32_16x16x32_bf16 v[48:51], v[124:127], v[136:139], v[48:51]
  ds_read_b128 v[88:91], v7 offset:8192
  v_mfma_f32_16x16x32_bf16 v[52:55], v[124:127], v[140:143], v[52:55]
  ds_read_b128 v[92:95], v7 offset:10240
  v_mfma_f32_16x16x32_bf16 v[56:59], v[128:131], v[136:139], v[56:59]
  ds_read_b128 v[96:99], v7 offset:12288
  v_mfma_f32_16x16x32_bf16 v[60:63], v[128:131], v[140:143], v[60:63]
  v_mfma_f32_16x16x32_bf16 v[64:67], v[132:135], v[136:139], v[64:67]
  v_mfma_f32_16x16x32_bf16 v[68:71], v[132:135], v[140:143], v[68:71]
  s_mov_b32 s16, 30
  .p2align 3
g4_kernel_cloop11:
  s_waitcnt lgkmcnt(7)
  v_mfma_f32_16x16x32_bf16 v[16:19], v[72:75], v[100:103], v[16:19]
  ds_read_b128 v[108:111], v8 offset:1024
  s_waitcnt lgkmcnt(6)
  v_mfma_f32_16x16x32_bf16 v[20:23], v[72:75], v[104:107], v[20:23]
  ds_read_b128 v[136:139], v12 offset:0
  v_mfma_f32_16x16x32_bf16 v[24:27], v[76:79], v[100:103], v[24:27]
  ds_read_b128 v[112:115], v8 offset:3072
  v_mfma_f32_16x16x32_bf16 v[28:31], v[76:79], v[104:107], v[28:31]
  ds_read_b128 v[140:143], v12 offset:512
  s_waitcnt lgkmcnt(8)
  v_mfma_f32_16x16x32_bf16 v[32:35], v[80:83], v[100:103], v[32:35]
  ds_read_b128 v[116:119], v8 offset:5120
  v_mfma_f32_16x16x32_bf16 v[36:39], v[80:83], v[104:107], v[36:39]
  ds_read_b128 v[120:123], v8 offset:7168
  s_waitcnt lgkmcnt(9)
  v_mfma_f32_16x16x32_bf16 v[40:43], v[84:87], v[100:103], v[40:43]
  ds_read_b128 v[124:127], v8 offset:9216
  v_mfma_f32_16x16x32_bf16 v[44:47], v[84:87], v[104:107], v[44:47]
  ds_read_b128 v[128:131], v8 offset:11264
  s_waitcnt lgkmcnt(10)
  v_mfma_f32_16x16x32_bf16 v[48:51], v[88:91], v[100:103], v[48:51]
  ds_read_b128 v[132:135], v8 offset:13312
  v_mfma_f32_16x16x32_bf16 v[52:55], v[88:91], v[104:107], v[52:55]
  s_add_u32 s15, s15, 30720
  s_cmp_ge_u32 s15, 122880
  s_cselect_b32 s3, 122880, 0
  s_sub_u32 s15, s15, s3
  s_waitcnt lgkmcnt(10)
  v_mfma_f32_16x16x32_bf16 v[56:59], v[92:95], v[100:103], v[56:59]
  v_add_u32 v7, s15, v6
  v_mfma_f32_16x16x32_bf16 v[60:63], v[92:95], v[104:107], v[60:63]
  v_add_u32 v10, s15, v9
  s_waitcnt lgkmcnt(9)
  v_mfma_f32_16x16x32_bf16 v[64:67], v[96:99], v[100:103], v[64:67]
  v_mfma_f32_16x16x32_bf16 v[68:71], v[96:99], v[104:107], v[68:71]
  s_waitcnt lgkmcnt(7)
  v_mfma_f32_16x16x32_bf16 v[16:19], v[108:111], v[136:139], v[16:19]
  v_add_u32 v8, s15, v6
  s_waitcnt lgkmcnt(5)
  v_mfma_f32_16x16x32_bf16 v[20:23], v[108:111], v[140:143], v[20:23]
  v_add_u32 v12, s15, v11
  s_waitcnt lgkmcnt(0)
  s_barrier
  v_mfma_f32_16x16x32_bf16 v[24:27], v[112:115], v[136:139], v[24:27]
  ds_read_b128 v[72:75], v7 offset:0
  v_mfma_f32_16x16x32_bf16 v[28:31], v[112:115], v[140:143], v[28:31]
  ds_read_b128 v[100:103], v10 offset:0
  v_mfma_f32_16x16x32_bf16 v[32:35], v[116:119], v[136:139], v[32:35]
  ds_read_b128 v[76:79], v7 offset:2048
  v_mfma_f32_16x16x32_bf16 v[36:39], v[116:119], v[140:143], v[36:39]
  ds_read_b128 v[104:107], v10 offset:512
  v_mfma_f32_16x16x32_bf16 v[40:43], v[120:123], v[136:139], v[40:43]
  ds_read_b128 v[80:83], v7 offset:4096
  v_mfma_f32_16x16x32_bf16 v[44:47], v[120:123], v[140:143], v[44:47]
  ds_read_b128 v[84:87], v7 offset:6144
  v_mfma_f32_16x16x32_bf16 v[48:51], v[124:127], v[136:139], v[48:51]
  ds_read_b128 v[88:91], v7 offset:8192
  v_mfma_f32_16x16x32_bf16 v[52:55], v[124:127], v[140:143], v[52:55]
  ds_read_b128 v[92:95], v7 offset:10240
  v_mfma_f32_16x16x32_bf16 v[56:59], v[128:131], v[136:139], v[56:59]
  ds_read_b128 v[96:99], v7 offset:12288
  v_mfma_f32_16x16x32_bf16 v[60:63], v[128:131], v[140:143], v[60:63]
  v_mfma_f32_16x16x32_bf16 v[64:67], v[132:135], v[136:139], v[64:67]
  v_mfma_f32_16x16x32_bf16 v[68:71], v[132:135], v[140:143], v[68:71]
  s_cmp_lg_u32 s16, 3
  s_cbranch_scc1 g4_kernel_late12
  v_and_b32 v2, 15, v0
  v_and_b32 v3, 15, v0
  v_and_b32 v3, 12, v3
  v_add_u32 v2, v2, v3
  v_lshlrev_b32 v2, 1, v2
  s_mul_i32 s3, s13, 256
  s_lshl_b32 s19, s25, 6
  s_add_u32 s3, s3, s19
  buffer_load_ushort v172, v2, s[36:39], s3 offen offset:0
  buffer_load_ushort v173, v2, s[36:39], s3 offen offset:8
g4_kernel_late12:
  s_sub_u32 s16, s16, 1
  s_cmp_lg_u32 s16, 0
  s_cbranch_scc1 g4_kernel_cloop11
  s_waitcnt lgkmcnt(7)
  v_mfma_f32_16x16x32_bf16 v[16:19], v[72:75], v[100:103], v[16:19]
  ds_read_b128 v[108:111], v8 offset:1024
  s_waitcnt lgkmcnt(6)
  v_mfma_f32_16x16x32_bf16 v[20:23], v[72:75], v[104:107], v[20:23]
  ds_read_b128 v[136:139], v12 offset:0
  v_mfma_f32_16x16x32_bf16 v[24:27], v[76:79], v[100:103], v[24:27]
  ds_read_b128 v[112:115], v8 offset:3072
  v_mfma_f32_16x16x32_bf16 v[28:31], v[76:79], v[104:107], v[28:31]
  ds_read_b128 v[140:143], v12 offset:512
  s_waitcnt lgkmcnt(8)
  v_mfma_f32_16x16x32_bf16 v[32:35], v[80:83], v[100:103], v[32:35]
  ds_read_b128 v[116:119], v8 offset:5120
  v_mfma_f32_16x16x32_bf16 v[36:39], v[80:83], v[104:107], v[36:39]
  ds_read_b128 v[120:123], v8 offset:7168
  s_waitcnt lgkmcnt(9)
  v_mfma_f32_16x16x32_bf16 v[40:43], v[84:87], v[100:103], v[40:43]
  ds_read_b128 v[124:127], v8 offset:9216
  v_mfma_f32_16x16x32_bf16 v[44:47], v[84:87], v[104:107], v[44:47]
  ds_read_b128 v[128:131], v8 offset:11264
  s_waitcnt lgkmcnt(10)
  v_mfma_f32_16x16x32_bf16 v[48:51], v[88:91], v[100:103], v[48:51]
  ds_read_b128 v[132:135], v8 offset:13312
  v_mfma_f32_16x16x32_bf16 v[52:55], v[88:91], v[104:107], v[52:55]
  s_waitcnt lgkmcnt(10)
  v_mfma_f32_16x16x32_bf16 v[56:59], v[92:95], v[100:103], v[56:59]
  v_mfma_f32_16x16x32_bf16 v[60:63], v[92:95], v[104:107], v[60:63]
  s_waitcnt lgkmcnt(9)
  v_mfma_f32_16x16x32_bf16 v[64:67], v[96:99], v[100:103], v[64:67]
  v_mfma_f32_16x16x32_bf16 v[68:71], v[96:99], v[104:107], v[68:71]
  s_waitcnt lgkmcnt(7)
  v_mfma_f32_16x16x32_bf16 v[16:19], v[108:111], v[136:139], v[16:19]
  s_waitcnt lgkmcnt(5)
  v_mfma_f32_16x16x32_bf16 v[20:23], v[108:111], v[140:143], v[20:23]
  v_mfma_f32_16x16x32_bf16 v[24:27], v[112:115], v[136:139], v[24:27]
  v_mfma_f32_16x16x32_bf16 v[28:31], v[112:115], v[140:143], v[28:31]
  s_waitcnt lgkmcnt(4)
  v_mfma_f32_16x16x32_bf16 v[32:35], v[116:119], v[136:139], v[32:35]
  v_mfma_f32_16x16x32_bf16 v[36:39], v[116:119], v[140:143], v[36:39]
  s_waitcnt lgkmcnt(3)
  v_mfma_f32_16x16x32_bf16 v[40:43], v[120:123], v[136:139], v[40:43]
  v_mfma_f32_16x16x32_bf16 v[44:47], v[120:123], v[140:143], v[44:47]
  s_waitcnt lgkmcnt(2)
  v_mfma_f32_16x16x32_bf16 v[48:51], v[124:127], v[136:139], v[48:51]
  v_mfma_f32_16x16x32_bf16 v[52:55], v[124:127], v[140:143], v[52:55]
  s_waitcnt lgkmcnt(1)
  v_mfma_f32_16x16x32_bf16 v[56:59], v[128:131], v[136:139], v[56:59]
  v_mfma_f32_16x16x32_bf16 v[60:63], v[128:131], v[140:143], v[60:63]
  s_waitcnt lgkmcnt(0)
  v_mfma_f32_16x16x32_bf16 v[64:67], v[132:135], v[136:139], v[64:67]
  v_mfma_f32_16x16x32_bf16 v[68:71], v[132:135], v[140:143], v[68:71]
  s_barrier
  v_lshlrev_b32 v2, 4, v0
  s_mul_i32 s58, s57, 114688
  s_lshr_b32 s19, s56, 1
  s_lshl_b32 s19, s19, 10
  s_add_u32 s26, s58, s19
  s_add_u32 s27, s26, 57344
  s_mov_b32 s59, 0xffff0000
  s_mul_i32 s19, s25, 7168
  s_add_u32 s19, s19, 135168
  v_add_u32 v3, s19, v2
  ds_read_b128 v[144:147], v3 offset:0
  ds_read_b128 v[148:151], v3 offset:1024
  ds_read_b128 v[152:155], v3 offset:2048
  ds_read_b128 v[156:159], v3 offset:3072
  ds_read_b128 v[160:163], v3 offset:4096
  ds_read_b128 v[164:167], v3 offset:5120
  ds_read_b128 v[168:171], v3 offset:6144
  s_waitcnt vmcnt(0) lgkmcnt(0)
  v_lshlrev_b32 v172, 16, v172
  v_lshlrev_b32 v173, 16, v173
  v_lshrrev_b32 v3, 4, v0
  v_and_b32 v3, 1, v3
  v_mul_u32_u24 v3, 57344, v3
  v_lshrrev_b32 v4, 4, v0
  v_lshrrev_b32 v4, 1, v4
  v_lshlrev_b32 v4, 8, v4
  v_add_u32 v3, v3, v4
  v_and_b32 v4, 15, v0
  v_lshlrev_b32 v4, 4, v4
  v_add_u32 v3, v3, v4
  s_and_b32 s3, s56, 1
  s_cbranch_scc1 g4_kernel_odd13
  v_lshlrev_b32 v72, 16, v144
  v_and_b32 v73, s59, v144
  v_pk_add_f32 v[16:17], v[16:17], v[172:173] op_sel:[0,0] op_sel_hi:[1,0]
  v_pk_mul_f32 v[16:17], v[16:17], v[72:73] op_sel:[0,0] op_sel_hi:[1,1]
  v_cvt_pk_bf16_f32 v108, v16, v17
  v_lshlrev_b32 v74, 16, v145
  v_and_b32 v75, s59, v145
  v_pk_add_f32 v[18:19], v[18:19], v[172:173] op_sel:[0,0] op_sel_hi:[1,0]
  v_pk_mul_f32 v[18:19], v[18:19], v[74:75] op_sel:[0,0] op_sel_hi:[1,1]
  v_cvt_pk_bf16_f32 v109, v18, v19
  v_lshlrev_b32 v76, 16, v148
  v_and_b32 v77, s59, v148
  v_pk_add_f32 v[24:25], v[24:25], v[172:173] op_sel:[0,0] op_sel_hi:[1,0]
  v_pk_mul_f32 v[24:25], v[24:25], v[76:77] op_sel:[0,0] op_sel_hi:[1,1]
  v_cvt_pk_bf16_f32 v110, v24, v25
  v_lshlrev_b32 v78, 16, v149
  v_and_b32 v79, s59, v149
  v_pk_add_f32 v[26:27], v[26:27], v[172:173] op_sel:[0,0] op_sel_hi:[1,0]
  v_pk_mul_f32 v[26:27], v[26:27], v[78:79] op_sel:[0,0] op_sel_hi:[1,1]
  v_cvt_pk_bf16_f32 v111, v26, v27
  v_permlane32_swap_b32 v108, v110
  s_nop 0
  v_permlane32_swap_b32 v109, v111
  v_permlane16_swap_b32 v108, v110
  s_nop 0
  v_permlane16_swap_b32 v109, v111
  buffer_store_dwordx4 v[108:111], v2, s[28:31], s26 offen offset:0 sc0 sc1
  v_lshlrev_b32 v72, 16, v146
  v_and_b32 v73, s59, v146
  v_pk_add_f32 v[20:21], v[20:21], v[172:173] op_sel:[0,1] op_sel_hi:[1,1]
  v_pk_mul_f32 v[20:21], v[20:21], v[72:73] op_sel:[0,0] op_sel_hi:[1,1]
  v_cvt_pk_bf16_f32 v112, v20, v21
  v_lshlrev_b32 v74, 16, v147
  v_and_b32 v75, s59, v147
  v_pk_add_f32 v[22:23], v[22:23], v[172:173] op_sel:[0,1] op_sel_hi:[1,1]
  v_pk_mul_f32 v[22:23], v[22:23], v[74:75] op_sel:[0,0] op_sel_hi:[1,1]
  v_cvt_pk_bf16_f32 v113, v22, v23
  v_lshlrev_b32 v76, 16, v150
  v_and_b32 v77, s59, v150
  v_pk_add_f32 v[28:29], v[28:29], v[172:173] op_sel:[0,1] op_sel_hi:[1,1]
  v_pk_mul_f32 v[28:29], v[28:29], v[76:77] op_sel:[0,0] op_sel_hi:[1,1]
  v_cvt_pk_bf16_f32 v114, v28, v29
  v_lshlrev_b32 v78, 16, v151
  v_and_b32 v79, s59, v151
  v_pk_add_f32 v[30:31], v[30:31], v[172:173] op_sel:[0,1] op_sel_hi:[1,1]
  v_pk_mul_f32 v[30:31], v[30:31], v[78:79] op_sel:[0,0] op_sel_hi:[1,1]
  v_cvt_pk_bf16_f32 v115, v30, v31
  v_permlane32_swap_b32 v112, v114
  s_nop 0
  v_permlane32_swap_b32 v113, v115
  v_permlane16_swap_b32 v112, v114
  s_nop 0
  v_permlane16_swap_b32 v113, v115
  buffer_store_dwordx4 v[112:115], v2, s[28:31], s27 offen offset:0 sc0 sc1
  v_lshlrev_b32 v72, 16, v152
  v_and_b32 v73, s59, v152
  v_pk_add_f32 v[32:33], v[32:33], v[172:173] op_sel:[0,0] op_sel_hi:[1,0]
  v_pk_mul_f32 v[32:33], v[32:33], v[72:73] op_sel:[0,0] op_sel_hi:[1,1]
  v_cvt_pk_bf16_f32 v116, v32, v33
  v_lshlrev_b32 v74, 16, v153
  v_and_b32 v75, s59, v153
  v_pk_add_f32 v[34:35], v[34:35], v[172:173] op_sel:[0,0] op_sel_hi:[1,0]
  v_pk_mul_f32 v[34:35], v[34:35], v[74:75] op_sel:[0,0] op_sel_hi:[1,1]
  v_cvt_pk_bf16_f32 v117, v34, v35
  v_lshlrev_b32 v76, 16, v156
  v_and_b32 v77, s59, v156
  v_pk_add_f32 v[40:41], v[40:41], v[172:173] op_sel:[0,0] op_sel_hi:[1,0]
  v_pk_mul_f32 v[40:41], v[40:41], v[76:77] op_sel:[0,0] op_sel_hi:[1,1]
  v_cvt_pk_bf16_f32 v118, v40, v41
  v_lshlrev_b32 v78, 16, v157
  v_and_b32 v79, s59, v157
  v_pk_add_f32 v[42:43], v[42:43], v[172:173] op_sel:[0,0] op_sel_hi:[1,0]
  v_pk_mul_f32 v[42:43], v[42:43], v[78:79] op_sel:[0,0] op_sel_hi:[1,1]
  v_cvt_pk_bf16_f32 v119, v42, v43
  v_permlane32_swap_b32 v116, v118
  s_nop 0
  v_permlane32_swap_b32 v117, v119
  v_permlane16_swap_b32 v116, v118
  s_nop 0
  v_permlane16_swap_b32 v117, v119
  buffer_store_dwordx4 v[116:119], v2, s[28:31], s26 offen offset:1024 sc0 sc1
  v_lshlrev_b32 v72, 16, v154
  v_and_b32 v73, s59, v154
  v_pk_add_f32 v[36:37], v[36:37], v[172:173] op_sel:[0,1] op_sel_hi:[1,1]
  v_pk_mul_f32 v[36:37], v[36:37], v[72:73] op_sel:[0,0] op_sel_hi:[1,1]
  v_cvt_pk_bf16_f32 v120, v36, v37
  v_lshlrev_b32 v74, 16, v155
  v_and_b32 v75, s59, v155
  v_pk_add_f32 v[38:39], v[38:39], v[172:173] op_sel:[0,1] op_sel_hi:[1,1]
  v_pk_mul_f32 v[38:39], v[38:39], v[74:75] op_sel:[0,0] op_sel_hi:[1,1]
  v_cvt_pk_bf16_f32 v121, v38, v39
  v_lshlrev_b32 v76, 16, v158
  v_and_b32 v77, s59, v158
  v_pk_add_f32 v[44:45], v[44:45], v[172:173] op_sel:[0,1] op_sel_hi:[1,1]
  v_pk_mul_f32 v[44:45], v[44:45], v[76:77] op_sel:[0,0] op_sel_hi:[1,1]
  v_cvt_pk_bf16_f32 v122, v44, v45
  v_lshlrev_b32 v78, 16, v159
  v_and_b32 v79, s59, v159
  v_pk_add_f32 v[46:47], v[46:47], v[172:173] op_sel:[0,1] op_sel_hi:[1,1]
  v_pk_mul_f32 v[46:47], v[46:47], v[78:79] op_sel:[0,0] op_sel_hi:[1,1]
  v_cvt_pk_bf16_f32 v123, v46, v47
  v_permlane32_swap_b32 v120, v122
  s_nop 0
  v_permlane32_swap_b32 v121, v123
  v_permlane16_swap_b32 v120, v122
  s_nop 0
  v_permlane16_swap_b32 v121, v123
  buffer_store_dwordx4 v[120:123], v2, s[28:31], s27 offen offset:1024 sc0 sc1
  v_lshlrev_b32 v72, 16, v160
  v_and_b32 v73, s59, v160
  v_pk_add_f32 v[48:49], v[48:49], v[172:173] op_sel:[0,0] op_sel_hi:[1,0]
  v_pk_mul_f32 v[48:49], v[48:49], v[72:73] op_sel:[0,0] op_sel_hi:[1,1]
  v_cvt_pk_bf16_f32 v108, v48, v49
  v_lshlrev_b32 v74, 16, v161
  v_and_b32 v75, s59, v161
  v_pk_add_f32 v[50:51], v[50:51], v[172:173] op_sel:[0,0] op_sel_hi:[1,0]
  v_pk_mul_f32 v[50:51], v[50:51], v[74:75] op_sel:[0,0] op_sel_hi:[1,1]
  v_cvt_pk_bf16_f32 v109, v50, v51
  v_lshlrev_b32 v76, 16, v164
  v_and_b32 v77, s59, v164
  v_pk_add_f32 v[56:57], v[56:57], v[172:173] op_sel:[0,0] op_sel_hi:[1,0]
  v_pk_mul_f32 v[56:57], v[56:57], v[76:77] op_sel:[0,0] op_sel_hi:[1,1]
  v_cvt_pk_bf16_f32 v110, v56, v57
  v_lshlrev_b32 v78, 16, v165
  v_and_b32 v79, s59, v165
  v_pk_add_f32 v[58:59], v[58:59], v[172:173] op_sel:[0,0] op_sel_hi:[1,0]
  v_pk_mul_f32 v[58:59], v[58:59], v[78:79] op_sel:[0,0] op_sel_hi:[1,1]
  v_cvt_pk_bf16_f32 v111, v58, v59
  v_permlane32_swap_b32 v108, v110
  s_nop 0
  v_permlane32_swap_b32 v109, v111
  v_permlane16_swap_b32 v108, v110
  s_nop 0
  v_permlane16_swap_b32 v109, v111
  buffer_store_dwordx4 v[108:111], v2, s[28:31], s26 offen offset:2048 sc0 sc1
  v_lshlrev_b32 v72, 16, v162
  v_and_b32 v73, s59, v162
  v_pk_add_f32 v[52:53], v[52:53], v[172:173] op_sel:[0,1] op_sel_hi:[1,1]
  v_pk_mul_f32 v[52:53], v[52:53], v[72:73] op_sel:[0,0] op_sel_hi:[1,1]
  v_cvt_pk_bf16_f32 v112, v52, v53
  v_lshlrev_b32 v74, 16, v163
  v_and_b32 v75, s59, v163
  v_pk_add_f32 v[54:55], v[54:55], v[172:173] op_sel:[0,1] op_sel_hi:[1,1]
  v_pk_mul_f32 v[54:55], v[54:55], v[74:75] op_sel:[0,0] op_sel_hi:[1,1]
  v_cvt_pk_bf16_f32 v113, v54, v55
  v_lshlrev_b32 v76, 16, v166
  v_and_b32 v77, s59, v166
  v_pk_add_f32 v[60:61], v[60:61], v[172:173] op_sel:[0,1] op_sel_hi:[1,1]
  v_pk_mul_f32 v[60:61], v[60:61], v[76:77] op_sel:[0,0] op_sel_hi:[1,1]
  v_cvt_pk_bf16_f32 v114, v60, v61
  v_lshlrev_b32 v78, 16, v167
  v_and_b32 v79, s59, v167
  v_pk_add_f32 v[62:63], v[62:63], v[172:173] op_sel:[0,1] op_sel_hi:[1,1]
  v_pk_mul_f32 v[62:63], v[62:63], v[78:79] op_sel:[0,0] op_sel_hi:[1,1]
  v_cvt_pk_bf16_f32 v115, v62, v63
  v_permlane32_swap_b32 v112, v114
  s_nop 0
  v_permlane32_swap_b32 v113, v115
  v_permlane16_swap_b32 v112, v114
  s_nop 0
  v_permlane16_swap_b32 v113, v115
  buffer_store_dwordx4 v[112:115], v2, s[28:31], s27 offen offset:2048 sc0 sc1
  v_lshlrev_b32 v72, 16, v168
  v_and_b32 v73, s59, v168
  v_pk_add_f32 v[64:65], v[64:65], v[172:173] op_sel:[0,0] op_sel_hi:[1,0]
  v_pk_mul_f32 v[64:65], v[64:65], v[72:73] op_sel:[0,0] op_sel_hi:[1,1]
  v_cvt_pk_bf16_f32 v116, v64, v65
  v_lshlrev_b32 v74, 16, v169
  v_and_b32 v75, s59, v169
  v_pk_add_f32 v[66:67], v[66:67], v[172:173] op_sel:[0,0] op_sel_hi:[1,0]
  v_pk_mul_f32 v[66:67], v[66:67], v[74:75] op_sel:[0,0] op_sel_hi:[1,1]
  v_cvt_pk_bf16_f32 v117, v66, v67
  v_lshlrev_b32 v76, 16, v170
  v_and_b32 v77, s59, v170
  v_pk_add_f32 v[68:69], v[68:69], v[172:173] op_sel:[0,1] op_sel_hi:[1,1]
  v_pk_mul_f32 v[68:69], v[68:69], v[76:77] op_sel:[0,0] op_sel_hi:[1,1]
  v_cvt_pk_bf16_f32 v118, v68, v69
  v_lshlrev_b32 v78, 16, v171
  v_and_b32 v79, s59, v171
  v_pk_add_f32 v[70:71], v[70:71], v[172:173] op_sel:[0,1] op_sel_hi:[1,1]
  v_pk_mul_f32 v[70:71], v[70:71], v[78:79] op_sel:[0,0] op_sel_hi:[1,1]
  v_cvt_pk_bf16_f32 v119, v70, v71
  v_permlane16_swap_b32 v116, v118
  s_nop 0
  v_permlane16_swap_b32 v117, v119
  buffer_store_dwordx4 v[116:119], v3, s[28:31], s26 offen offset:3072 sc0 sc1
  s_branch g4_kernel_oe14
g4_kernel_odd13:
  v_lshlrev_b32 v72, 16, v144
  v_and_b32 v73, s59, v144
  v_pk_add_f32 v[16:17], v[16:17], v[172:173] op_sel:[0,0] op_sel_hi:[1,0]
  v_pk_mul_f32 v[16:17], v[16:17], v[72:73] op_sel:[0,0] op_sel_hi:[1,1]
  v_cvt_pk_bf16_f32 v108, v16, v17
  v_lshlrev_b32 v74, 16, v145
  v_and_b32 v75, s59, v145
  v_pk_add_f32 v[18:19], v[18:19], v[172:173] op_sel:[0,0] op_sel_hi:[1,0]
  v_pk_mul_f32 v[18:19], v[18:19], v[74:75] op_sel:[0,0] op_sel_hi:[1,1]
  v_cvt_pk_bf16_f32 v109, v18, v19
  v_lshlrev_b32 v76, 16, v146
  v_and_b32 v77, s59, v146
  v_pk_add_f32 v[20:21], v[20:21], v[172:173] op_sel:[0,1] op_sel_hi:[1,1]
  v_pk_mul_f32 v[20:21], v[20:21], v[76:77] op_sel:[0,0] op_sel_hi:[1,1]
  v_cvt_pk_bf16_f32 v110, v20, v21
  v_lshlrev_b32 v78, 16, v147
  v_and_b32 v79, s59, v147
  v_pk_add_f32 v[22:23], v[22:23], v[172:173] op_sel:[0,1] op_sel_hi:[1,1]
  v_pk_mul_f32 v[22:23], v[22:23], v[78:79] op_sel:[0,0] op_sel_hi:[1,1]
  v_cvt_pk_bf16_f32 v111, v22, v23
  v_permlane16_swap_b32 v108, v110
  s_nop 0
  v_permlane16_swap_b32 v109, v111
  buffer_store_dwordx4 v[108:111], v3, s[28:31], s26 offen offset:512 sc0 sc1
  v_lshlrev_b32 v72, 16, v148
  v_and_b32 v73, s59, v148
  v_pk_add_f32 v[24:25], v[24:25], v[172:173] op_sel:[0,0] op_sel_hi:[1,0]
  v_pk_mul_f32 v[24:25], v[24:25], v[72:73] op_sel:[0,0] op_sel_hi:[1,1]
  v_cvt_pk_bf16_f32 v112, v24, v25
  v_lshlrev_b32 v74, 16, v149
  v_and_b32 v75, s59, v149
  v_pk_add_f32 v[26:27], v[26:27], v[172:173] op_sel:[0,0] op_sel_hi:[1,0]
  v_pk_mul_f32 v[26:27], v[26:27], v[74:75] op_sel:[0,0] op_sel_hi:[1,1]
  v_cvt_pk_bf16_f32 v113, v26, v27
  v_lshlrev_b32 v76, 16, v152
  v_and_b32 v77, s59, v152
  v_pk_add_f32 v[32:33], v[32:33], v[172:173] op_sel:[0,0] op_sel_hi:[1,0]
  v_pk_mul_f32 v[32:33], v[32:33], v[76:77] op_sel:[0,0] op_sel_hi:[1,1]
  v_cvt_pk_bf16_f32 v114, v32, v33
  v_lshlrev_b32 v78, 16, v153
  v_and_b32 v79, s59, v153
  v_pk_add_f32 v[34:35], v[34:35], v[172:173] op_sel:[0,0] op_sel_hi:[1,0]
  v_pk_mul_f32 v[34:35], v[34:35], v[78:79] op_sel:[0,0] op_sel_hi:[1,1]
  v_cvt_pk_bf16_f32 v115, v34, v35
  v_permlane32_swap_b32 v112, v114
  s_nop 0
  v_permlane32_swap_b32 v113, v115
  v_permlane16_swap_b32 v112, v114
  s_nop 0
  v_permlane16_swap_b32 v113, v115
  buffer_store_dwordx4 v[112:115], v2, s[28:31], s26 offen offset:1024 sc0 sc1
  v_lshlrev_b32 v72, 16, v150
  v_and_b32 v73, s59, v150
  v_pk_add_f32 v[28:29], v[28:29], v[172:173] op_sel:[0,1] op_sel_hi:[1,1]
  v_pk_mul_f32 v[28:29], v[28:29], v[72:73] op_sel:[0,0] op_sel_hi:[1,1]
  v_cvt_pk_bf16_f32 v116, v28, v29
  v_lshlrev_b32 v74, 16, v151
  v_and_b32 v75, s59, v151
  v_pk_add_f32 v[30:31], v[30:31], v[172:173] op_sel:[0,1] op_sel_hi:[1,1]
  v_pk_mul_f32 v[30:31], v[30:31], v[74:75] op_sel:[0,0] op_sel_hi:[1,1]
  v_cvt_pk_bf16_f32 v117, v30, v31
  v_lshlrev_b32 v76, 16, v154
  v_and_b32 v77, s59, v154
  v_pk_add_f32 v[36:37], v[36:37], v[172:173] op_sel:[0,1] op_sel_hi:[1,1]
  v_pk_mul_f32 v[36:37], v[36:37], v[76:77] op_sel:[0,0] op_sel_hi:[1,1]
  v_cvt_pk_bf16_f32 v118, v36, v37
  v_lshlrev_b32 v78, 16, v155
  v_and_b32 v79, s59, v155
  v_pk_add_f32 v[38:39], v[38:39], v[172:173] op_sel:[0,1] op_sel_hi:[1,1]
  v_pk_mul_f32 v[38:39], v[38:39], v[78:79] op_sel:[0,0] op_sel_hi:[1,1]
  v_cvt_pk_bf16_f32 v119, v38, v39
  v_permlane32_swap_b32 v116, v118
  s_nop 0
  v_permlane32_swap_b32 v117, v119
  v_permlane16_swap_b32 v116, v118
  s_nop 0
  v_permlane16_swap_b32 v117, v119
  buffer_store_dwordx4 v[116:119], v2, s[28:31], s27 offen offset:1024 sc0 sc1
  v_lshlrev_b32 v72, 16, v156
  v_and_b32 v73, s59, v156
  v_pk_add_f32 v[40:41], v[40:41], v[172:173] op_sel:[0,0] op_sel_hi:[1,0]
  v_pk_mul_f32 v[40:41], v[40:41], v[72:73] op_sel:[0,0] op_sel_hi:[1,1]
  v_cvt_pk_bf16_f32 v120, v40, v41
  v_lshlrev_b32 v74, 16, v157
  v_and_b32 v75, s59, v157
  v_pk_add_f32 v[42:43], v[42:43], v[172:173] op_sel:[0,0] op_sel_hi:[1,0]
  v_pk_mul_f32 v[42:43], v[42:43], v[74:75] op_sel:[0,0] op_sel_hi:[1,1]
  v_cvt_pk_bf16_f32 v121, v42, v43
  v_lshlrev_b32 v76, 16, v160
  v_and_b32 v77, s59, v160
  v_pk_add_f32 v[48:49], v[48:49], v[172:173] op_sel:[0,0] op_sel_hi:[1,0]
  v_pk_mul_f32 v[48:49], v[48:49], v[76:77] op_sel:[0,0] op_sel_hi:[1,1]
  v_cvt_pk_bf16_f32 v122, v48, v49
  v_lshlrev_b32 v78, 16, v161
  v_and_b32 v79, s59, v161
  v_pk_add_f32 v[50:51], v[50:51], v[172:173] op_sel:[0,0] op_sel_hi:[1,0]
  v_pk_mul_f32 v[50:51], v[50:51], v[78:79] op_sel:[0,0] op_sel_hi:[1,1]
  v_cvt_pk_bf16_f32 v123, v50, v51
  v_permlane32_swap_b32 v120, v122
  s_nop 0
  v_permlane32_swap_b32 v121, v123
  v_permlane16_swap_b32 v120, v122
  s_nop 0
  v_permlane16_swap_b32 v121, v123
  buffer_store_dwordx4 v[120:123], v2, s[28:31], s26 offen offset:2048 sc0 sc1
  v_lshlrev_b32 v72, 16, v158
  v_and_b32 v73, s59, v158
  v_pk_add_f32 v[44:45], v[44:45], v[172:173] op_sel:[0,1] op_sel_hi:[1,1]
  v_pk_mul_f32 v[44:45], v[44:45], v[72:73] op_sel:[0,0] op_sel_hi:[1,1]
  v_cvt_pk_bf16_f32 v108, v44, v45
  v_lshlrev_b32 v74, 16, v159
  v_and_b32 v75, s59, v159
  v_pk_add_f32 v[46:47], v[46:47], v[172:173] op_sel:[0,1] op_sel_hi:[1,1]
  v_pk_mul_f32 v[46:47], v[46:47], v[74:75] op_sel:[0,0] op_sel_hi:[1,1]
  v_cvt_pk_bf16_f32 v109, v46, v47
  v_lshlrev_b32 v76, 16, v162
  v_and_b32 v77, s59, v162
  v_pk_add_f32 v[52:53], v[52:53], v[172:173] op_sel:[0,1] op_sel_hi:[1,1]
  v_pk_mul_f32 v[52:53], v[52:53], v[76:77] op_sel:[0,0] op_sel_hi:[1,1]
  v_cvt_pk_bf16_f32 v110, v52, v53
  v_lshlrev_b32 v78, 16, v163
  v_and_b32 v79, s59, v163
  v_pk_add_f32 v[54:55], v[54:55], v[172:173] op_sel:[0,1] op_sel_hi:[1,1]
  v_pk_mul_f32 v[54:55], v[54:55], v[78:79] op_sel:[0,0] op_sel_hi:[1,1]
  v_cvt_pk_bf16_f32 v111, v54, v55
  v_permlane32_swap_b32 v108, v110
  s_nop 0
  v_permlane32_swap_b32 v109, v111
  v_permlane16_swap_b32 v108, v110
  s_nop 0
  v_permlane16_swap_b32 v109, v111
  buffer_store_dwordx4 v[108:111], v2, s[28:31], s27 offen offset:2048 sc0 sc1
  v_lshlrev_b32 v72, 16, v164
  v_and_b32 v73, s59, v164
  v_pk_add_f32 v[56:57], v[56:57], v[172:173] op_sel:[0,0] op_sel_hi:[1,0]
  v_pk_mul_f32 v[56:57], v[56:57], v[72:73] op_sel:[0,0] op_sel_hi:[1,1]
  v_cvt_pk_bf16_f32 v112, v56, v57
  v_lshlrev_b32 v74, 16, v165
  v_and_b32 v75, s59, v165
  v_pk_add_f32 v[58:59], v[58:59], v[172:173] op_sel:[0,0] op_sel_hi:[1,0]
  v_pk_mul_f32 v[58:59], v[58:59], v[74:75] op_sel:[0,0] op_sel_hi:[1,1]
  v_cvt_pk_bf16_f32 v113, v58, v59
  v_lshlrev_b32 v76, 16, v168
  v_and_b32 v77, s59, v168
  v_pk_add_f32 v[64:65], v[64:65], v[172:173] op_sel:[0,0] op_sel_hi:[1,0]
  v_pk_mul_f32 v[64:65], v[64:65], v[76:77] op_sel:[0,0] op_sel_hi:[1,1]
  v_cvt_pk_bf16_f32 v114, v64, v65
  v_lshlrev_b32 v78, 16, v169
  v_and_b32 v79, s59, v169
  v_pk_add_f32 v[66:67], v[66:67], v[172:173] op_sel:[0,0] op_sel_hi:[1,0]
  v_pk_mul_f32 v[66:67], v[66:67], v[78:79] op_sel:[0,0] op_sel_hi:[1,1]
  v_cvt_pk_bf16_f32 v115, v66, v67
  v_permlane32_swap_b32 v112, v114
  s_nop 0
  v_permlane32_swap_b32 v113, v115
  v_permlane16_swap_b32 v112, v114
  s_nop 0
  v_permlane16_swap_b32 v113, v115
  buffer_store_dwordx4 v[112:115], v2, s[28:31], s26 offen offset:3072 sc0 sc1
  v_lshlrev_b32 v72, 16, v166
  v_and_b32 v73, s59, v166
  v_pk_add_f32 v[60:61], v[60:61], v[172:173] op_sel:[0,1] op_sel_hi:[1,1]
  v_pk_mul_f32 v[60:61], v[60:61], v[72:73] op_sel:[0,0] op_sel_hi:[1,1]
  v_cvt_pk_bf16_f32 v116, v60, v61
  v_lshlrev_b32 v74, 16, v167
  v_and_b32 v75, s59, v167
  v_pk_add_f32 v[62:63], v[62:63], v[172:173] op_sel:[0,1] op_sel_hi:[1,1]
  v_pk_mul_f32 v[62:63], v[62:63], v[74:75] op_sel:[0,0] op_sel_hi:[1,1]
  v_cvt_pk_bf16_f32 v117, v62, v63
  v_lshlrev_b32 v76, 16, v170
  v_and_b32 v77, s59, v170
  v_pk_add_f32 v[68:69], v[68:69], v[172:173] op_sel:[0,1] op_sel_hi:[1,1]
  v_pk_mul_f32 v[68:69], v[68:69], v[76:77] op_sel:[0,0] op_sel_hi:[1,1]
  v_cvt_pk_bf16_f32 v118, v68, v69
  v_lshlrev_b32 v78, 16, v171
  v_and_b32 v79, s59, v171
  v_pk_add_f32 v[70:71], v[70:71], v[172:173] op_sel:[0,1] op_sel_hi:[1,1]
  v_pk_mul_f32 v[70:71], v[70:71], v[78:79] op_sel:[0,0] op_sel_hi:[1,1]
  v_cvt_pk_bf16_f32 v119, v70, v71
  v_permlane32_swap_b32 v116, v118
  s_nop 0
  v_permlane32_swap_b32 v117, v119
  v_permlane16_swap_b32 v116, v118
  s_nop 0
  v_permlane16_swap_b32 v117, v119
  buffer_store_dwordx4 v[116:119], v2, s[28:31], s27 offen offset:3072 sc0 sc1
g4_kernel_oe14:
g4_kernel_fin:
  s_load_dwordx2 s[96:97], s[0:1], 96
  s_cmp_lg_u32 s90, 0
  s_cselect_b32 s19, 3, 7
  s_lshl_b32 s19, s19, 15
  s_lshl_b32 s3, s13, 4
  s_add_u32 s3, s3, s12
  s_lshl_b32 s3, s3, 7
  s_add_u32 s3, s3, s19
  v_mov_b32 v2, 0
  v_mov_b32 v3, 1
  s_waitcnt lgkmcnt(0)
  s_add_u32 s96, s96, 63963136
  s_addc_u32 s97, s97, 0
  s_mov_b32 s98, 262144
  s_mov_b32 s99, 0x20000
  s_waitcnt vmcnt(0)
  s_barrier
  s_cmp_lg_u32 s14, 0
  s_cbranch_scc1 g4_kernel_nb15
  buffer_store_dword v3, v2, s[96:99], s3 offen sc1
g4_kernel_nb15:
  s_cmp_lg_u32 s90, 0
  s_cbranch_scc1 g5_kernel_fe
  s_branch g5f_kernel_fe
g4_kernel_end:
  s_endpgm
.p2align 6
g5_kernel_fe:
  s_load_dwordx2 s[4:5], s[0:1], 72
  s_load_dwordx2 s[8:9], s[0:1], 96
  s_and_b32 s3, s2, 7
  s_lshr_b32 s16, s2, 3
  s_and_b32 s12, s3, 1
  s_mul_i32 s12, s12, 8
  s_lshr_b32 s13, s3, 1
  s_mul_i32 s13, s13, 4
  s_and_b32 s3, s16, 7
  s_add_u32 s12, s12, s3
  s_lshr_b32 s16, s16, 3
  s_add_u32 s13, s13, s16
  s_mov_b32 s15, 0
  s_cmp_lt_u32 s14, 4
  s_cbranch_scc1 g5_kernel_comp
  s_sub_u32 s24, s14, 4
  s_setprio 2
  s_mul_i32 s83, s13, 458752
  s_lshr_b32 s3, s12, 3
  s_mul_i32 s97, s3, 114688
  s_mul_i32 s3, s3, 28672
  s_add_u32 s83, s83, s3
  s_lshr_b32 s3, s24, 1
  s_mul_i32 s3, s3, 57344
  s_add_u32 s83, s83, s3
  s_and_b32 s3, s24, 1
  s_lshl_b32 s3, s3, 10
  s_add_u32 s83, s83, s3
  s_mul_i32 s85, s24, 1024
  s_add_u32 s85, s85, 16384
  v_lshlrev_b32 v6, 4, v0
  v_add_u32 v6, s83, v6
  s_and_b32 s3, s12, 7
  s_mul_i32 s82, s3, 256
  s_lshr_b32 s3, s12, 3
  s_mul_i32 s3, s3, 1835008
  s_add_u32 s82, s82, s3
  s_mul_i32 s3, s24, 8192
  s_add_u32 s82, s82, s3
  s_mul_i32 s84, s24, 1024
  v_lshrrev_b32 v7, 4, v0
  v_lshlrev_b32 v7, 11, v7
  v_and_b32 v2, 15, v0
  v_lshrrev_b32 v3, 4, v0
  v_lshlrev_b32 v3, 1, v3
  v_xor_b32 v2, v2, v3
  v_lshlrev_b32 v2, 4, v2
  v_add_u32 v7, v7, v2
  s_lshr_b32 s3, s24, 1
  s_lshl_b32 s3, s3, 7
  v_xor_b32 v7, s3, v7
  v_add_u32 v7, s82, v7
  s_mov_b32 s17, 0
  s_mov_b32 s18, 0
  s_mov_b32 s80, 0
  s_mul_i32 s81, s12, 1
  s_mul_i32 s3, s13, 1
  s_add_u32 s81, s81, s3
  s_and_b32 s81, s81, 3
  s_mul_i32 s81, s81, 2
  s_mov_b32 s16, 0
  s_waitcnt lgkmcnt(0)
  s_mov_b32 s6, 3670016
  s_mov_b32 s7, 0x20000
  s_add_u32 s8, s8, 33554432
  s_addc_u32 s9, s9, 0
  s_cmp_eq_u32 s90, 0
  s_cselect_b32 s10, 67108864, 0
  s_add_u32 s8, s8, s10
  s_addc_u32 s9, s9, 0
  s_mov_b32 s10, 7340032
  s_mov_b32 s11, 0x20000
  s_add_u32 s3, s80, s81
  s_cmp_lt_u32 s80, 7
  s_cselect_b32 s19, 7, 14
  s_cmp_ge_u32 s3, s19
  s_cselect_b32 s19, 7, 0
  s_sub_u32 s3, s3, s19
  s_mul_i32 s17, s3, 131072
  s_mul_i32 s18, s3, 2048
  s_barrier
g5_kernel_nsg3:
  s_add_u32 s26, s15, s84
  s_mov_b32 m0, s26
  s_nop 0
  buffer_load_dwordx4 v7, s[4:7], s17 offen lds
  s_add_u32 m0, s26, 4096
  s_add_u32 s27, s17, 32768
  buffer_load_dwordx4 v7, s[4:7], s27 offen lds
  s_add_u32 m0, s26, 8192
  s_add_u32 s27, s17, 65536
  buffer_load_dwordx4 v7, s[4:7], s27 offen lds
  s_add_u32 m0, s26, 12288
  s_add_u32 s27, s17, 98304
  buffer_load_dwordx4 v7, s[4:7], s27 offen lds
  s_add_u32 s15, s15, 32768
  s_cmp_eq_u32 s15, 131072
  s_cselect_b32 s15, 0, s15
  s_add_u32 s80, s80, 1
  s_add_u32 s3, s80, s81
  s_cmp_lt_u32 s80, 7
  s_cselect_b32 s19, 7, 14
  s_cmp_ge_u32 s3, s19
  s_cselect_b32 s19, 7, 0
  s_sub_u32 s3, s3, s19
  s_mul_i32 s17, s3, 131072
  s_mul_i32 s18, s3, 2048
  s_add_u32 s26, s15, s84
  s_mov_b32 m0, s26
  s_nop 0
  buffer_load_dwordx4 v7, s[4:7], s17 offen lds
  s_add_u32 m0, s26, 4096
  s_add_u32 s27, s17, 32768
  buffer_load_dwordx4 v7, s[4:7], s27 offen lds
  s_add_u32 m0, s26, 8192
  s_add_u32 s27, s17, 65536
  buffer_load_dwordx4 v7, s[4:7], s27 offen lds
  s_add_u32 m0, s26, 12288
  s_add_u32 s27, s17, 98304
  buffer_load_dwordx4 v7, s[4:7], s27 offen lds
  s_add_u32 s15, s15, 32768
  s_cmp_eq_u32 s15, 131072
  s_cselect_b32 s15, 0, s15
  s_add_u32 s80, s80, 1
  s_add_u32 s3, s80, s81
  s_cmp_lt_u32 s80, 7
  s_cselect_b32 s19, 7, 14
  s_cmp_ge_u32 s3, s19
  s_cselect_b32 s19, 7, 0
  s_sub_u32 s3, s3, s19
  s_mul_i32 s17, s3, 131072
  s_mul_i32 s18, s3, 2048
  s_add_u32 s26, s15, s84
  s_mov_b32 m0, s26
  s_nop 0
  buffer_load_dwordx4 v7, s[4:7], s17 offen lds
  s_add_u32 m0, s26, 4096
  s_add_u32 s27, s17, 32768
  buffer_load_dwordx4 v7, s[4:7], s27 offen lds
  s_add_u32 m0, s26, 8192
  s_add_u32 s27, s17, 65536
  buffer_load_dwordx4 v7, s[4:7], s27 offen lds
  s_add_u32 m0, s26, 12288
  s_add_u32 s27, s17, 98304
  buffer_load_dwordx4 v7, s[4:7], s27 offen lds
  s_add_u32 s15, s15, 32768
  s_cmp_eq_u32 s15, 131072
  s_cselect_b32 s15, 0, s15
  s_add_u32 s80, s80, 1
  s_add_u32 s3, s80, s81
  s_cmp_lt_u32 s80, 7
  s_cselect_b32 s19, 7, 14
  s_cmp_ge_u32 s3, s19
  s_cselect_b32 s19, 7, 0
  s_sub_u32 s3, s3, s19
  s_mul_i32 s17, s3, 131072
  s_mul_i32 s18, s3, 2048
  s_mov_b32 s15, 0
  s_mov_b32 s17, 0
  s_mov_b32 s18, 0
  s_mov_b32 s80, 0
  s_add_u32 s3, s80, s81
  s_cmp_lt_u32 s80, 7
  s_cselect_b32 s19, 7, 14
  s_cmp_ge_u32 s3, s19
  s_cselect_b32 s19, 7, 0
  s_sub_u32 s3, s3, s19
  s_mul_i32 s17, s3, 131072
  s_mul_i32 s18, s3, 2048
  s_load_dwordx2 s[28:29], s[0:1], 96
  v_and_b32 v2, 7, v0
  v_lshlrev_b32 v2, 7, v2
  s_cmp_lg_u32 s90, 0
  s_cselect_b32 s32, 3, 7
  s_lshl_b32 s32, s32, 15
  s_lshl_b32 s3, s13, 8
  s_and_b32 s19, s12, 8
  s_lshl_b32 s19, s19, 4
  s_add_u32 s3, s3, s19
  s_lshr_b32 s3, s3, 4
  s_lshl_b32 s3, s3, 7
  s_add_u32 s32, s32, s3
  s_mov_b32 s33, 0
  s_waitcnt lgkmcnt(0)
  s_add_u32 s28, s28, 63963136
  s_addc_u32 s29, s29, 0
  s_mov_b32 s30, 262144
  s_mov_b32 s31, 0x20000
  s_cmp_lg_u32 s24, 0
  s_cbranch_scc1 g5_kernel_dd5
g5_kernel_dp4:
  buffer_load_dword v8, v2, s[28:31], s32 offen sc1
  s_add_u32 s33, s33, 1
  s_waitcnt vmcnt(0)
  v_cmp_eq_u32 vcc, -1, v8
  s_cmp_ge_u32 s33, 0x8000
  s_cbranch_vccz g5_kernel_dd5
  s_cbranch_scc0 g5_kernel_dp4
g5_kernel_dd5:
  s_barrier
  s_add_u32 s26, s15, s85
  s_mov_b32 m0, s26
  s_add_u32 s27, s18, 0
  s_add_u32 s27, s27, s97
  buffer_load_dwordx4 v6, s[8:11], s27 offen lds
  s_add_u32 m0, s26, 4096
  s_add_u32 s27, s18, 114688
  s_sub_u32 s27, s27, s97
  buffer_load_dwordx4 v6, s[8:11], s27 offen lds
  s_add_u32 m0, s26, 8192
  s_add_u32 s27, s18, 229376
  s_add_u32 s27, s27, s97
  buffer_load_dwordx4 v6, s[8:11], s27 offen lds
  s_add_u32 m0, s26, 12288
  s_add_u32 s27, s18, 344064
  s_sub_u32 s27, s27, s97
  buffer_load_dwordx4 v6, s[8:11], s27 offen lds
  s_add_u32 s15, s15, 32768
  s_cmp_eq_u32 s15, 131072
  s_cselect_b32 s15, 0, s15
  s_add_u32 s80, s80, 1
  s_add_u32 s3, s80, s81
  s_cmp_lt_u32 s80, 7
  s_cselect_b32 s19, 7, 14
  s_cmp_ge_u32 s3, s19
  s_cselect_b32 s19, 7, 0
  s_sub_u32 s3, s3, s19
  s_mul_i32 s17, s3, 131072
  s_mul_i32 s18, s3, 2048
  s_add_u32 s26, s15, s85
  s_mov_b32 m0, s26
  s_add_u32 s27, s18, 0
  s_add_u32 s27, s27, s97
  buffer_load_dwordx4 v6, s[8:11], s27 offen lds
  s_add_u32 m0, s26, 4096
  s_add_u32 s27, s18, 114688
  s_sub_u32 s27, s27, s97
  buffer_load_dwordx4 v6, s[8:11], s27 offen lds
  s_add_u32 m0, s26, 8192
  s_add_u32 s27, s18, 229376
  s_add_u32 s27, s27, s97
  buffer_load_dwordx4 v6, s[8:11], s27 offen lds
  s_add_u32 m0, s26, 12288
  s_add_u32 s27, s18, 344064
  s_sub_u32 s27, s27, s97
  buffer_load_dwordx4 v6, s[8:11], s27 offen lds
  s_add_u32 s15, s15, 32768
  s_cmp_eq_u32 s15, 131072
  s_cselect_b32 s15, 0, s15
  s_add_u32 s80, s80, 1
  s_add_u32 s3, s80, s81
  s_cmp_lt_u32 s80, 7
  s_cselect_b32 s19, 7, 14
  s_cmp_ge_u32 s3, s19
  s_cselect_b32 s19, 7, 0
  s_sub_u32 s3, s3, s19
  s_mul_i32 s17, s3, 131072
  s_mul_i32 s18, s3, 2048
  s_add_u32 s26, s15, s85
  s_mov_b32 m0, s26
  s_add_u32 s27, s18, 0
  s_add_u32 s27, s27, s97
  buffer_load_dwordx4 v6, s[8:11], s27 offen lds
  s_add_u32 m0, s26, 4096
  s_add_u32 s27, s18, 114688
  s_sub_u32 s27, s27, s97
  buffer_load_dwordx4 v6, s[8:11], s27 offen lds
  s_add_u32 m0, s26, 8192
  s_add_u32 s27, s18, 229376
  s_add_u32 s27, s27, s97
  buffer_load_dwordx4 v6, s[8:11], s27 offen lds
  s_add_u32 m0, s26, 12288
  s_add_u32 s27, s18, 344064
  s_sub_u32 s27, s27, s97
  buffer_load_dwordx4 v6, s[8:11], s27 offen lds
  s_add_u32 s15, s15, 32768
  s_cmp_eq_u32 s15, 131072
  s_cselect_b32 s15, 0, s15
  s_add_u32 s80, s80, 1
  s_add_u32 s3, s80, s81
  s_cmp_lt_u32 s80, 7
  s_cselect_b32 s19, 7, 14
  s_cmp_ge_u32 s3, s19
  s_cselect_b32 s19, 7, 0
  s_sub_u32 s3, s3, s19
  s_mul_i32 s17, s3, 131072
  s_mul_i32 s18, s3, 2048
  s_waitcnt vmcnt(8)
  s_barrier
  s_add_u32 s26, s15, s85
  s_mov_b32 m0, s26
  s_add_u32 s27, s18, 0
  s_add_u32 s27, s27, s97
  buffer_load_dwordx4 v6, s[8:11], s27 offen lds
  s_add_u32 m0, s26, 4096
  s_add_u32 s27, s18, 114688
  s_sub_u32 s27, s27, s97
  buffer_load_dwordx4 v6, s[8:11], s27 offen lds
  s_add_u32 m0, s26, 8192
  s_add_u32 s27, s18, 229376
  s_add_u32 s27, s27, s97
  buffer_load_dwordx4 v6, s[8:11], s27 offen lds
  s_add_u32 m0, s26, 12288
  s_add_u32 s27, s18, 344064
  s_sub_u32 s27, s27, s97
  buffer_load_dwordx4 v6, s[8:11], s27 offen lds
  s_add_u32 s26, s15, s84
  s_mov_b32 m0, s26
  s_nop 0
  buffer_load_dwordx4 v7, s[4:7], s17 offen lds
  s_add_u32 m0, s26, 4096
  s_add_u32 s27, s17, 32768
  buffer_load_dwordx4 v7, s[4:7], s27 offen lds
  s_add_u32 m0, s26, 8192
  s_add_u32 s27, s17, 65536
  buffer_load_dwordx4 v7, s[4:7], s27 offen lds
  s_add_u32 m0, s26, 12288
  s_add_u32 s27, s17, 98304
  buffer_load_dwordx4 v7, s[4:7], s27 offen lds
  s_add_u32 s15, s15, 32768
  s_cmp_eq_u32 s15, 131072
  s_cselect_b32 s15, 0, s15
  s_add_u32 s80, s80, 1
  s_add_u32 s3, s80, s81
  s_cmp_lt_u32 s80, 7
  s_cselect_b32 s19, 7, 14
  s_cmp_ge_u32 s3, s19
  s_cselect_b32 s19, 7, 0
  s_sub_u32 s3, s3, s19
  s_mul_i32 s17, s3, 131072
  s_mul_i32 s18, s3, 2048
  s_waitcnt vmcnt(12)
  s_barrier
  s_add_u32 s26, s15, s85
  s_mov_b32 m0, s26
  s_add_u32 s27, s18, 0
  s_add_u32 s27, s27, s97
  buffer_load_dwordx4 v6, s[8:11], s27 offen lds
  s_add_u32 m0, s26, 4096
  s_add_u32 s27, s18, 114688
  s_sub_u32 s27, s27, s97
  buffer_load_dwordx4 v6, s[8:11], s27 offen lds
  s_add_u32 m0, s26, 8192
  s_add_u32 s27, s18, 229376
  s_add_u32 s27, s27, s97
  buffer_load_dwordx4 v6, s[8:11], s27 offen lds
  s_add_u32 m0, s26, 12288
  s_add_u32 s27, s18, 344064
  s_sub_u32 s27, s27, s97
  buffer_load_dwordx4 v6, s[8:11], s27 offen lds
  s_add_u32 s26, s15, s84
  s_mov_b32 m0, s26
  s_nop 0
  buffer_load_dwordx4 v7, s[4:7], s17 offen lds
  s_add_u32 m0, s26, 4096
  s_add_u32 s27, s17, 32768
  buffer_load_dwordx4 v7, s[4:7], s27 offen lds
  s_add_u32 m0, s26, 8192
  s_add_u32 s27, s17, 65536
  buffer_load_dwordx4 v7, s[4:7], s27 offen lds
  s_add_u32 m0, s26, 12288
  s_add_u32 s27, s17, 98304
  buffer_load_dwordx4 v7, s[4:7], s27 offen lds
  s_add_u32 s15, s15, 32768
  s_cmp_eq_u32 s15, 131072
  s_cselect_b32 s15, 0, s15
  s_add_u32 s80, s80, 1
  s_add_u32 s3, s80, s81
  s_cmp_lt_u32 s80, 7
  s_cselect_b32 s19, 7, 14
  s_cmp_ge_u32 s3, s19
  s_cselect_b32 s19, 7, 0
  s_sub_u32 s3, s3, s19
  s_mul_i32 s17, s3, 131072
  s_mul_i32 s18, s3, 2048
  s_mov_b32 s16, 5
g5_kernel_ldloop1:
  s_waitcnt vmcnt(16)
  s_barrier
g5_kernel_ldissue2:
  s_add_u32 s26, s15, s85
  s_mov_b32 m0, s26
  s_add_u32 s27, s18, 0
  s_add_u32 s27, s27, s97
  buffer_load_dwordx4 v6, s[8:11], s27 offen lds
  s_add_u32 m0, s26, 4096
  s_add_u32 s27, s18, 114688
  s_sub_u32 s27, s27, s97
  buffer_load_dwordx4 v6, s[8:11], s27 offen lds
  s_add_u32 m0, s26, 8192
  s_add_u32 s27, s18, 229376
  s_add_u32 s27, s27, s97
  buffer_load_dwordx4 v6, s[8:11], s27 offen lds
  s_add_u32 m0, s26, 12288
  s_add_u32 s27, s18, 344064
  s_sub_u32 s27, s27, s97
  buffer_load_dwordx4 v6, s[8:11], s27 offen lds
  s_add_u32 s26, s15, s84
  s_mov_b32 m0, s26
  s_nop 0
  buffer_load_dwordx4 v7, s[4:7], s17 offen lds
  s_add_u32 m0, s26, 4096
  s_add_u32 s27, s17, 32768
  buffer_load_dwordx4 v7, s[4:7], s27 offen lds
  s_add_u32 m0, s26, 8192
  s_add_u32 s27, s17, 65536
  buffer_load_dwordx4 v7, s[4:7], s27 offen lds
  s_add_u32 m0, s26, 12288
  s_add_u32 s27, s17, 98304
  buffer_load_dwordx4 v7, s[4:7], s27 offen lds
  s_add_u32 s15, s15, 32768
  s_cmp_eq_u32 s15, 131072
  s_cselect_b32 s15, 0, s15
  s_add_u32 s80, s80, 1
  s_add_u32 s3, s80, s81
  s_cmp_lt_u32 s80, 7
  s_cselect_b32 s19, 7, 14
  s_cmp_ge_u32 s3, s19
  s_cselect_b32 s19, 7, 0
  s_sub_u32 s3, s3, s19
  s_mul_i32 s17, s3, 131072
  s_mul_i32 s18, s3, 2048
  s_add_u32 s16, s16, 1
  s_cmp_lt_u32 s16, 14
  s_cbranch_scc1 g5_kernel_ldloop1
  s_waitcnt vmcnt(16)
  s_barrier
  s_waitcnt vmcnt(8)
  s_barrier
  s_waitcnt vmcnt(0)
  s_barrier
  s_barrier
  s_lshl_b32 s86, s13, 4
  s_add_u32 s86, s86, s12
  s_lshl_b32 s86, s86, 7
  s_mov_b32 s90, 0
  s_branch g1b_kernel_fe
g5_kernel_comp:
  s_load_dwordx2 s[28:29], s[0:1], 96
  s_load_dwordx2 s[32:33], s[0:1], 96
  s_load_dwordx2 s[72:73], s[0:1], 96
  s_load_dwordx2 s[64:65], s[0:1], 96
  s_and_b32 s24, s14, 1
  s_lshr_b32 s25, s14, 1
  v_and_b32 v6, 3, v0
  v_lshlrev_b32 v6, 3, v6
  s_mul_i32 s3, s24, 128
  v_add_u32 v6, s3, v6
  v_lshrrev_b32 v5, 4, v0
  v_lshlrev_b32 v5, 3, v5
  v_lshrrev_b32 v2, 2, v0
  v_and_b32 v2, 3, v2
  v_add_u32 v5, v5, v2
  v_and_b32 v5, 3, v5
  v_lshrrev_b32 v2, 4, v0
  v_lshlrev_b32 v2, 3, v2
  v_lshrrev_b32 v3, 2, v0
  v_and_b32 v3, 3, v3
  v_add_u32 v2, v2, v3
  v_lshrrev_b32 v2, 1, v2
  v_and_b32 v2, 4, v2
  v_add_u32 v5, v5, v2
  v_lshlrev_b32 v5, 5, v5
  v_xor_b32 v6, v6, v5
  v_lshrrev_b32 v5, 4, v0
  v_lshlrev_b32 v5, 3, v5
  v_lshrrev_b32 v2, 2, v0
  v_and_b32 v2, 3, v2
  v_add_u32 v5, v5, v2
  v_lshlrev_b32 v5, 8, v5
  v_add_u32 v6, v6, v5
  v_mov_b32 v7, v6
  v_mov_b32 v8, v6
  v_and_b32 v9, 3, v0
  v_lshlrev_b32 v9, 3, v9
  v_add_u32 v9, 32, v9
  s_mul_i32 s3, s24, 128
  v_add_u32 v9, s3, v9
  v_lshrrev_b32 v5, 4, v0
  v_lshlrev_b32 v5, 3, v5
  v_lshrrev_b32 v2, 2, v0
  v_and_b32 v2, 3, v2
  v_add_u32 v5, v5, v2
  v_and_b32 v5, 3, v5
  v_lshrrev_b32 v2, 4, v0
  v_lshlrev_b32 v2, 3, v2
  v_lshrrev_b32 v3, 2, v0
  v_and_b32 v3, 3, v3
  v_add_u32 v2, v2, v3
  v_lshrrev_b32 v2, 1, v2
  v_and_b32 v2, 4, v2
  v_add_u32 v5, v5, v2
  v_lshlrev_b32 v5, 5, v5
  v_xor_b32 v9, v9, v5
  v_lshrrev_b32 v5, 4, v0
  v_lshlrev_b32 v5, 3, v5
  v_lshrrev_b32 v2, 2, v0
  v_and_b32 v2, 3, v2
  v_add_u32 v5, v5, v2
  v_lshlrev_b32 v5, 8, v5
  v_add_u32 v9, v9, v5
  v_mov_b32 v10, v9
  v_mov_b32 v11, v9
  v_and_b32 v12, 3, v0
  v_lshlrev_b32 v12, 3, v12
  v_add_u32 v12, 64, v12
  s_mul_i32 s3, s24, 128
  v_add_u32 v12, s3, v12
  v_lshrrev_b32 v5, 4, v0
  v_lshlrev_b32 v5, 3, v5
  v_lshrrev_b32 v2, 2, v0
  v_and_b32 v2, 3, v2
  v_add_u32 v5, v5, v2
  v_and_b32 v5, 3, v5
  v_lshrrev_b32 v2, 4, v0
  v_lshlrev_b32 v2, 3, v2
  v_lshrrev_b32 v3, 2, v0
  v_and_b32 v3, 3, v3
  v_add_u32 v2, v2, v3
  v_lshrrev_b32 v2, 1, v2
  v_and_b32 v2, 4, v2
  v_add_u32 v5, v5, v2
  v_lshlrev_b32 v5, 5, v5
  v_xor_b32 v12, v12, v5
  v_lshrrev_b32 v5, 4, v0
  v_lshlrev_b32 v5, 3, v5
  v_lshrrev_b32 v2, 2, v0
  v_and_b32 v2, 3, v2
  v_add_u32 v5, v5, v2
  v_lshlrev_b32 v5, 8, v5
  v_add_u32 v12, v12, v5
  v_mov_b32 v13, v12
  v_mov_b32 v14, v12
  v_and_b32 v15, 3, v0
  v_lshlrev_b32 v15, 3, v15
  v_add_u32 v15, 96, v15
  s_mul_i32 s3, s24, 128
  v_add_u32 v15, s3, v15
  v_lshrrev_b32 v5, 4, v0
  v_lshlrev_b32 v5, 3, v5
  v_lshrrev_b32 v2, 2, v0
  v_and_b32 v2, 3, v2
  v_add_u32 v5, v5, v2
  v_and_b32 v5, 3, v5
  v_lshrrev_b32 v2, 4, v0
  v_lshlrev_b32 v2, 3, v2
  v_lshrrev_b32 v3, 2, v0
  v_and_b32 v3, 3, v3
  v_add_u32 v2, v2, v3
  v_lshrrev_b32 v2, 1, v2
  v_and_b32 v2, 4, v2
  v_add_u32 v5, v5, v2
  v_lshlrev_b32 v5, 5, v5
  v_xor_b32 v15, v15, v5
  v_lshrrev_b32 v5, 4, v0
  v_lshlrev_b32 v5, 3, v5
  v_lshrrev_b32 v2, 2, v0
  v_and_b32 v2, 3, v2
  v_add_u32 v5, v5, v2
  v_lshlrev_b32 v5, 8, v5
  v_add_u32 v15, v15, v5
  v_mov_b32 v16, v15
  v_mov_b32 v17, v15
  v_lshlrev_b32 v18, 4, v0
  s_mul_i32 s3, s25, 8192
  s_add_u32 s3, s3, 16384
  v_add_u32 v18, s3, v18
  v_mov_b32 v19, v18
  v_mov_b32 v20, v18
  s_waitcnt lgkmcnt(0)
  s_add_u32 s28, s28, 67108864
  s_addc_u32 s29, s29, 0
  s_mov_b32 s30, 4194304
  s_mov_b32 s31, 0x20000
  s_add_u32 s32, s32, 66060288
  s_addc_u32 s33, s33, 0
  s_mov_b32 s34, 262144
  s_mov_b32 s35, 0x20000
  s_cmp_eq_u32 s90, 0
  s_cselect_b32 s74, 58720256, 0
  s_add_u32 s72, s72, s74
  s_addc_u32 s73, s73, 0
  s_mov_b32 s74, 4194304
  s_mov_b32 s75, 0x20000
  s_add_u32 s64, s64, 54525952
  s_addc_u32 s65, s65, 0
  s_mov_b32 s66, 4194304
  s_mov_b32 s67, 0x20000
  s_and_b32 s60, s12, 7
  s_lshr_b32 s62, s12, 3
  s_lshl_b32 s61, s13, 2
  s_lshl_b32 s19, s25, 1
  s_add_u32 s61, s61, s19
  s_add_u32 s61, s61, s62
  s_mul_i32 s63, s13, 8
  s_add_u32 s63, s63, s60
  s_lshl_b32 s63, s63, 1
  s_add_u32 s63, s63, s62
  s_lshl_b32 s63, s63, 2
  s_add_u32 s63, s63, s14
  s_lshl_b32 s56, s61, 6
  s_mul_i32 s19, s60, 4
  s_add_u32 s56, s56, s19
  s_mul_i32 s19, s24, 2
  s_add_u32 s56, s56, s19
  s_lshl_b32 s56, s56, 10
  v_lshlrev_b32 v168, 4, v0
  s_waitcnt lgkmcnt(0)
  s_barrier
  s_barrier
  ds_read_b64_tr_b16 v[88:89], v7 offset:0
  ds_read_b64_tr_b16 v[90:91], v7 offset:1024
  ds_read_b128 v[104:107], v19 offset:0
  ds_read_b64_tr_b16 v[92:93], v10 offset:0
  ds_read_b64_tr_b16 v[94:95], v10 offset:1024
  ds_read_b128 v[108:111], v19 offset:2048
  ds_read_b64_tr_b16 v[96:97], v13 offset:0
  ds_read_b64_tr_b16 v[98:99], v13 offset:1024
  ds_read_b128 v[112:115], v19 offset:4096
  ds_read_b64_tr_b16 v[100:101], v16 offset:0
  ds_read_b64_tr_b16 v[102:103], v16 offset:1024
  ds_read_b128 v[116:119], v19 offset:6144
  s_waitcnt lgkmcnt(9)
  v_mfma_f32_16x16x32_bf16 v[24:27], v[88:91], v[104:107], 0
  ds_read_b64_tr_b16 v[120:121], v8 offset:8192
  s_waitcnt lgkmcnt(7)
  v_mfma_f32_16x16x32_bf16 v[28:31], v[88:91], v[108:111], 0
  ds_read_b64_tr_b16 v[122:123], v8 offset:9216
  v_mfma_f32_16x16x32_bf16 v[40:43], v[92:95], v[104:107], 0
  ds_read_b128 v[136:139], v20 offset:1024
  v_mfma_f32_16x16x32_bf16 v[44:47], v[92:95], v[108:111], 0
  ds_read_b64_tr_b16 v[124:125], v11 offset:8192
  s_waitcnt lgkmcnt(7)
  v_mfma_f32_16x16x32_bf16 v[32:35], v[88:91], v[112:115], 0
  ds_read_b64_tr_b16 v[126:127], v11 offset:9216
  v_mfma_f32_16x16x32_bf16 v[48:51], v[92:95], v[112:115], 0
  ds_read_b128 v[140:143], v20 offset:3072
  v_mfma_f32_16x16x32_bf16 v[56:59], v[96:99], v[104:107], 0
  ds_read_b64_tr_b16 v[128:129], v14 offset:8192
  v_mfma_f32_16x16x32_bf16 v[60:63], v[96:99], v[108:111], 0
  ds_read_b64_tr_b16 v[130:131], v14 offset:9216
  v_mfma_f32_16x16x32_bf16 v[64:67], v[96:99], v[112:115], 0
  ds_read_b128 v[144:147], v20 offset:5120
  s_waitcnt lgkmcnt(9)
  v_mfma_f32_16x16x32_bf16 v[36:39], v[88:91], v[116:119], 0
  ds_read_b64_tr_b16 v[132:133], v17 offset:8192
  v_mfma_f32_16x16x32_bf16 v[52:55], v[92:95], v[116:119], 0
  ds_read_b64_tr_b16 v[134:135], v17 offset:9216
  s_add_u32 s15, s15, 32768
  s_cmp_ge_u32 s15, 131072
  s_cselect_b32 s3, 131072, 0
  s_sub_u32 s15, s15, s3
  v_mfma_f32_16x16x32_bf16 v[68:71], v[96:99], v[116:119], 0
  ds_read_b128 v[148:151], v20 offset:7168
  v_add_u32 v7, s15, v6
  v_mfma_f32_16x16x32_bf16 v[72:75], v[100:103], v[104:107], 0
  v_add_u32 v10, s15, v9
  v_mfma_f32_16x16x32_bf16 v[76:79], v[100:103], v[108:111], 0
  v_add_u32 v13, s15, v12
  v_mfma_f32_16x16x32_bf16 v[80:83], v[100:103], v[112:115], 0
  v_add_u32 v16, s15, v15
  v_mfma_f32_16x16x32_bf16 v[84:87], v[100:103], v[116:119], 0
  v_add_u32 v19, s15, v18
  s_waitcnt lgkmcnt(9)
  v_mfma_f32_16x16x32_bf16 v[24:27], v[120:123], v[136:139], v[24:27]
  v_add_u32 v8, s15, v6
  s_waitcnt lgkmcnt(6)
  v_mfma_f32_16x16x32_bf16 v[28:31], v[120:123], v[140:143], v[28:31]
  v_add_u32 v11, s15, v9
  s_waitcnt lgkmcnt(0)
  s_barrier
  v_mfma_f32_16x16x32_bf16 v[40:43], v[124:127], v[136:139], v[40:43]
  ds_read_b64_tr_b16 v[88:89], v7 offset:0
  v_mfma_f32_16x16x32_bf16 v[44:47], v[124:127], v[140:143], v[44:47]
  ds_read_b64_tr_b16 v[90:91], v7 offset:1024
  v_mfma_f32_16x16x32_bf16 v[32:35], v[120:123], v[144:147], v[32:35]
  ds_read_b128 v[104:107], v19 offset:0
  v_mfma_f32_16x16x32_bf16 v[48:51], v[124:127], v[144:147], v[48:51]
  ds_read_b64_tr_b16 v[92:93], v10 offset:0
  v_mfma_f32_16x16x32_bf16 v[56:59], v[128:131], v[136:139], v[56:59]
  ds_read_b64_tr_b16 v[94:95], v10 offset:1024
  v_mfma_f32_16x16x32_bf16 v[60:63], v[128:131], v[140:143], v[60:63]
  ds_read_b128 v[108:111], v19 offset:2048
  v_mfma_f32_16x16x32_bf16 v[64:67], v[128:131], v[144:147], v[64:67]
  ds_read_b64_tr_b16 v[96:97], v13 offset:0
  v_mfma_f32_16x16x32_bf16 v[36:39], v[120:123], v[148:151], v[36:39]
  ds_read_b64_tr_b16 v[98:99], v13 offset:1024
  v_mfma_f32_16x16x32_bf16 v[52:55], v[124:127], v[148:151], v[52:55]
  ds_read_b128 v[112:115], v19 offset:4096
  v_mfma_f32_16x16x32_bf16 v[68:71], v[128:131], v[148:151], v[68:71]
  ds_read_b64_tr_b16 v[100:101], v16 offset:0
  v_mfma_f32_16x16x32_bf16 v[72:75], v[132:135], v[136:139], v[72:75]
  ds_read_b64_tr_b16 v[102:103], v16 offset:1024
  v_mfma_f32_16x16x32_bf16 v[76:79], v[132:135], v[140:143], v[76:79]
  ds_read_b128 v[116:119], v19 offset:6144
  v_add_u32 v14, s15, v12
  v_mfma_f32_16x16x32_bf16 v[80:83], v[132:135], v[144:147], v[80:83]
  v_add_u32 v17, s15, v15
  v_mfma_f32_16x16x32_bf16 v[84:87], v[132:135], v[148:151], v[84:87]
  v_add_u32 v20, s15, v18
  s_mov_b32 s16, 12
  .p2align 3
g5_kernel_cloop6:
  s_waitcnt lgkmcnt(9)
  v_mfma_f32_16x16x32_bf16 v[24:27], v[88:91], v[104:107], v[24:27]
  ds_read_b64_tr_b16 v[120:121], v8 offset:8192
  s_waitcnt lgkmcnt(7)
  v_mfma_f32_16x16x32_bf16 v[28:31], v[88:91], v[108:111], v[28:31]
  ds_read_b64_tr_b16 v[122:123], v8 offset:9216
  v_mfma_f32_16x16x32_bf16 v[40:43], v[92:95], v[104:107], v[40:43]
  ds_read_b128 v[136:139], v20 offset:1024
  v_mfma_f32_16x16x32_bf16 v[44:47], v[92:95], v[108:111], v[44:47]
  ds_read_b64_tr_b16 v[124:125], v11 offset:8192
  s_waitcnt lgkmcnt(7)
  v_mfma_f32_16x16x32_bf16 v[32:35], v[88:91], v[112:115], v[32:35]
  ds_read_b64_tr_b16 v[126:127], v11 offset:9216
  v_mfma_f32_16x16x32_bf16 v[48:51], v[92:95], v[112:115], v[48:51]
  ds_read_b128 v[140:143], v20 offset:3072
  v_mfma_f32_16x16x32_bf16 v[56:59], v[96:99], v[104:107], v[56:59]
  ds_read_b64_tr_b16 v[128:129], v14 offset:8192
  v_mfma_f32_16x16x32_bf16 v[60:63], v[96:99], v[108:111], v[60:63]
  ds_read_b64_tr_b16 v[130:131], v14 offset:9216
  v_mfma_f32_16x16x32_bf16 v[64:67], v[96:99], v[112:115], v[64:67]
  ds_read_b128 v[144:147], v20 offset:5120
  s_waitcnt lgkmcnt(9)
  v_mfma_f32_16x16x32_bf16 v[36:39], v[88:91], v[116:119], v[36:39]
  ds_read_b64_tr_b16 v[132:133], v17 offset:8192
  v_mfma_f32_16x16x32_bf16 v[52:55], v[92:95], v[116:119], v[52:55]
  ds_read_b64_tr_b16 v[134:135], v17 offset:9216
  s_add_u32 s15, s15, 32768
  s_cmp_ge_u32 s15, 131072
  s_cselect_b32 s3, 131072, 0
  s_sub_u32 s15, s15, s3
  v_mfma_f32_16x16x32_bf16 v[68:71], v[96:99], v[116:119], v[68:71]
  ds_read_b128 v[148:151], v20 offset:7168
  v_add_u32 v7, s15, v6
  v_mfma_f32_16x16x32_bf16 v[72:75], v[100:103], v[104:107], v[72:75]
  v_add_u32 v10, s15, v9
  v_mfma_f32_16x16x32_bf16 v[76:79], v[100:103], v[108:111], v[76:79]
  v_add_u32 v13, s15, v12
  v_mfma_f32_16x16x32_bf16 v[80:83], v[100:103], v[112:115], v[80:83]
  v_add_u32 v16, s15, v15
  v_mfma_f32_16x16x32_bf16 v[84:87], v[100:103], v[116:119], v[84:87]
  v_add_u32 v19, s15, v18
  s_waitcnt lgkmcnt(9)
  v_mfma_f32_16x16x32_bf16 v[24:27], v[120:123], v[136:139], v[24:27]
  v_add_u32 v8, s15, v6
  s_waitcnt lgkmcnt(6)
  v_mfma_f32_16x16x32_bf16 v[28:31], v[120:123], v[140:143], v[28:31]
  v_add_u32 v11, s15, v9
  s_waitcnt lgkmcnt(0)
  s_barrier
  v_mfma_f32_16x16x32_bf16 v[40:43], v[124:127], v[136:139], v[40:43]
  ds_read_b64_tr_b16 v[88:89], v7 offset:0
  v_mfma_f32_16x16x32_bf16 v[44:47], v[124:127], v[140:143], v[44:47]
  ds_read_b64_tr_b16 v[90:91], v7 offset:1024
  v_mfma_f32_16x16x32_bf16 v[32:35], v[120:123], v[144:147], v[32:35]
  ds_read_b128 v[104:107], v19 offset:0
  v_mfma_f32_16x16x32_bf16 v[48:51], v[124:127], v[144:147], v[48:51]
  ds_read_b64_tr_b16 v[92:93], v10 offset:0
  v_mfma_f32_16x16x32_bf16 v[56:59], v[128:131], v[136:139], v[56:59]
  ds_read_b64_tr_b16 v[94:95], v10 offset:1024
  v_mfma_f32_16x16x32_bf16 v[60:63], v[128:131], v[140:143], v[60:63]
  ds_read_b128 v[108:111], v19 offset:2048
  v_mfma_f32_16x16x32_bf16 v[64:67], v[128:131], v[144:147], v[64:67]
  ds_read_b64_tr_b16 v[96:97], v13 offset:0
  v_mfma_f32_16x16x32_bf16 v[36:39], v[120:123], v[148:151], v[36:39]
  ds_read_b64_tr_b16 v[98:99], v13 offset:1024
  v_mfma_f32_16x16x32_bf16 v[52:55], v[124:127], v[148:151], v[52:55]
  ds_read_b128 v[112:115], v19 offset:4096
  v_mfma_f32_16x16x32_bf16 v[68:71], v[128:131], v[148:151], v[68:71]
  ds_read_b64_tr_b16 v[100:101], v16 offset:0
  v_mfma_f32_16x16x32_bf16 v[72:75], v[132:135], v[136:139], v[72:75]
  ds_read_b64_tr_b16 v[102:103], v16 offset:1024
  v_mfma_f32_16x16x32_bf16 v[76:79], v[132:135], v[140:143], v[76:79]
  ds_read_b128 v[116:119], v19 offset:6144
  v_add_u32 v14, s15, v12
  v_mfma_f32_16x16x32_bf16 v[80:83], v[132:135], v[144:147], v[80:83]
  v_add_u32 v17, s15, v15
  v_mfma_f32_16x16x32_bf16 v[84:87], v[132:135], v[148:151], v[84:87]
  v_add_u32 v20, s15, v18
  s_cmp_lg_u32 s16, 2
  s_cbranch_scc1 g5_kernel_late7
  s_add_u32 s26, s56, 0
  buffer_load_dwordx4 v[152:155], v168, s[72:75], s26 offen offset:0
  buffer_load_dwordx4 v[156:159], v168, s[72:75], s26 offen offset:1024
  s_add_u32 s26, s56, 32768
  buffer_load_dwordx4 v[160:163], v168, s[72:75], s26 offen offset:0
  buffer_load_dwordx4 v[164:167], v168, s[72:75], s26 offen offset:1024
g5_kernel_late7:
  s_sub_u32 s16, s16, 1
  s_cmp_lg_u32 s16, 0
  s_cbranch_scc1 g5_kernel_cloop6
  s_waitcnt lgkmcnt(9)
  v_mfma_f32_16x16x32_bf16 v[24:27], v[88:91], v[104:107], v[24:27]
  ds_read_b64_tr_b16 v[120:121], v8 offset:8192
  s_waitcnt lgkmcnt(7)
  v_mfma_f32_16x16x32_bf16 v[28:31], v[88:91], v[108:111], v[28:31]
  ds_read_b64_tr_b16 v[122:123], v8 offset:9216
  v_mfma_f32_16x16x32_bf16 v[40:43], v[92:95], v[104:107], v[40:43]
  ds_read_b128 v[136:139], v20 offset:1024
  v_mfma_f32_16x16x32_bf16 v[44:47], v[92:95], v[108:111], v[44:47]
  ds_read_b64_tr_b16 v[124:125], v11 offset:8192
  s_waitcnt lgkmcnt(7)
  v_mfma_f32_16x16x32_bf16 v[32:35], v[88:91], v[112:115], v[32:35]
  ds_read_b64_tr_b16 v[126:127], v11 offset:9216
  v_mfma_f32_16x16x32_bf16 v[48:51], v[92:95], v[112:115], v[48:51]
  ds_read_b128 v[140:143], v20 offset:3072
  v_mfma_f32_16x16x32_bf16 v[56:59], v[96:99], v[104:107], v[56:59]
  ds_read_b64_tr_b16 v[128:129], v14 offset:8192
  v_mfma_f32_16x16x32_bf16 v[60:63], v[96:99], v[108:111], v[60:63]
  ds_read_b64_tr_b16 v[130:131], v14 offset:9216
  v_mfma_f32_16x16x32_bf16 v[64:67], v[96:99], v[112:115], v[64:67]
  ds_read_b128 v[144:147], v20 offset:5120
  s_waitcnt lgkmcnt(9)
  v_mfma_f32_16x16x32_bf16 v[36:39], v[88:91], v[116:119], v[36:39]
  ds_read_b64_tr_b16 v[132:133], v17 offset:8192
  v_mfma_f32_16x16x32_bf16 v[52:55], v[92:95], v[116:119], v[52:55]
  ds_read_b64_tr_b16 v[134:135], v17 offset:9216
  v_mfma_f32_16x16x32_bf16 v[68:71], v[96:99], v[116:119], v[68:71]
  ds_read_b128 v[148:151], v20 offset:7168
  v_mfma_f32_16x16x32_bf16 v[72:75], v[100:103], v[104:107], v[72:75]
  v_mfma_f32_16x16x32_bf16 v[76:79], v[100:103], v[108:111], v[76:79]
  v_mfma_f32_16x16x32_bf16 v[80:83], v[100:103], v[112:115], v[80:83]
  v_mfma_f32_16x16x32_bf16 v[84:87], v[100:103], v[116:119], v[84:87]
  s_waitcnt lgkmcnt(9)
  v_mfma_f32_16x16x32_bf16 v[24:27], v[120:123], v[136:139], v[24:27]
  s_waitcnt lgkmcnt(6)
  v_mfma_f32_16x16x32_bf16 v[28:31], v[120:123], v[140:143], v[28:31]
  v_mfma_f32_16x16x32_bf16 v[40:43], v[124:127], v[136:139], v[40:43]
  v_mfma_f32_16x16x32_bf16 v[44:47], v[124:127], v[140:143], v[44:47]
  s_waitcnt lgkmcnt(3)
  v_mfma_f32_16x16x32_bf16 v[32:35], v[120:123], v[144:147], v[32:35]
  v_mfma_f32_16x16x32_bf16 v[48:51], v[124:127], v[144:147], v[48:51]
  v_mfma_f32_16x16x32_bf16 v[56:59], v[128:131], v[136:139], v[56:59]
  v_mfma_f32_16x16x32_bf16 v[60:63], v[128:131], v[140:143], v[60:63]
  v_mfma_f32_16x16x32_bf16 v[64:67], v[128:131], v[144:147], v[64:67]
  s_waitcnt lgkmcnt(0)
  v_mfma_f32_16x16x32_bf16 v[36:39], v[120:123], v[148:151], v[36:39]
  v_mfma_f32_16x16x32_bf16 v[52:55], v[124:127], v[148:151], v[52:55]
  v_mfma_f32_16x16x32_bf16 v[68:71], v[128:131], v[148:151], v[68:71]
  v_mfma_f32_16x16x32_bf16 v[72:75], v[132:135], v[136:139], v[72:75]
  v_mfma_f32_16x16x32_bf16 v[76:79], v[132:135], v[140:143], v[76:79]
  v_mfma_f32_16x16x32_bf16 v[80:83], v[132:135], v[144:147], v[80:83]
  v_mfma_f32_16x16x32_bf16 v[84:87], v[132:135], v[148:151], v[84:87]
  s_barrier
  s_lshl_b32 s26, s63, 12
  s_mov_b32 s58, 1
  v_cvt_pk_bf16_f32 v88, v32, v33
  v_cvt_pk_bf16_f32 v89, v34, v35
  v_cvt_pk_bf16_f32 v90, v36, v37
  v_cvt_pk_bf16_f32 v91, v38, v39
  v_and_or_b32 v88, v88, -2, s58
  buffer_store_dwordx4 v[88:91], v168, s[64:67], s26 offen offset:0 sc1
  v_cvt_pk_bf16_f32 v92, v48, v49
  v_cvt_pk_bf16_f32 v93, v50, v51
  v_cvt_pk_bf16_f32 v94, v52, v53
  v_cvt_pk_bf16_f32 v95, v54, v55
  v_and_or_b32 v92, v92, -2, s58
  buffer_store_dwordx4 v[92:95], v168, s[64:67], s26 offen offset:1024 sc1
  v_cvt_pk_bf16_f32 v96, v64, v65
  v_cvt_pk_bf16_f32 v97, v66, v67
  v_cvt_pk_bf16_f32 v98, v68, v69
  v_cvt_pk_bf16_f32 v99, v70, v71
  v_and_or_b32 v96, v96, -2, s58
  buffer_store_dwordx4 v[96:99], v168, s[64:67], s26 offen offset:2048 sc1
  v_cvt_pk_bf16_f32 v100, v80, v81
  v_cvt_pk_bf16_f32 v101, v82, v83
  v_cvt_pk_bf16_f32 v102, v84, v85
  v_cvt_pk_bf16_f32 v103, v86, v87
  v_and_or_b32 v100, v100, -2, s58
  buffer_store_dwordx4 v[100:103], v168, s[64:67], s26 offen offset:3072 sc1
  s_xor_b32 s27, s26, 0x4000
  s_mov_b32 s59, 0
  s_mov_b32 s19, 0xffff0000
  s_waitcnt vmcnt(4)
  v_permlane32_swap_b32 v24, v40
  v_permlane32_swap_b32 v25, v41
  v_permlane32_swap_b32 v26, v42
  v_permlane32_swap_b32 v27, v43
  v_permlane32_swap_b32 v56, v72
  v_permlane32_swap_b32 v57, v73
  v_permlane32_swap_b32 v58, v74
  v_permlane32_swap_b32 v59, v75
  v_permlane32_swap_b32 v28, v44
  v_permlane32_swap_b32 v29, v45
  v_permlane32_swap_b32 v30, v46
  v_permlane32_swap_b32 v31, v47
  v_permlane32_swap_b32 v60, v76
  v_permlane32_swap_b32 v61, v77
  v_permlane32_swap_b32 v62, v78
  v_permlane32_swap_b32 v63, v79
  v_permlane16_swap_b32 v24, v40
  v_permlane16_swap_b32 v25, v41
  v_permlane16_swap_b32 v26, v42
  v_permlane16_swap_b32 v27, v43
  v_permlane16_swap_b32 v56, v72
  v_permlane16_swap_b32 v57, v73
  v_permlane16_swap_b32 v58, v74
  v_permlane16_swap_b32 v59, v75
  v_permlane16_swap_b32 v28, v44
  v_permlane16_swap_b32 v29, v45
  v_permlane16_swap_b32 v30, v46
  v_permlane16_swap_b32 v31, v47
  v_permlane16_swap_b32 v60, v76
  v_permlane16_swap_b32 v61, v77
  v_permlane16_swap_b32 v62, v78
  v_permlane16_swap_b32 v63, v79
  v_lshlrev_b32 v104, 16, v152
  v_and_b32 v105, s19, v152
  v_pk_add_f32 v[24:25], v[24:25], v[104:105] op_sel:[0,0] op_sel_hi:[1,1]
  v_lshlrev_b32 v106, 16, v153
  v_and_b32 v107, s19, v153
  v_pk_add_f32 v[26:27], v[26:27], v[106:107] op_sel:[0,0] op_sel_hi:[1,1]
  v_lshlrev_b32 v108, 16, v154
  v_and_b32 v109, s19, v154
  v_pk_add_f32 v[40:41], v[40:41], v[108:109] op_sel:[0,0] op_sel_hi:[1,1]
  v_lshlrev_b32 v110, 16, v155
  v_and_b32 v111, s19, v155
  v_pk_add_f32 v[42:43], v[42:43], v[110:111] op_sel:[0,0] op_sel_hi:[1,1]
  v_lshlrev_b32 v104, 16, v156
  v_and_b32 v105, s19, v156
  v_pk_add_f32 v[56:57], v[56:57], v[104:105] op_sel:[0,0] op_sel_hi:[1,1]
  v_lshlrev_b32 v106, 16, v157
  v_and_b32 v107, s19, v157
  v_pk_add_f32 v[58:59], v[58:59], v[106:107] op_sel:[0,0] op_sel_hi:[1,1]
  v_lshlrev_b32 v108, 16, v158
  v_and_b32 v109, s19, v158
  v_pk_add_f32 v[72:73], v[72:73], v[108:109] op_sel:[0,0] op_sel_hi:[1,1]
  v_lshlrev_b32 v110, 16, v159
  v_and_b32 v111, s19, v159
  v_pk_add_f32 v[74:75], v[74:75], v[110:111] op_sel:[0,0] op_sel_hi:[1,1]
  v_lshlrev_b32 v104, 16, v160
  v_and_b32 v105, s19, v160
  v_pk_add_f32 v[28:29], v[28:29], v[104:105] op_sel:[0,0] op_sel_hi:[1,1]
  v_lshlrev_b32 v106, 16, v161
  v_and_b32 v107, s19, v161
  v_pk_add_f32 v[30:31], v[30:31], v[106:107] op_sel:[0,0] op_sel_hi:[1,1]
  v_lshlrev_b32 v108, 16, v162
  v_and_b32 v109, s19, v162
  v_pk_add_f32 v[44:45], v[44:45], v[108:109] op_sel:[0,0] op_sel_hi:[1,1]
  v_lshlrev_b32 v110, 16, v163
  v_and_b32 v111, s19, v163
  v_pk_add_f32 v[46:47], v[46:47], v[110:111] op_sel:[0,0] op_sel_hi:[1,1]
  v_lshlrev_b32 v104, 16, v164
  v_and_b32 v105, s19, v164
  v_pk_add_f32 v[60:61], v[60:61], v[104:105] op_sel:[0,0] op_sel_hi:[1,1]
  v_lshlrev_b32 v106, 16, v165
  v_and_b32 v107, s19, v165
  v_pk_add_f32 v[62:63], v[62:63], v[106:107] op_sel:[0,0] op_sel_hi:[1,1]
  v_lshlrev_b32 v108, 16, v166
  v_and_b32 v109, s19, v166
  v_pk_add_f32 v[76:77], v[76:77], v[108:109] op_sel:[0,0] op_sel_hi:[1,1]
  v_lshlrev_b32 v110, 16, v167
  v_and_b32 v111, s19, v167
  v_pk_add_f32 v[78:79], v[78:79], v[110:111] op_sel:[0,0] op_sel_hi:[1,1]
  s_waitcnt vmcnt(0)
g5_kernel_xp8:
  buffer_load_dwordx4 v[120:123], v168, s[64:67], s27 offen offset:0 sc1
  buffer_load_dwordx4 v[124:127], v168, s[64:67], s27 offen offset:1024 sc1
  buffer_load_dwordx4 v[128:131], v168, s[64:67], s27 offen offset:2048 sc1
  buffer_load_dwordx4 v[132:135], v168, s[64:67], s27 offen offset:3072 sc1
  s_add_u32 s59, s59, 1
  s_waitcnt vmcnt(0)
  v_xor_b32 v2, s58, v120
  v_xor_b32 v3, s58, v124
  v_xor_b32 v4, s58, v128
  v_xor_b32 v5, s58, v132
  v_or3_b32 v2, v2, v3, v4
  v_or_b32 v2, v2, v5
  v_and_b32 v2, 1, v2
  v_cmp_eq_u32 vcc, 1, v2
  s_cmp_ge_u32 s59, 0x10000
  s_cbranch_vccz g5_kernel_xd9
  s_cbranch_scc0 g5_kernel_xp8
g5_kernel_xd9:
  v_permlane32_swap_b32 v120, v124
  v_permlane32_swap_b32 v121, v125
  v_permlane32_swap_b32 v122, v126
  v_permlane32_swap_b32 v123, v127
  v_permlane32_swap_b32 v128, v132
  v_permlane32_swap_b32 v129, v133
  v_permlane32_swap_b32 v130, v134
  v_permlane32_swap_b32 v131, v135
  v_permlane16_swap_b32 v120, v124
  v_permlane16_swap_b32 v121, v125
  v_permlane16_swap_b32 v122, v126
  v_permlane16_swap_b32 v123, v127
  v_permlane16_swap_b32 v128, v132
  v_permlane16_swap_b32 v129, v133
  v_permlane16_swap_b32 v130, v134
  v_permlane16_swap_b32 v131, v135
  v_lshlrev_b32 v104, 16, v120
  v_and_b32 v105, s19, v120
  v_pk_add_f32 v[24:25], v[24:25], v[104:105] op_sel:[0,0] op_sel_hi:[1,1]
  v_lshlrev_b32 v106, 16, v121
  v_and_b32 v107, s19, v121
  v_pk_add_f32 v[26:27], v[26:27], v[106:107] op_sel:[0,0] op_sel_hi:[1,1]
  v_lshlrev_b32 v108, 16, v124
  v_and_b32 v109, s19, v124
  v_pk_add_f32 v[40:41], v[40:41], v[108:109] op_sel:[0,0] op_sel_hi:[1,1]
  v_lshlrev_b32 v110, 16, v125
  v_and_b32 v111, s19, v125
  v_pk_add_f32 v[42:43], v[42:43], v[110:111] op_sel:[0,0] op_sel_hi:[1,1]
  v_lshlrev_b32 v104, 16, v128
  v_and_b32 v105, s19, v128
  v_pk_add_f32 v[56:57], v[56:57], v[104:105] op_sel:[0,0] op_sel_hi:[1,1]
  v_lshlrev_b32 v106, 16, v129
  v_and_b32 v107, s19, v129
  v_pk_add_f32 v[58:59], v[58:59], v[106:107] op_sel:[0,0] op_sel_hi:[1,1]
  v_lshlrev_b32 v108, 16, v132
  v_and_b32 v109, s19, v132
  v_pk_add_f32 v[72:73], v[72:73], v[108:109] op_sel:[0,0] op_sel_hi:[1,1]
  v_lshlrev_b32 v110, 16, v133
  v_and_b32 v111, s19, v133
  v_pk_add_f32 v[74:75], v[74:75], v[110:111] op_sel:[0,0] op_sel_hi:[1,1]
  v_lshlrev_b32 v104, 16, v122
  v_and_b32 v105, s19, v122
  v_pk_add_f32 v[28:29], v[28:29], v[104:105] op_sel:[0,0] op_sel_hi:[1,1]
  v_lshlrev_b32 v106, 16, v123
  v_and_b32 v107, s19, v123
  v_pk_add_f32 v[30:31], v[30:31], v[106:107] op_sel:[0,0] op_sel_hi:[1,1]
  v_lshlrev_b32 v108, 16, v126
  v_and_b32 v109, s19, v126
  v_pk_add_f32 v[44:45], v[44:45], v[108:109] op_sel:[0,0] op_sel_hi:[1,1]
  v_lshlrev_b32 v110, 16, v127
  v_and_b32 v111, s19, v127
  v_pk_add_f32 v[46:47], v[46:47], v[110:111] op_sel:[0,0] op_sel_hi:[1,1]
  v_lshlrev_b32 v104, 16, v130
  v_and_b32 v105, s19, v130
  v_pk_add_f32 v[60:61], v[60:61], v[104:105] op_sel:[0,0] op_sel_hi:[1,1]
  v_lshlrev_b32 v106, 16, v131
  v_and_b32 v107, s19, v131
  v_pk_add_f32 v[62:63], v[62:63], v[106:107] op_sel:[0,0] op_sel_hi:[1,1]
  v_lshlrev_b32 v108, 16, v134
  v_and_b32 v109, s19, v134
  v_pk_add_f32 v[76:77], v[76:77], v[108:109] op_sel:[0,0] op_sel_hi:[1,1]
  v_lshlrev_b32 v110, 16, v135
  v_and_b32 v111, s19, v135
  v_pk_add_f32 v[78:79], v[78:79], v[110:111] op_sel:[0,0] op_sel_hi:[1,1]
  s_waitcnt vmcnt(0)
  s_mov_b32 s19, 0xffff0000
  s_add_u32 s26, s56, 0
  v_cvt_pk_bf16_f32 v152, v24, v25
  v_cvt_pk_bf16_f32 v153, v26, v27
  v_cvt_pk_bf16_f32 v154, v40, v41
  v_cvt_pk_bf16_f32 v155, v42, v43
  buffer_store_dwordx4 v[152:155], v168, s[28:31], s26 offen offset:0 sc0 sc1
  v_cvt_pk_bf16_f32 v156, v56, v57
  v_cvt_pk_bf16_f32 v157, v58, v59
  v_cvt_pk_bf16_f32 v158, v72, v73
  v_cvt_pk_bf16_f32 v159, v74, v75
  buffer_store_dwordx4 v[156:159], v168, s[28:31], s26 offen offset:1024 sc0 sc1
  s_add_u32 s26, s56, 32768
  v_cvt_pk_bf16_f32 v160, v28, v29
  v_cvt_pk_bf16_f32 v161, v30, v31
  v_cvt_pk_bf16_f32 v162, v44, v45
  v_cvt_pk_bf16_f32 v163, v46, v47
  buffer_store_dwordx4 v[160:163], v168, s[28:31], s26 offen offset:0 sc0 sc1
  v_cvt_pk_bf16_f32 v164, v60, v61
  v_cvt_pk_bf16_f32 v165, v62, v63
  v_cvt_pk_bf16_f32 v166, v76, v77
  v_cvt_pk_bf16_f32 v167, v78, v79
  buffer_store_dwordx4 v[164:167], v168, s[28:31], s26 offen offset:1024 sc0 sc1
  v_lshlrev_b32 v24, 16, v152
  v_and_b32 v25, s19, v152
  v_mov_b32 v120, v24
  v_mov_b32 v121, v25
  v_pk_mul_f32 v[122:123], v[24:25], v[24:25] op_sel:[0,0] op_sel_hi:[1,1]
  v_lshlrev_b32 v26, 16, v153
  v_and_b32 v27, s19, v153
  v_pk_add_f32 v[120:121], v[120:121], v[26:27] op_sel:[0,0] op_sel_hi:[1,1]
  v_pk_fma_f32 v[122:123], v[26:27], v[26:27], v[122:123] op_sel:[0,0,0] op_sel_hi:[1,1,1]
  v_lshlrev_b32 v40, 16, v154
  v_and_b32 v41, s19, v154
  v_pk_add_f32 v[120:121], v[120:121], v[40:41] op_sel:[0,0] op_sel_hi:[1,1]
  v_pk_fma_f32 v[122:123], v[40:41], v[40:41], v[122:123] op_sel:[0,0,0] op_sel_hi:[1,1,1]
  v_lshlrev_b32 v42, 16, v155
  v_and_b32 v43, s19, v155
  v_pk_add_f32 v[120:121], v[120:121], v[42:43] op_sel:[0,0] op_sel_hi:[1,1]
  v_pk_fma_f32 v[122:123], v[42:43], v[42:43], v[122:123] op_sel:[0,0,0] op_sel_hi:[1,1,1]
  v_lshlrev_b32 v56, 16, v156
  v_and_b32 v57, s19, v156
  v_pk_add_f32 v[120:121], v[120:121], v[56:57] op_sel:[0,0] op_sel_hi:[1,1]
  v_pk_fma_f32 v[122:123], v[56:57], v[56:57], v[122:123] op_sel:[0,0,0] op_sel_hi:[1,1,1]
  v_lshlrev_b32 v58, 16, v157
  v_and_b32 v59, s19, v157
  v_pk_add_f32 v[120:121], v[120:121], v[58:59] op_sel:[0,0] op_sel_hi:[1,1]
  v_pk_fma_f32 v[122:123], v[58:59], v[58:59], v[122:123] op_sel:[0,0,0] op_sel_hi:[1,1,1]
  v_lshlrev_b32 v72, 16, v158
  v_and_b32 v73, s19, v158
  v_pk_add_f32 v[120:121], v[120:121], v[72:73] op_sel:[0,0] op_sel_hi:[1,1]
  v_pk_fma_f32 v[122:123], v[72:73], v[72:73], v[122:123] op_sel:[0,0,0] op_sel_hi:[1,1,1]
  v_lshlrev_b32 v74, 16, v159
  v_and_b32 v75, s19, v159
  v_pk_add_f32 v[120:121], v[120:121], v[74:75] op_sel:[0,0] op_sel_hi:[1,1]
  v_pk_fma_f32 v[122:123], v[74:75], v[74:75], v[122:123] op_sel:[0,0,0] op_sel_hi:[1,1,1]
  v_lshlrev_b32 v28, 16, v160
  v_and_b32 v29, s19, v160
  v_mov_b32 v124, v28
  v_mov_b32 v125, v29
  v_pk_mul_f32 v[126:127], v[28:29], v[28:29] op_sel:[0,0] op_sel_hi:[1,1]
  v_lshlrev_b32 v30, 16, v161
  v_and_b32 v31, s19, v161
  v_pk_add_f32 v[124:125], v[124:125], v[30:31] op_sel:[0,0] op_sel_hi:[1,1]
  v_pk_fma_f32 v[126:127], v[30:31], v[30:31], v[126:127] op_sel:[0,0,0] op_sel_hi:[1,1,1]
  v_lshlrev_b32 v44, 16, v162
  v_and_b32 v45, s19, v162
  v_pk_add_f32 v[124:125], v[124:125], v[44:45] op_sel:[0,0] op_sel_hi:[1,1]
  v_pk_fma_f32 v[126:127], v[44:45], v[44:45], v[126:127] op_sel:[0,0,0] op_sel_hi:[1,1,1]
  v_lshlrev_b32 v46, 16, v163
  v_and_b32 v47, s19, v163
  v_pk_add_f32 v[124:125], v[124:125], v[46:47] op_sel:[0,0] op_sel_hi:[1,1]
  v_pk_fma_f32 v[126:127], v[46:47], v[46:47], v[126:127] op_sel:[0,0,0] op_sel_hi:[1,1,1]
  v_lshlrev_b32 v60, 16, v164
  v_and_b32 v61, s19, v164
  v_pk_add_f32 v[124:125], v[124:125], v[60:61] op_sel:[0,0] op_sel_hi:[1,1]
  v_pk_fma_f32 v[126:127], v[60:61], v[60:61], v[126:127] op_sel:[0,0,0] op_sel_hi:[1,1,1]
  v_lshlrev_b32 v62, 16, v165
  v_and_b32 v63, s19, v165
  v_pk_add_f32 v[124:125], v[124:125], v[62:63] op_sel:[0,0] op_sel_hi:[1,1]
  v_pk_fma_f32 v[126:127], v[62:63], v[62:63], v[126:127] op_sel:[0,0,0] op_sel_hi:[1,1,1]
  v_lshlrev_b32 v76, 16, v166
  v_and_b32 v77, s19, v166
  v_pk_add_f32 v[124:125], v[124:125], v[76:77] op_sel:[0,0] op_sel_hi:[1,1]
  v_pk_fma_f32 v[126:127], v[76:77], v[76:77], v[126:127] op_sel:[0,0,0] op_sel_hi:[1,1,1]
  v_lshlrev_b32 v78, 16, v167
  v_and_b32 v79, s19, v167
  v_pk_add_f32 v[124:125], v[124:125], v[78:79] op_sel:[0,0] op_sel_hi:[1,1]
  v_pk_fma_f32 v[126:127], v[78:79], v[78:79], v[126:127] op_sel:[0,0,0] op_sel_hi:[1,1,1]
  v_add_f32 v120, v120, v121
  v_add_f32 v122, v122, v123
  v_add_f32 v124, v124, v125
  v_add_f32 v126, v126, v127
  v_permlane32_swap_b32 v120, v122
  s_nop 0
  v_permlane32_swap_b32 v124, v126
  v_add_f32 v120, v120, v122
  v_add_f32 v124, v124, v126
  v_and_b32 v2, 15, v0
  v_and_b32 v3, 15, v0
  v_and_b32 v3, 12, v3
  v_add_u32 v2, v2, v3
  v_lshrrev_b32 v3, 4, v0
  v_and_b32 v3, 1, v3
  v_lshlrev_b32 v3, 2, v3
  v_add_u32 v2, v2, v3
  v_lshlrev_b32 v2, 3, v2
  v_lshrrev_b32 v3, 4, v0
  v_lshrrev_b32 v3, 1, v3
  v_lshlrev_b32 v3, 2, v3
  v_add_u32 v2, v2, v3
  s_lshr_b32 s3, s61, 2
  s_lshl_b32 s3, s3, 14
  s_and_b32 s19, s61, 3
  s_lshl_b32 s19, s19, 8
  s_add_u32 s3, s3, s19
  s_mul_i32 s19, s60, 2048
  s_add_u32 s3, s3, s19
  s_lshl_b32 s19, s24, 10
  s_add_u32 s3, s3, s19
  v_permlane16_swap_b32 v120, v124
  v_add_f32 v120, v120, v124
  buffer_store_dword v120, v2, s[32:35], s3 offen sc0 sc1
g5_kernel_fin:
  s_load_dwordx2 s[96:97], s[0:1], 96
  s_cmp_lg_u32 s90, 0
  s_cselect_b32 s19, 0, 4
  s_lshl_b32 s19, s19, 15
  s_lshl_b32 s3, s13, 4
  s_add_u32 s3, s3, s12
  s_lshl_b32 s3, s3, 7
  s_add_u32 s3, s3, s19
  v_mov_b32 v2, 0
  v_mov_b32 v3, 1
  s_waitcnt lgkmcnt(0)
  s_add_u32 s96, s96, 63963136
  s_addc_u32 s97, s97, 0
  s_mov_b32 s98, 262144
  s_mov_b32 s99, 0x20000
  s_waitcnt vmcnt(0)
  s_barrier
  s_cmp_lg_u32 s14, 0
  s_cbranch_scc1 g5_kernel_nb10
  buffer_store_dword v3, v2, s[96:99], s3 offen sc1
g5_kernel_nb10:
  s_mov_b32 s90, 0
  s_branch g1b_kernel_fe
g5_kernel_end:
  s_endpgm
.p2align 6
g5f_kernel_fe:
  s_load_dwordx2 s[4:5], s[0:1], 72
  s_load_dwordx2 s[8:9], s[0:1], 96
  s_and_b32 s3, s2, 7
  s_lshr_b32 s16, s2, 3
  s_and_b32 s12, s3, 1
  s_mul_i32 s12, s12, 8
  s_lshr_b32 s13, s3, 1
  s_mul_i32 s13, s13, 4
  s_and_b32 s3, s16, 7
  s_add_u32 s12, s12, s3
  s_lshr_b32 s16, s16, 3
  s_add_u32 s13, s13, s16
  s_mov_b32 s15, 0
  s_cmp_lt_u32 s14, 4
  s_cbranch_scc1 g5f_kernel_comp
  s_sub_u32 s24, s14, 4
  s_setprio 2
  s_mul_i32 s83, s13, 458752
  s_lshr_b32 s3, s12, 3
  s_mul_i32 s97, s3, 114688
  s_mul_i32 s3, s3, 28672
  s_add_u32 s83, s83, s3
  s_lshr_b32 s3, s24, 1
  s_mul_i32 s3, s3, 57344
  s_add_u32 s83, s83, s3
  s_and_b32 s3, s24, 1
  s_lshl_b32 s3, s3, 10
  s_add_u32 s83, s83, s3
  s_mul_i32 s85, s24, 1024
  s_add_u32 s85, s85, 16384
  v_lshlrev_b32 v6, 4, v0
  v_add_u32 v6, s83, v6
  s_and_b32 s3, s12, 7
  s_mul_i32 s82, s3, 256
  s_lshr_b32 s3, s12, 3
  s_mul_i32 s3, s3, 1835008
  s_add_u32 s82, s82, s3
  s_mul_i32 s3, s24, 8192
  s_add_u32 s82, s82, s3
  s_mul_i32 s84, s24, 1024
  v_lshrrev_b32 v7, 4, v0
  v_lshlrev_b32 v7, 11, v7
  v_and_b32 v2, 15, v0
  v_lshrrev_b32 v3, 4, v0
  v_lshlrev_b32 v3, 1, v3
  v_xor_b32 v2, v2, v3
  v_lshlrev_b32 v2, 4, v2
  v_add_u32 v7, v7, v2
  s_lshr_b32 s3, s24, 1
  s_lshl_b32 s3, s3, 7
  v_xor_b32 v7, s3, v7
  v_add_u32 v7, s82, v7
  s_mov_b32 s17, 0
  s_mov_b32 s18, 0
  s_mov_b32 s80, 0
  s_mul_i32 s81, s12, 1
  s_mul_i32 s3, s13, 1
  s_add_u32 s81, s81, s3
  s_and_b32 s81, s81, 3
  s_mul_i32 s81, s81, 2
  s_mov_b32 s16, 0
  s_waitcnt lgkmcnt(0)
  s_mov_b32 s6, 3670016
  s_mov_b32 s7, 0x20000
  s_add_u32 s8, s8, 33554432
  s_addc_u32 s9, s9, 0
  s_cmp_eq_u32 s90, 0
  s_cselect_b32 s10, 67108864, 0
  s_add_u32 s8, s8, s10
  s_addc_u32 s9, s9, 0
  s_mov_b32 s10, 7340032
  s_mov_b32 s11, 0x20000
  s_add_u32 s3, s80, s81
  s_cmp_lt_u32 s80, 7
  s_cselect_b32 s19, 7, 14
  s_cmp_ge_u32 s3, s19
  s_cselect_b32 s19, 7, 0
  s_sub_u32 s3, s3, s19
  s_mul_i32 s17, s3, 131072
  s_mul_i32 s18, s3, 2048
  s_barrier
g5f_kernel_nsg3:
  s_add_u32 s26, s15, s84
  s_mov_b32 m0, s26
  s_nop 0
  buffer_load_dwordx4 v7, s[4:7], s17 offen lds
  s_add_u32 m0, s26, 4096
  s_add_u32 s27, s17, 32768
  buffer_load_dwordx4 v7, s[4:7], s27 offen lds
  s_add_u32 m0, s26, 8192
  s_add_u32 s27, s17, 65536
  buffer_load_dwordx4 v7, s[4:7], s27 offen lds
  s_add_u32 m0, s26, 12288
  s_add_u32 s27, s17, 98304
  buffer_load_dwordx4 v7, s[4:7], s27 offen lds
  s_add_u32 s15, s15, 32768
  s_cmp_eq_u32 s15, 131072
  s_cselect_b32 s15, 0, s15
  s_add_u32 s80, s80, 1
  s_add_u32 s3, s80, s81
  s_cmp_lt_u32 s80, 7
  s_cselect_b32 s19, 7, 14
  s_cmp_ge_u32 s3, s19
  s_cselect_b32 s19, 7, 0
  s_sub_u32 s3, s3, s19
  s_mul_i32 s17, s3, 131072
  s_mul_i32 s18, s3, 2048
  s_add_u32 s26, s15, s84
  s_mov_b32 m0, s26
  s_nop 0
  buffer_load_dwordx4 v7, s[4:7], s17 offen lds
  s_add_u32 m0, s26, 4096
  s_add_u32 s27, s17, 32768
  buffer_load_dwordx4 v7, s[4:7], s27 offen lds
  s_add_u32 m0, s26, 8192
  s_add_u32 s27, s17, 65536
  buffer_load_dwordx4 v7, s[4:7], s27 offen lds
  s_add_u32 m0, s26, 12288
  s_add_u32 s27, s17, 98304
  buffer_load_dwordx4 v7, s[4:7], s27 offen lds
  s_add_u32 s15, s15, 32768
  s_cmp_eq_u32 s15, 131072
  s_cselect_b32 s15, 0, s15
  s_add_u32 s80, s80, 1
  s_add_u32 s3, s80, s81
  s_cmp_lt_u32 s80, 7
  s_cselect_b32 s19, 7, 14
  s_cmp_ge_u32 s3, s19
  s_cselect_b32 s19, 7, 0
  s_sub_u32 s3, s3, s19
  s_mul_i32 s17, s3, 131072
  s_mul_i32 s18, s3, 2048
  s_add_u32 s26, s15, s84
  s_mov_b32 m0, s26
  s_nop 0
  buffer_load_dwordx4 v7, s[4:7], s17 offen lds
  s_add_u32 m0, s26, 4096
  s_add_u32 s27, s17, 32768
  buffer_load_dwordx4 v7, s[4:7], s27 offen lds
  s_add_u32 m0, s26, 8192
  s_add_u32 s27, s17, 65536
  buffer_load_dwordx4 v7, s[4:7], s27 offen lds
  s_add_u32 m0, s26, 12288
  s_add_u32 s27, s17, 98304
  buffer_load_dwordx4 v7, s[4:7], s27 offen lds
  s_add_u32 s15, s15, 32768
  s_cmp_eq_u32 s15, 131072
  s_cselect_b32 s15, 0, s15
  s_add_u32 s80, s80, 1
  s_add_u32 s3, s80, s81
  s_cmp_lt_u32 s80, 7
  s_cselect_b32 s19, 7, 14
  s_cmp_ge_u32 s3, s19
  s_cselect_b32 s19, 7, 0
  s_sub_u32 s3, s3, s19
  s_mul_i32 s17, s3, 131072
  s_mul_i32 s18, s3, 2048
  s_mov_b32 s15, 0
  s_mov_b32 s17, 0
  s_mov_b32 s18, 0
  s_mov_b32 s80, 0
  s_add_u32 s3, s80, s81
  s_cmp_lt_u32 s80, 7
  s_cselect_b32 s19, 7, 14
  s_cmp_ge_u32 s3, s19
  s_cselect_b32 s19, 7, 0
  s_sub_u32 s3, s3, s19
  s_mul_i32 s17, s3, 131072
  s_mul_i32 s18, s3, 2048
  s_load_dwordx2 s[28:29], s[0:1], 96
  v_and_b32 v2, 7, v0
  v_lshlrev_b32 v2, 7, v2
  s_cmp_lg_u32 s90, 0
  s_cselect_b32 s32, 3, 7
  s_lshl_b32 s32, s32, 15
  s_lshl_b32 s3, s13, 8
  s_and_b32 s19, s12, 8
  s_lshl_b32 s19, s19, 4
  s_add_u32 s3, s3, s19
  s_lshr_b32 s3, s3, 4
  s_lshl_b32 s3, s3, 7
  s_add_u32 s32, s32, s3
  s_mov_b32 s33, 0
  s_waitcnt lgkmcnt(0)
  s_add_u32 s28, s28, 63963136
  s_addc_u32 s29, s29, 0
  s_mov_b32 s30, 262144
  s_mov_b32 s31, 0x20000
  s_cmp_lg_u32 s24, 0
  s_cbranch_scc1 g5f_kernel_dd5
g5f_kernel_dp4:
  buffer_load_dword v8, v2, s[28:31], s32 offen sc1
  s_add_u32 s33, s33, 1
  s_waitcnt vmcnt(0)
  v_cmp_eq_u32 vcc, -1, v8
  s_cmp_ge_u32 s33, 0x8000
  s_cbranch_vccz g5f_kernel_dd5
  s_cbranch_scc0 g5f_kernel_dp4
g5f_kernel_dd5:
  s_barrier
  s_add_u32 s26, s15, s85
  s_mov_b32 m0, s26
  s_add_u32 s27, s18, 0
  s_add_u32 s27, s27, s97
  buffer_load_dwordx4 v6, s[8:11], s27 offen lds
  s_add_u32 m0, s26, 4096
  s_add_u32 s27, s18, 114688
  s_sub_u32 s27, s27, s97
  buffer_load_dwordx4 v6, s[8:11], s27 offen lds
  s_add_u32 m0, s26, 8192
  s_add_u32 s27, s18, 229376
  s_add_u32 s27, s27, s97
  buffer_load_dwordx4 v6, s[8:11], s27 offen lds
  s_add_u32 m0, s26, 12288
  s_add_u32 s27, s18, 344064
  s_sub_u32 s27, s27, s97
  buffer_load_dwordx4 v6, s[8:11], s27 offen lds
  s_add_u32 s15, s15, 32768
  s_cmp_eq_u32 s15, 131072
  s_cselect_b32 s15, 0, s15
  s_add_u32 s80, s80, 1
  s_add_u32 s3, s80, s81
  s_cmp_lt_u32 s80, 7
  s_cselect_b32 s19, 7, 14
  s_cmp_ge_u32 s3, s19
  s_cselect_b32 s19, 7, 0
  s_sub_u32 s3, s3, s19
  s_mul_i32 s17, s3, 131072
  s_mul_i32 s18, s3, 2048
  s_add_u32 s26, s15, s85
  s_mov_b32 m0, s26
  s_add_u32 s27, s18, 0
  s_add_u32 s27, s27, s97
  buffer_load_dwordx4 v6, s[8:11], s27 offen lds
  s_add_u32 m0, s26, 4096
  s_add_u32 s27, s18, 114688
  s_sub_u32 s27, s27, s97
  buffer_load_dwordx4 v6, s[8:11], s27 offen lds
  s_add_u32 m0, s26, 8192
  s_add_u32 s27, s18, 229376
  s_add_u32 s27, s27, s97
  buffer_load_dwordx4 v6, s[8:11], s27 offen lds
  s_add_u32 m0, s26, 12288
  s_add_u32 s27, s18, 344064
  s_sub_u32 s27, s27, s97
  buffer_load_dwordx4 v6, s[8:11], s27 offen lds
  s_add_u32 s15, s15, 32768
  s_cmp_eq_u32 s15, 131072
  s_cselect_b32 s15, 0, s15
  s_add_u32 s80, s80, 1
  s_add_u32 s3, s80, s81
  s_cmp_lt_u32 s80, 7
  s_cselect_b32 s19, 7, 14
  s_cmp_ge_u32 s3, s19
  s_cselect_b32 s19, 7, 0
  s_sub_u32 s3, s3, s19
  s_mul_i32 s17, s3, 131072
  s_mul_i32 s18, s3, 2048
  s_add_u32 s26, s15, s85
  s_mov_b32 m0, s26
  s_add_u32 s27, s18, 0
  s_add_u32 s27, s27, s97
  buffer_load_dwordx4 v6, s[8:11], s27 offen lds
  s_add_u32 m0, s26, 4096
  s_add_u32 s27, s18, 114688
  s_sub_u32 s27, s27, s97
  buffer_load_dwordx4 v6, s[8:11], s27 offen lds
  s_add_u32 m0, s26, 8192
  s_add_u32 s27, s18, 229376
  s_add_u32 s27, s27, s97
  buffer_load_dwordx4 v6, s[8:11], s27 offen lds
  s_add_u32 m0, s26, 12288
  s_add_u32 s27, s18, 344064
  s_sub_u32 s27, s27, s97
  buffer_load_dwordx4 v6, s[8:11], s27 offen lds
  s_add_u32 s15, s15, 32768
  s_cmp_eq_u32 s15, 131072
  s_cselect_b32 s15, 0, s15
  s_add_u32 s80, s80, 1
  s_add_u32 s3, s80, s81
  s_cmp_lt_u32 s80, 7
  s_cselect_b32 s19, 7, 14
  s_cmp_ge_u32 s3, s19
  s_cselect_b32 s19, 7, 0
  s_sub_u32 s3, s3, s19
  s_mul_i32 s17, s3, 131072
  s_mul_i32 s18, s3, 2048
  s_waitcnt vmcnt(8)
  s_barrier
  s_add_u32 s26, s15, s85
  s_mov_b32 m0, s26
  s_add_u32 s27, s18, 0
  s_add_u32 s27, s27, s97
  buffer_load_dwordx4 v6, s[8:11], s27 offen lds
  s_add_u32 m0, s26, 4096
  s_add_u32 s27, s18, 114688
  s_sub_u32 s27, s27, s97
  buffer_load_dwordx4 v6, s[8:11], s27 offen lds
  s_add_u32 m0, s26, 8192
  s_add_u32 s27, s18, 229376
  s_add_u32 s27, s27, s97
  buffer_load_dwordx4 v6, s[8:11], s27 offen lds
  s_add_u32 m0, s26, 12288
  s_add_u32 s27, s18, 344064
  s_sub_u32 s27, s27, s97
  buffer_load_dwordx4 v6, s[8:11], s27 offen lds
  s_add_u32 s26, s15, s84
  s_mov_b32 m0, s26
  s_nop 0
  buffer_load_dwordx4 v7, s[4:7], s17 offen lds
  s_add_u32 m0, s26, 4096
  s_add_u32 s27, s17, 32768
  buffer_load_dwordx4 v7, s[4:7], s27 offen lds
  s_add_u32 m0, s26, 8192
  s_add_u32 s27, s17, 65536
  buffer_load_dwordx4 v7, s[4:7], s27 offen lds
  s_add_u32 m0, s26, 12288
  s_add_u32 s27, s17, 98304
  buffer_load_dwordx4 v7, s[4:7], s27 offen lds
  s_add_u32 s15, s15, 32768
  s_cmp_eq_u32 s15, 131072
  s_cselect_b32 s15, 0, s15
  s_add_u32 s80, s80, 1
  s_add_u32 s3, s80, s81
  s_cmp_lt_u32 s80, 7
  s_cselect_b32 s19, 7, 14
  s_cmp_ge_u32 s3, s19
  s_cselect_b32 s19, 7, 0
  s_sub_u32 s3, s3, s19
  s_mul_i32 s17, s3, 131072
  s_mul_i32 s18, s3, 2048
  s_waitcnt vmcnt(12)
  s_barrier
  s_add_u32 s26, s15, s85
  s_mov_b32 m0, s26
  s_add_u32 s27, s18, 0
  s_add_u32 s27, s27, s97
  buffer_load_dwordx4 v6, s[8:11], s27 offen lds
  s_add_u32 m0, s26, 4096
  s_add_u32 s27, s18, 114688
  s_sub_u32 s27, s27, s97
  buffer_load_dwordx4 v6, s[8:11], s27 offen lds
  s_add_u32 m0, s26, 8192
  s_add_u32 s27, s18, 229376
  s_add_u32 s27, s27, s97
  buffer_load_dwordx4 v6, s[8:11], s27 offen lds
  s_add_u32 m0, s26, 12288
  s_add_u32 s27, s18, 344064
  s_sub_u32 s27, s27, s97
  buffer_load_dwordx4 v6, s[8:11], s27 offen lds
  s_add_u32 s26, s15, s84
  s_mov_b32 m0, s26
  s_nop 0
  buffer_load_dwordx4 v7, s[4:7], s17 offen lds
  s_add_u32 m0, s26, 4096
  s_add_u32 s27, s17, 32768
  buffer_load_dwordx4 v7, s[4:7], s27 offen lds
  s_add_u32 m0, s26, 8192
  s_add_u32 s27, s17, 65536
  buffer_load_dwordx4 v7, s[4:7], s27 offen lds
  s_add_u32 m0, s26, 12288
  s_add_u32 s27, s17, 98304
  buffer_load_dwordx4 v7, s[4:7], s27 offen lds
  s_add_u32 s15, s15, 32768
  s_cmp_eq_u32 s15, 131072
  s_cselect_b32 s15, 0, s15
  s_add_u32 s80, s80, 1
  s_add_u32 s3, s80, s81
  s_cmp_lt_u32 s80, 7
  s_cselect_b32 s19, 7, 14
  s_cmp_ge_u32 s3, s19
  s_cselect_b32 s19, 7, 0
  s_sub_u32 s3, s3, s19
  s_mul_i32 s17, s3, 131072
  s_mul_i32 s18, s3, 2048
  s_mov_b32 s16, 5
g5f_kernel_ldloop1:
  s_waitcnt vmcnt(16)
  s_barrier
g5f_kernel_ldissue2:
  s_add_u32 s26, s15, s85
  s_mov_b32 m0, s26
  s_add_u32 s27, s18, 0
  s_add_u32 s27, s27, s97
  buffer_load_dwordx4 v6, s[8:11], s27 offen lds
  s_add_u32 m0, s26, 4096
  s_add_u32 s27, s18, 114688
  s_sub_u32 s27, s27, s97
  buffer_load_dwordx4 v6, s[8:11], s27 offen lds
  s_add_u32 m0, s26, 8192
  s_add_u32 s27, s18, 229376
  s_add_u32 s27, s27, s97
  buffer_load_dwordx4 v6, s[8:11], s27 offen lds
  s_add_u32 m0, s26, 12288
  s_add_u32 s27, s18, 344064
  s_sub_u32 s27, s27, s97
  buffer_load_dwordx4 v6, s[8:11], s27 offen lds
  s_add_u32 s26, s15, s84
  s_mov_b32 m0, s26
  s_nop 0
  buffer_load_dwordx4 v7, s[4:7], s17 offen lds
  s_add_u32 m0, s26, 4096
  s_add_u32 s27, s17, 32768
  buffer_load_dwordx4 v7, s[4:7], s27 offen lds
  s_add_u32 m0, s26, 8192
  s_add_u32 s27, s17, 65536
  buffer_load_dwordx4 v7, s[4:7], s27 offen lds
  s_add_u32 m0, s26, 12288
  s_add_u32 s27, s17, 98304
  buffer_load_dwordx4 v7, s[4:7], s27 offen lds
  s_add_u32 s15, s15, 32768
  s_cmp_eq_u32 s15, 131072
  s_cselect_b32 s15, 0, s15
  s_add_u32 s80, s80, 1
  s_add_u32 s3, s80, s81
  s_cmp_lt_u32 s80, 7
  s_cselect_b32 s19, 7, 14
  s_cmp_ge_u32 s3, s19
  s_cselect_b32 s19, 7, 0
  s_sub_u32 s3, s3, s19
  s_mul_i32 s17, s3, 131072
  s_mul_i32 s18, s3, 2048
  s_add_u32 s16, s16, 1
  s_cmp_lt_u32 s16, 14
  s_cbranch_scc1 g5f_kernel_ldloop1
  s_waitcnt vmcnt(16)
  s_barrier
  s_waitcnt vmcnt(8)
  s_barrier
  s_waitcnt vmcnt(0)
  s_endpgm
g5f_kernel_comp:
  s_load_dwordx2 s[28:29], s[0:1], 96
  s_load_dwordx2 s[32:33], s[0:1], 96
  s_load_dwordx2 s[72:73], s[0:1], 96
  s_load_dwordx2 s[36:37], s[0:1], 80
  s_load_dwordx2 s[64:65], s[0:1], 96
  s_and_b32 s24, s14, 1
  s_lshr_b32 s25, s14, 1
  v_and_b32 v6, 3, v0
  v_lshlrev_b32 v6, 3, v6
  s_mul_i32 s3, s24, 128
  v_add_u32 v6, s3, v6
  v_lshrrev_b32 v5, 4, v0
  v_lshlrev_b32 v5, 3, v5
  v_lshrrev_b32 v2, 2, v0
  v_and_b32 v2, 3, v2
  v_add_u32 v5, v5, v2
  v_and_b32 v5, 3, v5
  v_lshrrev_b32 v2, 4, v0
  v_lshlrev_b32 v2, 3, v2
  v_lshrrev_b32 v3, 2, v0
  v_and_b32 v3, 3, v3
  v_add_u32 v2, v2, v3
  v_lshrrev_b32 v2, 1, v2
  v_and_b32 v2, 4, v2
  v_add_u32 v5, v5, v2
  v_lshlrev_b32 v5, 5, v5
  v_xor_b32 v6, v6, v5
  v_lshrrev_b32 v5, 4, v0
  v_lshlrev_b32 v5, 3, v5
  v_lshrrev_b32 v2, 2, v0
  v_and_b32 v2, 3, v2
  v_add_u32 v5, v5, v2
  v_lshlrev_b32 v5, 8, v5
  v_add_u32 v6, v6, v5
  v_mov_b32 v7, v6
  v_mov_b32 v8, v6
  v_and_b32 v9, 3, v0
  v_lshlrev_b32 v9, 3, v9
  v_add_u32 v9, 32, v9
  s_mul_i32 s3, s24, 128
  v_add_u32 v9, s3, v9
  v_lshrrev_b32 v5, 4, v0
  v_lshlrev_b32 v5, 3, v5
  v_lshrrev_b32 v2, 2, v0
  v_and_b32 v2, 3, v2
  v_add_u32 v5, v5, v2
  v_and_b32 v5, 3, v5
  v_lshrrev_b32 v2, 4, v0
  v_lshlrev_b32 v2, 3, v2
  v_lshrrev_b32 v3, 2, v0
  v_and_b32 v3, 3, v3
  v_add_u32 v2, v2, v3
  v_lshrrev_b32 v2, 1, v2
  v_and_b32 v2, 4, v2
  v_add_u32 v5, v5, v2
  v_lshlrev_b32 v5, 5, v5
  v_xor_b32 v9, v9, v5
  v_lshrrev_b32 v5, 4, v0
  v_lshlrev_b32 v5, 3, v5
  v_lshrrev_b32 v2, 2, v0
  v_and_b32 v2, 3, v2
  v_add_u32 v5, v5, v2
  v_lshlrev_b32 v5, 8, v5
  v_add_u32 v9, v9, v5
  v_mov_b32 v10, v9
  v_mov_b32 v11, v9
  v_and_b32 v12, 3, v0
  v_lshlrev_b32 v12, 3, v12
  v_add_u32 v12, 64, v12
  s_mul_i32 s3, s24, 128
  v_add_u32 v12, s3, v12
  v_lshrrev_b32 v5, 4, v0
  v_lshlrev_b32 v5, 3, v5
  v_lshrrev_b32 v2, 2, v0
  v_and_b32 v2, 3, v2
  v_add_u32 v5, v5, v2
  v_and_b32 v5, 3, v5
  v_lshrrev_b32 v2, 4, v0
  v_lshlrev_b32 v2, 3, v2
  v_lshrrev_b32 v3, 2, v0
  v_and_b32 v3, 3, v3
  v_add_u32 v2, v2, v3
  v_lshrrev_b32 v2, 1, v2
  v_and_b32 v2, 4, v2
  v_add_u32 v5, v5, v2
  v_lshlrev_b32 v5, 5, v5
  v_xor_b32 v12, v12, v5
  v_lshrrev_b32 v5, 4, v0
  v_lshlrev_b32 v5, 3, v5
  v_lshrrev_b32 v2, 2, v0
  v_and_b32 v2, 3, v2
  v_add_u32 v5, v5, v2
  v_lshlrev_b32 v5, 8, v5
  v_add_u32 v12, v12, v5
  v_mov_b32 v13, v12
  v_mov_b32 v14, v12
  v_and_b32 v15, 3, v0
  v_lshlrev_b32 v15, 3, v15
  v_add_u32 v15, 96, v15
  s_mul_i32 s3, s24, 128
  v_add_u32 v15, s3, v15
  v_lshrrev_b32 v5, 4, v0
  v_lshlrev_b32 v5, 3, v5
  v_lshrrev_b32 v2, 2, v0
  v_and_b32 v2, 3, v2
  v_add_u32 v5, v5, v2
  v_and_b32 v5, 3, v5
  v_lshrrev_b32 v2, 4, v0
  v_lshlrev_b32 v2, 3, v2
  v_lshrrev_b32 v3, 2, v0
  v_and_b32 v3, 3, v3
  v_add_u32 v2, v2, v3
  v_lshrrev_b32 v2, 1, v2
  v_and_b32 v2, 4, v2
  v_add_u32 v5, v5, v2
  v_lshlrev_b32 v5, 5, v5
  v_xor_b32 v15, v15, v5
  v_lshrrev_b32 v5, 4, v0
  v_lshlrev_b32 v5, 3, v5
  v_lshrrev_b32 v2, 2, v0
  v_and_b32 v2, 3, v2
  v_add_u32 v5, v5, v2
  v_lshlrev_b32 v5, 8, v5
  v_add_u32 v15, v15, v5
  v_mov_b32 v16, v15
  v_mov_b32 v17, v15
  v_lshlrev_b32 v18, 4, v0
  s_mul_i32 s3, s25, 8192
  s_add_u32 s3, s3, 16384
  v_add_u32 v18, s3, v18
  v_mov_b32 v19, v18
  v_mov_b32 v20, v18
  s_waitcnt lgkmcnt(0)
  s_add_u32 s28, s28, 67108864
  s_addc_u32 s29, s29, 0
  s_mov_b32 s30, 4194304
  s_mov_b32 s31, 0x20000
  s_add_u32 s32, s32, 66060288
  s_addc_u32 s33, s33, 0
  s_mov_b32 s34, 262144
  s_mov_b32 s35, 0x20000
  s_cmp_eq_u32 s90, 0
  s_cselect_b32 s74, 58720256, 0
  s_add_u32 s72, s72, s74
  s_addc_u32 s73, s73, 0
  s_mov_b32 s74, 4194304
  s_mov_b32 s75, 0x20000
  s_mov_b32 s38, 4194304
  s_mov_b32 s39, 0x20000
  s_add_u32 s64, s64, 54525952
  s_addc_u32 s65, s65, 0
  s_mov_b32 s66, 4194304
  s_mov_b32 s67, 0x20000
  s_and_b32 s60, s12, 7
  s_lshr_b32 s62, s12, 3
  s_lshl_b32 s61, s13, 2
  s_lshl_b32 s19, s25, 1
  s_add_u32 s61, s61, s19
  s_add_u32 s61, s61, s62
  s_mul_i32 s63, s13, 8
  s_add_u32 s63, s63, s60
  s_lshl_b32 s63, s63, 1
  s_add_u32 s63, s63, s62
  s_lshl_b32 s63, s63, 2
  s_add_u32 s63, s63, s14
  s_lshl_b32 s56, s61, 6
  s_mul_i32 s19, s60, 4
  s_add_u32 s56, s56, s19
  s_mul_i32 s19, s24, 2
  s_add_u32 s56, s56, s19
  s_lshl_b32 s56, s56, 10
  v_lshlrev_b32 v168, 4, v0
  s_waitcnt lgkmcnt(0)
  s_barrier
  s_barrier
  ds_read_b64_tr_b16 v[88:89], v7 offset:0
  ds_read_b64_tr_b16 v[90:91], v7 offset:1024
  ds_read_b128 v[104:107], v19 offset:0
  ds_read_b64_tr_b16 v[92:93], v10 offset:0
  ds_read_b64_tr_b16 v[94:95], v10 offset:1024
  ds_read_b128 v[108:111], v19 offset:2048
  ds_read_b64_tr_b16 v[96:97], v13 offset:0
  ds_read_b64_tr_b16 v[98:99], v13 offset:1024
  ds_read_b128 v[112:115], v19 offset:4096
  ds_read_b64_tr_b16 v[100:101], v16 offset:0
  ds_read_b64_tr_b16 v[102:103], v16 offset:1024
  ds_read_b128 v[116:119], v19 offset:6144
  s_waitcnt lgkmcnt(9)
  v_mfma_f32_16x16x32_bf16 v[24:27], v[88:91], v[104:107], 0
  ds_read_b64_tr_b16 v[120:121], v8 offset:8192
  s_waitcnt lgkmcnt(7)
  v_mfma_f32_16x16x32_bf16 v[28:31], v[88:91], v[108:111], 0
  ds_read_b64_tr_b16 v[122:123], v8 offset:9216
  v_mfma_f32_16x16x32_bf16 v[40:43], v[92:95], v[104:107], 0
  ds_read_b128 v[136:139], v20 offset:1024
  v_mfma_f32_16x16x32_bf16 v[44:47], v[92:95], v[108:111], 0
  ds_read_b64_tr_b16 v[124:125], v11 offset:8192
  s_waitcnt lgkmcnt(7)
  v_mfma_f32_16x16x32_bf16 v[32:35], v[88:91], v[112:115], 0
  ds_read_b64_tr_b16 v[126:127], v11 offset:9216
  v_mfma_f32_16x16x32_bf16 v[48:51], v[92:95], v[112:115], 0
  ds_read_b128 v[140:143], v20 offset:3072
  v_mfma_f32_16x16x32_bf16 v[56:59], v[96:99], v[104:107], 0
  ds_read_b64_tr_b16 v[128:129], v14 offset:8192
  v_mfma_f32_16x16x32_bf16 v[60:63], v[96:99], v[108:111], 0
  ds_read_b64_tr_b16 v[130:131], v14 offset:9216
  v_mfma_f32_16x16x32_bf16 v[64:67], v[96:99], v[112:115], 0
  ds_read_b128 v[144:147], v20 offset:5120
  s_waitcnt lgkmcnt(9)
  v_mfma_f32_16x16x32_bf16 v[36:39], v[88:91], v[116:119], 0
  ds_read_b64_tr_b16 v[132:133], v17 offset:8192
  v_mfma_f32_16x16x32_bf16 v[52:55], v[92:95], v[116:119], 0
  ds_read_b64_tr_b16 v[134:135], v17 offset:9216
  s_add_u32 s15, s15, 32768
  s_cmp_ge_u32 s15, 131072
  s_cselect_b32 s3, 131072, 0
  s_sub_u32 s15, s15, s3
  v_mfma_f32_16x16x32_bf16 v[68:71], v[96:99], v[116:119], 0
  ds_read_b128 v[148:151], v20 offset:7168
  v_add_u32 v7, s15, v6
  v_mfma_f32_16x16x32_bf16 v[72:75], v[100:103], v[104:107], 0
  v_add_u32 v10, s15, v9
  v_mfma_f32_16x16x32_bf16 v[76:79], v[100:103], v[108:111], 0
  v_add_u32 v13, s15, v12
  v_mfma_f32_16x16x32_bf16 v[80:83], v[100:103], v[112:115], 0
  v_add_u32 v16, s15, v15
  v_mfma_f32_16x16x32_bf16 v[84:87], v[100:103], v[116:119], 0
  v_add_u32 v19, s15, v18
  s_waitcnt lgkmcnt(9)
  v_mfma_f32_16x16x32_bf16 v[24:27], v[120:123], v[136:139], v[24:27]
  v_add_u32 v8, s15, v6
  s_waitcnt lgkmcnt(6)
  v_mfma_f32_16x16x32_bf16 v[28:31], v[120:123], v[140:143], v[28:31]
  v_add_u32 v11, s15, v9
  s_waitcnt lgkmcnt(0)
  s_barrier
  v_mfma_f32_16x16x32_bf16 v[40:43], v[124:127], v[136:139], v[40:43]
  ds_read_b64_tr_b16 v[88:89], v7 offset:0
  v_mfma_f32_16x16x32_bf16 v[44:47], v[124:127], v[140:143], v[44:47]
  ds_read_b64_tr_b16 v[90:91], v7 offset:1024
  v_mfma_f32_16x16x32_bf16 v[32:35], v[120:123], v[144:147], v[32:35]
  ds_read_b128 v[104:107], v19 offset:0
  v_mfma_f32_16x16x32_bf16 v[48:51], v[124:127], v[144:147], v[48:51]
  ds_read_b64_tr_b16 v[92:93], v10 offset:0
  v_mfma_f32_16x16x32_bf16 v[56:59], v[128:131], v[136:139], v[56:59]
  ds_read_b64_tr_b16 v[94:95], v10 offset:1024
  v_mfma_f32_16x16x32_bf16 v[60:63], v[128:131], v[140:143], v[60:63]
  ds_read_b128 v[108:111], v19 offset:2048
  v_mfma_f32_16x16x32_bf16 v[64:67], v[128:131], v[144:147], v[64:67]
  ds_read_b64_tr_b16 v[96:97], v13 offset:0
  v_mfma_f32_16x16x32_bf16 v[36:39], v[120:123], v[148:151], v[36:39]
  ds_read_b64_tr_b16 v[98:99], v13 offset:1024
  v_mfma_f32_16x16x32_bf16 v[52:55], v[124:127], v[148:151], v[52:55]
  ds_read_b128 v[112:115], v19 offset:4096
  v_mfma_f32_16x16x32_bf16 v[68:71], v[128:131], v[148:151], v[68:71]
  ds_read_b64_tr_b16 v[100:101], v16 offset:0
  v_mfma_f32_16x16x32_bf16 v[72:75], v[132:135], v[136:139], v[72:75]
  ds_read_b64_tr_b16 v[102:103], v16 offset:1024
  v_mfma_f32_16x16x32_bf16 v[76:79], v[132:135], v[140:143], v[76:79]
  ds_read_b128 v[116:119], v19 offset:6144
  v_add_u32 v14, s15, v12
  v_mfma_f32_16x16x32_bf16 v[80:83], v[132:135], v[144:147], v[80:83]
  v_add_u32 v17, s15, v15
  v_mfma_f32_16x16x32_bf16 v[84:87], v[132:135], v[148:151], v[84:87]
  v_add_u32 v20, s15, v18
  s_mov_b32 s16, 12
  .p2align 3
g5f_kernel_cloop6:
  s_waitcnt lgkmcnt(9)
  v_mfma_f32_16x16x32_bf16 v[24:27], v[88:91], v[104:107], v[24:27]
  ds_read_b64_tr_b16 v[120:121], v8 offset:8192
  s_waitcnt lgkmcnt(7)
  v_mfma_f32_16x16x32_bf16 v[28:31], v[88:91], v[108:111], v[28:31]
  ds_read_b64_tr_b16 v[122:123], v8 offset:9216
  v_mfma_f32_16x16x32_bf16 v[40:43], v[92:95], v[104:107], v[40:43]
  ds_read_b128 v[136:139], v20 offset:1024
  v_mfma_f32_16x16x32_bf16 v[44:47], v[92:95], v[108:111], v[44:47]
  ds_read_b64_tr_b16 v[124:125], v11 offset:8192
  s_waitcnt lgkmcnt(7)
  v_mfma_f32_16x16x32_bf16 v[32:35], v[88:91], v[112:115], v[32:35]
  ds_read_b64_tr_b16 v[126:127], v11 offset:9216
  v_mfma_f32_16x16x32_bf16 v[48:51], v[92:95], v[112:115], v[48:51]
  ds_read_b128 v[140:143], v20 offset:3072
  v_mfma_f32_16x16x32_bf16 v[56:59], v[96:99], v[104:107], v[56:59]
  ds_read_b64_tr_b16 v[128:129], v14 offset:8192
  v_mfma_f32_16x16x32_bf16 v[60:63], v[96:99], v[108:111], v[60:63]
  ds_read_b64_tr_b16 v[130:131], v14 offset:9216
  v_mfma_f32_16x16x32_bf16 v[64:67], v[96:99], v[112:115], v[64:67]
  ds_read_b128 v[144:147], v20 offset:5120
  s_waitcnt lgkmcnt(9)
  v_mfma_f32_16x16x32_bf16 v[36:39], v[88:91], v[116:119], v[36:39]
  ds_read_b64_tr_b16 v[132:133], v17 offset:8192
  v_mfma_f32_16x16x32_bf16 v[52:55], v[92:95], v[116:119], v[52:55]
  ds_read_b64_tr_b16 v[134:135], v17 offset:9216
  s_add_u32 s15, s15, 32768
  s_cmp_ge_u32 s15, 131072
  s_cselect_b32 s3, 131072, 0
  s_sub_u32 s15, s15, s3
  v_mfma_f32_16x16x32_bf16 v[68:71], v[96:99], v[116:119], v[68:71]
  ds_read_b128 v[148:151], v20 offset:7168
  v_add_u32 v7, s15, v6
  v_mfma_f32_16x16x32_bf16 v[72:75], v[100:103], v[104:107], v[72:75]
  v_add_u32 v10, s15, v9
  v_mfma_f32_16x16x32_bf16 v[76:79], v[100:103], v[108:111], v[76:79]
  v_add_u32 v13, s15, v12
  v_mfma_f32_16x16x32_bf16 v[80:83], v[100:103], v[112:115], v[80:83]
  v_add_u32 v16, s15, v15
  v_mfma_f32_16x16x32_bf16 v[84:87], v[100:103], v[116:119], v[84:87]
  v_add_u32 v19, s15, v18
  s_waitcnt lgkmcnt(9)
  v_mfma_f32_16x16x32_bf16 v[24:27], v[120:123], v[136:139], v[24:27]
  v_add_u32 v8, s15, v6
  s_waitcnt lgkmcnt(6)
  v_mfma_f32_16x16x32_bf16 v[28:31], v[120:123], v[140:143], v[28:31]
  v_add_u32 v11, s15, v9
  s_waitcnt lgkmcnt(0)
  s_barrier
  v_mfma_f32_16x16x32_bf16 v[40:43], v[124:127], v[136:139], v[40:43]
  ds_read_b64_tr_b16 v[88:89], v7 offset:0
  v_mfma_f32_16x16x32_bf16 v[44:47], v[124:127], v[140:143], v[44:47]
  ds_read_b64_tr_b16 v[90:91], v7 offset:1024
  v_mfma_f32_16x16x32_bf16 v[32:35], v[120:123], v[144:147], v[32:35]
  ds_read_b128 v[104:107], v19 offset:0
  v_mfma_f32_16x16x32_bf16 v[48:51], v[124:127], v[144:147], v[48:51]
  ds_read_b64_tr_b16 v[92:93], v10 offset:0
  v_mfma_f32_16x16x32_bf16 v[56:59], v[128:131], v[136:139], v[56:59]
  ds_read_b64_tr_b16 v[94:95], v10 offset:1024
  v_mfma_f32_16x16x32_bf16 v[60:63], v[128:131], v[140:143], v[60:63]
  ds_read_b128 v[108:111], v19 offset:2048
  v_mfma_f32_16x16x32_bf16 v[64:67], v[128:131], v[144:147], v[64:67]
  ds_read_b64_tr_b16 v[96:97], v13 offset:0
  v_mfma_f32_16x16x32_bf16 v[36:39], v[120:123], v[148:151], v[36:39]
  ds_read_b64_tr_b16 v[98:99], v13 offset:1024
  v_mfma_f32_16x16x32_bf16 v[52:55], v[124:127], v[148:151], v[52:55]
  ds_read_b128 v[112:115], v19 offset:4096
  v_mfma_f32_16x16x32_bf16 v[68:71], v[128:131], v[148:151], v[68:71]
  ds_read_b64_tr_b16 v[100:101], v16 offset:0
  v_mfma_f32_16x16x32_bf16 v[72:75], v[132:135], v[136:139], v[72:75]
  ds_read_b64_tr_b16 v[102:103], v16 offset:1024
  v_mfma_f32_16x16x32_bf16 v[76:79], v[132:135], v[140:143], v[76:79]
  ds_read_b128 v[116:119], v19 offset:6144
  v_add_u32 v14, s15, v12
  v_mfma_f32_16x16x32_bf16 v[80:83], v[132:135], v[144:147], v[80:83]
  v_add_u32 v17, s15, v15
  v_mfma_f32_16x16x32_bf16 v[84:87], v[132:135], v[148:151], v[84:87]
  v_add_u32 v20, s15, v18
  s_cmp_lg_u32 s16, 2
  s_cbranch_scc1 g5f_kernel_late7
  s_add_u32 s26, s56, 0
  buffer_load_dwordx4 v[152:155], v168, s[72:75], s26 offen offset:0
  buffer_load_dwordx4 v[156:159], v168, s[72:75], s26 offen offset:1024
  s_add_u32 s26, s56, 32768
  buffer_load_dwordx4 v[160:163], v168, s[72:75], s26 offen offset:0
  buffer_load_dwordx4 v[164:167], v168, s[72:75], s26 offen offset:1024
g5f_kernel_late7:
  s_sub_u32 s16, s16, 1
  s_cmp_lg_u32 s16, 0
  s_cbranch_scc1 g5f_kernel_cloop6
  s_waitcnt lgkmcnt(9)
  v_mfma_f32_16x16x32_bf16 v[24:27], v[88:91], v[104:107], v[24:27]
  ds_read_b64_tr_b16 v[120:121], v8 offset:8192
  s_waitcnt lgkmcnt(7)
  v_mfma_f32_16x16x32_bf16 v[28:31], v[88:91], v[108:111], v[28:31]
  ds_read_b64_tr_b16 v[122:123], v8 offset:9216
  v_mfma_f32_16x16x32_bf16 v[40:43], v[92:95], v[104:107], v[40:43]
  ds_read_b128 v[136:139], v20 offset:1024
  v_mfma_f32_16x16x32_bf16 v[44:47], v[92:95], v[108:111], v[44:47]
  ds_read_b64_tr_b16 v[124:125], v11 offset:8192
  s_waitcnt lgkmcnt(7)
  v_mfma_f32_16x16x32_bf16 v[32:35], v[88:91], v[112:115], v[32:35]
  ds_read_b64_tr_b16 v[126:127], v11 offset:9216
  v_mfma_f32_16x16x32_bf16 v[48:51], v[92:95], v[112:115], v[48:51]
  ds_read_b128 v[140:143], v20 offset:3072
  v_mfma_f32_16x16x32_bf16 v[56:59], v[96:99], v[104:107], v[56:59]
  ds_read_b64_tr_b16 v[128:129], v14 offset:8192
  v_mfma_f32_16x16x32_bf16 v[60:63], v[96:99], v[108:111], v[60:63]
  ds_read_b64_tr_b16 v[130:131], v14 offset:9216
  v_mfma_f32_16x16x32_bf16 v[64:67], v[96:99], v[112:115], v[64:67]
  ds_read_b128 v[144:147], v20 offset:5120
  s_waitcnt lgkmcnt(9)
  v_mfma_f32_16x16x32_bf16 v[36:39], v[88:91], v[116:119], v[36:39]
  ds_read_b64_tr_b16 v[132:133], v17 offset:8192
  v_mfma_f32_16x16x32_bf16 v[52:55], v[92:95], v[116:119], v[52:55]
  ds_read_b64_tr_b16 v[134:135], v17 offset:9216
  v_mfma_f32_16x16x32_bf16 v[68:71], v[96:99], v[116:119], v[68:71]
  ds_read_b128 v[148:151], v20 offset:7168
  v_mfma_f32_16x16x32_bf16 v[72:75], v[100:103], v[104:107], v[72:75]
  v_mfma_f32_16x16x32_bf16 v[76:79], v[100:103], v[108:111], v[76:79]
  v_mfma_f32_16x16x32_bf16 v[80:83], v[100:103], v[112:115], v[80:83]
  v_mfma_f32_16x16x32_bf16 v[84:87], v[100:103], v[116:119], v[84:87]
  s_waitcnt lgkmcnt(9)
  v_mfma_f32_16x16x32_bf16 v[24:27], v[120:123], v[136:139], v[24:27]
  s_waitcnt lgkmcnt(6)
  v_mfma_f32_16x16x32_bf16 v[28:31], v[120:123], v[140:143], v[28:31]
  v_mfma_f32_16x16x32_bf16 v[40:43], v[124:127], v[136:139], v[40:43]
  v_mfma_f32_16x16x32_bf16 v[44:47], v[124:127], v[140:143], v[44:47]
  s_waitcnt lgkmcnt(3)
  v_mfma_f32_16x16x32_bf16 v[32:35], v[120:123], v[144:147], v[32:35]
  v_mfma_f32_16x16x32_bf16 v[48:51], v[124:127], v[144:147], v[48:51]
  v_mfma_f32_16x16x32_bf16 v[56:59], v[128:131], v[136:139], v[56:59]
  v_mfma_f32_16x16x32_bf16 v[60:63], v[128:131], v[140:143], v[60:63]
  v_mfma_f32_16x16x32_bf16 v[64:67], v[128:131], v[144:147], v[64:67]
  s_waitcnt lgkmcnt(0)
  v_mfma_f32_16x16x32_bf16 v[36:39], v[120:123], v[148:151], v[36:39]
  v_mfma_f32_16x16x32_bf16 v[52:55], v[124:127], v[148:151], v[52:55]
  v_mfma_f32_16x16x32_bf16 v[68:71], v[128:131], v[148:151], v[68:71]
  v_mfma_f32_16x16x32_bf16 v[72:75], v[132:135], v[136:139], v[72:75]
  v_mfma_f32_16x16x32_bf16 v[76:79], v[132:135], v[140:143], v[76:79]
  v_mfma_f32_16x16x32_bf16 v[80:83], v[132:135], v[144:147], v[80:83]
  v_mfma_f32_16x16x32_bf16 v[84:87], v[132:135], v[148:151], v[84:87]
  s_lshl_b32 s26, s63, 12
  s_mov_b32 s58, 1
  v_cvt_pk_bf16_f32 v88, v32, v33
  v_cvt_pk_bf16_f32 v89, v34, v35
  v_cvt_pk_bf16_f32 v90, v36, v37
  v_cvt_pk_bf16_f32 v91, v38, v39
  v_and_or_b32 v88, v88, -2, s58
  buffer_store_dwordx4 v[88:91], v168, s[64:67], s26 offen offset:0 sc1
  v_cvt_pk_bf16_f32 v92, v48, v49
  v_cvt_pk_bf16_f32 v93, v50, v51
  v_cvt_pk_bf16_f32 v94, v52, v53
  v_cvt_pk_bf16_f32 v95, v54, v55
  v_and_or_b32 v92, v92, -2, s58
  buffer_store_dwordx4 v[92:95], v168, s[64:67], s26 offen offset:1024 sc1
  v_cvt_pk_bf16_f32 v96, v64, v65
  v_cvt_pk_bf16_f32 v97, v66, v67
  v_cvt_pk_bf16_f32 v98, v68, v69
  v_cvt_pk_bf16_f32 v99, v70, v71
  v_and_or_b32 v96, v96, -2, s58
  buffer_store_dwordx4 v[96:99], v168, s[64:67], s26 offen offset:2048 sc1
  v_cvt_pk_bf16_f32 v100, v80, v81
  v_cvt_pk_bf16_f32 v101, v82, v83
  v_cvt_pk_bf16_f32 v102, v84, v85
  v_cvt_pk_bf16_f32 v103, v86, v87
  v_and_or_b32 v100, v100, -2, s58
  buffer_store_dwordx4 v[100:103], v168, s[64:67], s26 offen offset:3072 sc1
  s_xor_b32 s27, s26, 0x4000
  s_mov_b32 s59, 0
  s_mov_b32 s19, 0xffff0000
  s_waitcnt vmcnt(4)
  v_permlane32_swap_b32 v24, v40
  v_permlane32_swap_b32 v25, v41
  v_permlane32_swap_b32 v26, v42
  v_permlane32_swap_b32 v27, v43
  v_permlane32_swap_b32 v56, v72
  v_permlane32_swap_b32 v57, v73
  v_permlane32_swap_b32 v58, v74
  v_permlane32_swap_b32 v59, v75
  v_permlane32_swap_b32 v28, v44
  v_permlane32_swap_b32 v29, v45
  v_permlane32_swap_b32 v30, v46
  v_permlane32_swap_b32 v31, v47
  v_permlane32_swap_b32 v60, v76
  v_permlane32_swap_b32 v61, v77
  v_permlane32_swap_b32 v62, v78
  v_permlane32_swap_b32 v63, v79
  v_permlane16_swap_b32 v24, v40
  v_permlane16_swap_b32 v25, v41
  v_permlane16_swap_b32 v26, v42
  v_permlane16_swap_b32 v27, v43
  v_permlane16_swap_b32 v56, v72
  v_permlane16_swap_b32 v57, v73
  v_permlane16_swap_b32 v58, v74
  v_permlane16_swap_b32 v59, v75
  v_permlane16_swap_b32 v28, v44
  v_permlane16_swap_b32 v29, v45
  v_permlane16_swap_b32 v30, v46
  v_permlane16_swap_b32 v31, v47
  v_permlane16_swap_b32 v60, v76
  v_permlane16_swap_b32 v61, v77
  v_permlane16_swap_b32 v62, v78
  v_permlane16_swap_b32 v63, v79
  v_lshlrev_b32 v104, 16, v152
  v_and_b32 v105, s19, v152
  v_pk_add_f32 v[24:25], v[24:25], v[104:105] op_sel:[0,0] op_sel_hi:[1,1]
  v_lshlrev_b32 v106, 16, v153
  v_and_b32 v107, s19, v153
  v_pk_add_f32 v[26:27], v[26:27], v[106:107] op_sel:[0,0] op_sel_hi:[1,1]
  v_lshlrev_b32 v108, 16, v154
  v_and_b32 v109, s19, v154
  v_pk_add_f32 v[40:41], v[40:41], v[108:109] op_sel:[0,0] op_sel_hi:[1,1]
  v_lshlrev_b32 v110, 16, v155
  v_and_b32 v111, s19, v155
  v_pk_add_f32 v[42:43], v[42:43], v[110:111] op_sel:[0,0] op_sel_hi:[1,1]
  v_lshlrev_b32 v104, 16, v156
  v_and_b32 v105, s19, v156
  v_pk_add_f32 v[56:57], v[56:57], v[104:105] op_sel:[0,0] op_sel_hi:[1,1]
  v_lshlrev_b32 v106, 16, v157
  v_and_b32 v107, s19, v157
  v_pk_add_f32 v[58:59], v[58:59], v[106:107] op_sel:[0,0] op_sel_hi:[1,1]
  v_lshlrev_b32 v108, 16, v158
  v_and_b32 v109, s19, v158
  v_pk_add_f32 v[72:73], v[72:73], v[108:109] op_sel:[0,0] op_sel_hi:[1,1]
  v_lshlrev_b32 v110, 16, v159
  v_and_b32 v111, s19, v159
  v_pk_add_f32 v[74:75], v[74:75], v[110:111] op_sel:[0,0] op_sel_hi:[1,1]
  v_lshlrev_b32 v104, 16, v160
  v_and_b32 v105, s19, v160
  v_pk_add_f32 v[28:29], v[28:29], v[104:105] op_sel:[0,0] op_sel_hi:[1,1]
  v_lshlrev_b32 v106, 16, v161
  v_and_b32 v107, s19, v161
  v_pk_add_f32 v[30:31], v[30:31], v[106:107] op_sel:[0,0] op_sel_hi:[1,1]
  v_lshlrev_b32 v108, 16, v162
  v_and_b32 v109, s19, v162
  v_pk_add_f32 v[44:45], v[44:45], v[108:109] op_sel:[0,0] op_sel_hi:[1,1]
  v_lshlrev_b32 v110, 16, v163
  v_and_b32 v111, s19, v163
  v_pk_add_f32 v[46:47], v[46:47], v[110:111] op_sel:[0,0] op_sel_hi:[1,1]
  v_lshlrev_b32 v104, 16, v164
  v_and_b32 v105, s19, v164
  v_pk_add_f32 v[60:61], v[60:61], v[104:105] op_sel:[0,0] op_sel_hi:[1,1]
  v_lshlrev_b32 v106, 16, v165
  v_and_b32 v107, s19, v165
  v_pk_add_f32 v[62:63], v[62:63], v[106:107] op_sel:[0,0] op_sel_hi:[1,1]
  v_lshlrev_b32 v108, 16, v166
  v_and_b32 v109, s19, v166
  v_pk_add_f32 v[76:77], v[76:77], v[108:109] op_sel:[0,0] op_sel_hi:[1,1]
  v_lshlrev_b32 v110, 16, v167
  v_and_b32 v111, s19, v167
  v_pk_add_f32 v[78:79], v[78:79], v[110:111] op_sel:[0,0] op_sel_hi:[1,1]
  s_waitcnt vmcnt(0)
g5f_kernel_xp8:
  buffer_load_dwordx4 v[120:123], v168, s[64:67], s27 offen offset:0 sc1
  buffer_load_dwordx4 v[124:127], v168, s[64:67], s27 offen offset:1024 sc1
  buffer_load_dwordx4 v[128:131], v168, s[64:67], s27 offen offset:2048 sc1
  buffer_load_dwordx4 v[132:135], v168, s[64:67], s27 offen offset:3072 sc1
  s_add_u32 s59, s59, 1
  s_waitcnt vmcnt(0)
  v_xor_b32 v2, s58, v120
  v_xor_b32 v3, s58, v124
  v_xor_b32 v4, s58, v128
  v_xor_b32 v5, s58, v132
  v_or3_b32 v2, v2, v3, v4
  v_or_b32 v2, v2, v5
  v_and_b32 v2, 1, v2
  v_cmp_eq_u32 vcc, 1, v2
  s_cmp_ge_u32 s59, 0x10000
  s_cbranch_vccz g5f_kernel_xd9
  s_cbranch_scc0 g5f_kernel_xp8
g5f_kernel_xd9:
  v_permlane32_swap_b32 v120, v124
  v_permlane32_swap_b32 v121, v125
  v_permlane32_swap_b32 v122, v126
  v_permlane32_swap_b32 v123, v127
  v_permlane32_swap_b32 v128, v132
  v_permlane32_swap_b32 v129, v133
  v_permlane32_swap_b32 v130, v134
  v_permlane32_swap_b32 v131, v135
  v_permlane16_swap_b32 v120, v124
  v_permlane16_swap_b32 v121, v125
  v_permlane16_swap_b32 v122, v126
  v_permlane16_swap_b32 v123, v127
  v_permlane16_swap_b32 v128, v132
  v_permlane16_swap_b32 v129, v133
  v_permlane16_swap_b32 v130, v134
  v_permlane16_swap_b32 v131, v135
  v_lshlrev_b32 v104, 16, v120
  v_and_b32 v105, s19, v120
  v_pk_add_f32 v[24:25], v[24:25], v[104:105] op_sel:[0,0] op_sel_hi:[1,1]
  v_lshlrev_b32 v106, 16, v121
  v_and_b32 v107, s19, v121
  v_pk_add_f32 v[26:27], v[26:27], v[106:107] op_sel:[0,0] op_sel_hi:[1,1]
  v_lshlrev_b32 v108, 16, v124
  v_and_b32 v109, s19, v124
  v_pk_add_f32 v[40:41], v[40:41], v[108:109] op_sel:[0,0] op_sel_hi:[1,1]
  v_lshlrev_b32 v110, 16, v125
  v_and_b32 v111, s19, v125
  v_pk_add_f32 v[42:43], v[42:43], v[110:111] op_sel:[0,0] op_sel_hi:[1,1]
  v_lshlrev_b32 v104, 16, v128
  v_and_b32 v105, s19, v128
  v_pk_add_f32 v[56:57], v[56:57], v[104:105] op_sel:[0,0] op_sel_hi:[1,1]
  v_lshlrev_b32 v106, 16, v129
  v_and_b32 v107, s19, v129
  v_pk_add_f32 v[58:59], v[58:59], v[106:107] op_sel:[0,0] op_sel_hi:[1,1]
  v_lshlrev_b32 v108, 16, v132
  v_and_b32 v109, s19, v132
  v_pk_add_f32 v[72:73], v[72:73], v[108:109] op_sel:[0,0] op_sel_hi:[1,1]
  v_lshlrev_b32 v110, 16, v133
  v_and_b32 v111, s19, v133
  v_pk_add_f32 v[74:75], v[74:75], v[110:111] op_sel:[0,0] op_sel_hi:[1,1]
  v_lshlrev_b32 v104, 16, v122
  v_and_b32 v105, s19, v122
  v_pk_add_f32 v[28:29], v[28:29], v[104:105] op_sel:[0,0] op_sel_hi:[1,1]
  v_lshlrev_b32 v106, 16, v123
  v_and_b32 v107, s19, v123
  v_pk_add_f32 v[30:31], v[30:31], v[106:107] op_sel:[0,0] op_sel_hi:[1,1]
  v_lshlrev_b32 v108, 16, v126
  v_and_b32 v109, s19, v126
  v_pk_add_f32 v[44:45], v[44:45], v[108:109] op_sel:[0,0] op_sel_hi:[1,1]
  v_lshlrev_b32 v110, 16, v127
  v_and_b32 v111, s19, v127
  v_pk_add_f32 v[46:47], v[46:47], v[110:111] op_sel:[0,0] op_sel_hi:[1,1]
  v_lshlrev_b32 v104, 16, v130
  v_and_b32 v105, s19, v130
  v_pk_add_f32 v[60:61], v[60:61], v[104:105] op_sel:[0,0] op_sel_hi:[1,1]
  v_lshlrev_b32 v106, 16, v131
  v_and_b32 v107, s19, v131
  v_pk_add_f32 v[62:63], v[62:63], v[106:107] op_sel:[0,0] op_sel_hi:[1,1]
  v_lshlrev_b32 v108, 16, v134
  v_and_b32 v109, s19, v134
  v_pk_add_f32 v[76:77], v[76:77], v[108:109] op_sel:[0,0] op_sel_hi:[1,1]
  v_lshlrev_b32 v110, 16, v135
  v_and_b32 v111, s19, v135
  v_pk_add_f32 v[78:79], v[78:79], v[110:111] op_sel:[0,0] op_sel_hi:[1,1]
  v_and_b32 v2, 15, v0
  v_and_b32 v3, 15, v0
  v_and_b32 v3, 12, v3
  v_add_u32 v2, v2, v3
  v_lshlrev_b32 v2, 11, v2
  v_lshrrev_b32 v3, 4, v0
  v_lshlrev_b32 v3, 4, v3
  v_add_u32 v2, v2, v3
  s_lshl_b32 s57, s61, 16
  s_mul_i32 s19, s60, 256
  s_add_u32 s57, s57, s19
  s_mul_i32 s19, s24, 128
  s_add_u32 s57, s57, s19
  s_waitcnt vmcnt(0)
  s_mov_b32 s19, 0xffff0000
  s_add_u32 s26, s57, 0
  v_cvt_pk_bf16_f32 v152, v24, v25
  v_cvt_pk_bf16_f32 v153, v26, v27
  v_cvt_pk_bf16_f32 v154, v40, v41
  v_cvt_pk_bf16_f32 v155, v42, v43
  buffer_store_dwordx4 v[152:155], v2, s[36:39], s26 offen offset:0 sc0 sc1
  v_cvt_pk_bf16_f32 v156, v56, v57
  v_cvt_pk_bf16_f32 v157, v58, v59
  v_cvt_pk_bf16_f32 v158, v72, v73
  v_cvt_pk_bf16_f32 v159, v74, v75
  buffer_store_dwordx4 v[156:159], v2, s[36:39], s26 offen offset:64 sc0 sc1
  s_add_u32 s26, s57, 8192
  v_cvt_pk_bf16_f32 v160, v28, v29
  v_cvt_pk_bf16_f32 v161, v30, v31
  v_cvt_pk_bf16_f32 v162, v44, v45
  v_cvt_pk_bf16_f32 v163, v46, v47
  buffer_store_dwordx4 v[160:163], v2, s[36:39], s26 offen offset:0 sc0 sc1
  v_cvt_pk_bf16_f32 v164, v60, v61
  v_cvt_pk_bf16_f32 v165, v62, v63
  v_cvt_pk_bf16_f32 v166, v76, v77
  v_cvt_pk_bf16_f32 v167, v78, v79
  buffer_store_dwordx4 v[164:167], v2, s[36:39], s26 offen offset:64 sc0 sc1
g5f_kernel_fin:
g5f_kernel_end:
  s_endpgm
text_end_mark:
  s_endpgm
.section .rodata,"a"
.p2align 6
kd_start_mark:
.p2align 6
.amdhsa_kernel g1_kernel
  .amdhsa_next_free_vgpr 160
  .amdhsa_next_free_sgpr 100
  .amdhsa_accum_offset 160
  .amdhsa_group_segment_fixed_size 0
  .amdhsa_kernarg_size 104
  .amdhsa_user_sgpr_count 2
  .amdhsa_user_sgpr_kernarg_segment_ptr 1
  .amdhsa_system_sgpr_workgroup_id_x 1
  .amdhsa_float_denorm_mode_32 3
  .amdhsa_float_denorm_mode_16_64 3
.end_amdhsa_kernel
.p2align 6
.amdhsa_kernel g2_kernel
  .amdhsa_next_free_vgpr 248
  .amdhsa_next_free_sgpr 100
  .amdhsa_accum_offset 248
  .amdhsa_group_segment_fixed_size 0
  .amdhsa_kernarg_size 104
  .amdhsa_user_sgpr_count 2
  .amdhsa_user_sgpr_kernarg_segment_ptr 1
  .amdhsa_system_sgpr_workgroup_id_x 1
  .amdhsa_float_denorm_mode_32 3
  .amdhsa_float_denorm_mode_16_64 3
.end_amdhsa_kernel
kd_end_mark:
```
